```python
import torch

def _softmax(x, axis=-1):
    return torch.softmax(x, dim=axis)
def _gelu(x):
    return torch.nn.functional.gelu(x, approximate="tanh")
def _silu(x):
    return torch.nn.functional.silu(x)
def _sigmoid(x):
    return torch.sigmoid(x)
def _layernorm(x, axis=-1, eps=1e-5):
    m = x.mean(dim=axis, keepdim=True)
    v = x.var(dim=axis, keepdim=True, unbiased=False)
    return (x - m) / torch.sqrt(v + eps)
def _scatter_add(tgt, idx, src, axis=0):
    return tgt.clone().index_add_(axis, idx, src)
def _segment_sum(src, seg, n):
    out = torch.zeros((n,) + src.shape[1:], dtype=src.dtype)
    return out.index_add_(0, seg, src)
def _pad(x, pw):
    flat = tuple(v for pair in reversed(pw) for v in pair)
    return torch.nn.functional.pad(x, flat)

kernel_name = 'gated_mix__spectral_gfnet__softmax_full_mha__prompt'

def setup_inputs():

    _w = (lambda a: (lambda t: t.to(torch.bfloat16) if t.is_floating_point() else t)(torch.as_tensor(a)))
    def _A_setup():
        B, S, D = 1, 2048, 448
        Df = D // 2 + 1
        return {
            "x": _w((lambda *s: torch.randn(*s, dtype=torch.bfloat16) * 0.05)(B, S, D)),
            "w_r": _w((lambda *s: torch.randn(*s, dtype=torch.bfloat16) * 6.4)(S, Df) * 0.02),
            "w_i": _w((lambda *s: torch.randn(*s, dtype=torch.bfloat16) * 6.4)(S, Df) * 0.02),
        }
    _A_in = _A_setup()

    def _B_setup():
        B, S, D = 1, 2048, 448
        return {
            "x": _w((lambda *s: torch.randn(*s, dtype=torch.bfloat16) * 0.05)(B, S, D)),
            "wqkv": _w((lambda *s: torch.randn(*s, dtype=torch.bfloat16) * 0.8)(D, 3 * D)),
            "wo": _w((lambda *s: torch.randn(*s, dtype=torch.bfloat16) * 0.05)(D, D)),
        }
    _B_in = _B_setup()

    return {
        "A_x": _A_in["x"],
        "A_w_r": _A_in["w_r"],
        "A_w_i": _A_in["w_i"],
        "B_x": _B_in["x"],
        "B_wqkv": _B_in["wqkv"],
        "B_wo": _B_in["wo"],
        "gate_w": _w((lambda *s: torch.randn(*s, dtype=torch.bfloat16) * 0.05)(448) * 16.0),
    }

def reference(A_x, A_w_r, A_w_i, B_x, B_wqkv, B_wo, gate_w):
    def _A_ref(x, w_r, w_i):
        B, S, D = x.shape
        X = (lambda x, axes=(-2,-1): torch.fft.rfft2(x.float(), dim=axes))(x, axes=(-2, -1))
        W = w_r + 1j * w_i
        X = X * W
        y = (lambda x, s, axes=(-2,-1): torch.fft.irfft2(x, s=s, dim=axes).to(torch.bfloat16))(X, (S, D), axes=(-2, -1))
        return y

    def _B_ref(x, wqkv, wo):
        B, S, D = x.shape
        H = 16; Dh = D // H
        qkv = (lambda x, *d: x.permute(*d))((x @ wqkv).reshape(B, S, 3, H, Dh), 2, 0, 3, 1, 4)
        q, k, v = qkv[0], qkv[1], qkv[2]
        scale = Dh ** -0.5
        scores = torch.einsum("bhqd,bhkd->bhqk", q, k) * scale
        p = _softmax(scores, axis=-1)
        o = torch.einsum("bhqk,bhkd->bhqd", p, v)
        return (lambda x, *d: x.permute(*d))(o, 0, 2, 1, 3).reshape(B, S, D) @ wo

    x = A_x
    g = _sigmoid((x * gate_w).sum(-1, keepdims=True))
    a = _A_ref(x, A_w_r, A_w_i)
    b = _B_ref(x, B_wqkv, B_wo)
    return g * a + (1 - g) * b
```

```asm
; @launch grid=(256,1,1) block=(512,1,1) lds=163840
.amdgcn_target "amdgcn-amd-amdhsa--gfx950"
.text
.globl gated_mix__spectral_gfnet__softmax_full_mha__prompt_kernel
.p2align 8
.type gated_mix__spectral_gfnet__softmax_full_mha__prompt_kernel,@function
gated_mix__spectral_gfnet__softmax_full_mha__prompt_kernel:
    s_cmp_ge_u32 s2, 256
    s_cbranch_scc1 K_END
    s_load_dwordx2 s[4:5], s[0:1], 0
    s_load_dwordx2 s[6:7], s[0:1], 32
    s_load_dwordx4 s[8:11], s[0:1], 40
    s_load_dwordx2 s[12:13], s[0:1], 72
    s_load_dwordx4 s[96:99], s[0:1], 8
    s_load_dwordx2 s[100:101], s[0:1], 56
    s_load_dwordx2 s[14:15], s[0:1], 64
    v_lshrrev_b32 v4, 6, v0
    v_and_b32 v1, 63, v0
    v_readfirstlane_b32 s42, v4
    v_lshlrev_b32 v2, 4, v1
    s_and_b32 s44, s2, 3
    s_lshl_b32 s44, s44, 2
    s_bfe_u32 s45, s2, 0x20003
    s_add_u32 s37, s44, s45
    s_bfe_u32 s55, s2, 0x10005
    s_bfe_u32 s46, s2, 0x10002
    s_bfe_u32 s38, s2, 0x10006
    s_lshl_b32 s46, s46, 1
    s_add_u32 s38, s38, s46
    s_lshr_b32 s44, s2, 5
    s_lshl_b32 s45, s45, 1
    s_add_u32 s39, s44, s45
    s_cmp_ge_u32 s39, 7
    s_cselect_b32 s45, 7, 0
    s_sub_u32 s39, s39, s45
    s_xor_b32 s3, s2, 0
    s_and_b32 s36, s42, 3
    s_cmp_lt_u32 s42, 4
    s_cbranch_scc1 K1_COMP
    s_cmp_ge_u32 s36, 2
    s_cbranch_scc1 K1_SIDE
    s_lshl_b32 s43, s36, 12
    v_lshrrev_b32 v4, 3, v1
    v_mul_u32_u24 v4, 57344, v4
    v_and_b32 v5, 7, v1
    v_lshrrev_b32 v6, 4, v1
    v_xor_b32 v7, v5, v6
    v_lshl_add_u32 v240, v7, 4, v4
    v_xor_b32 v241, 64, v240
    v_lshlrev_b32 v4, 2, v6
    v_sub_u32 v4, v1, v4
    v_and_b32 v4, 15, v4
    v_mul_u32_u24 v7, 2688, v6
    v_cmp_gt_u32 vcc, 14, v4
    v_lshl_add_u32 v7, v4, 4, v7
    v_mov_b32 v5, 2146435072
    v_cndmask_b32 v242, v5, v7, vcc
    s_cmp_ge_u32 s3, 128
    s_cselect_b32 s44, s55, 0
    s_cselect_b32 s45, 0, 1
    s_cselect_b32 s46, 0, s55
    s_lshl_b32 s47, s37, 1
    s_add_u32 s44, s44, s47
    s_lshl_b32 s44, s44, 1
    s_add_u32 s44, s44, s36
    s_mul_i32 s40, s44, 896
    s_add_u32 s45, s45, s46
    s_mul_i32 s41, s45, 896
    s_mul_i32 s45, s38, 224
    s_add_u32 s41, s41, s45
    s_mul_i32 s44, s36, 86016
    s_add_u32 s41, s41, s44
    s_lshl_b32 s54, s36, 13
    s_waitcnt lgkmcnt(0)
    s_mov_b32 s16, s4
    s_and_b32 s17, s5, 0xffff
    s_mov_b32 s18, 1835008
    s_mov_b32 s19, 0x20000
    s_mov_b32 s20, s6
    s_and_b32 s21, s7, 0xffff
    s_mov_b32 s22, 1204224
    s_mov_b32 s23, 0x20000
    s_cmp_ge_u32 s3, 128
    s_cbranch_scc1 K1_LDQ
    s_lshl_b32 s58, s39, 7
    s_add_u32 s58, s58, s40
    s_mul_i32 s59, s39, 172032
    s_add_u32 s59, s59, s41
    s_add_u32 s39, s39, 1
    s_cmp_eq_u32 s39, 7
    s_cselect_b32 s39, 0, s39
    s_add_u32 m0, s43, 114688
    s_nop 0
    buffer_load_dwordx4 v240, s[16:19], s58 offen lds
    s_add_u32 m0, s54, 0
    s_nop 0
    buffer_load_dwordx4 v242, s[20:23], s59 offen lds
    s_add_u32 m0, s54, 1024
    s_add_u32 s59, s59, 10752
    buffer_load_dwordx4 v242, s[20:23], s59 offen lds
    s_add_u32 m0, s43, 115712
    s_add_u32 s58, s58, 458752
    buffer_load_dwordx4 v241, s[16:19], s58 offen lds
    s_add_u32 m0, s54, 2048
    s_add_u32 s59, s59, 10752
    buffer_load_dwordx4 v242, s[20:23], s59 offen lds
    s_add_u32 m0, s54, 3072
    s_add_u32 s59, s59, 10752
    buffer_load_dwordx4 v242, s[20:23], s59 offen lds
    s_add_u32 m0, s43, 116736
    s_add_u32 s58, s58, 458752
    buffer_load_dwordx4 v240, s[16:19], s58 offen lds
    s_add_u32 m0, s54, 4096
    s_add_u32 s59, s59, 10752
    buffer_load_dwordx4 v242, s[20:23], s59 offen lds
    s_add_u32 m0, s54, 5120
    s_add_u32 s59, s59, 10752
    buffer_load_dwordx4 v242, s[20:23], s59 offen lds
    s_add_u32 m0, s43, 117760
    s_add_u32 s58, s58, 458752
    buffer_load_dwordx4 v241, s[16:19], s58 offen lds
    s_add_u32 m0, s54, 6144
    s_add_u32 s59, s59, 10752
    buffer_load_dwordx4 v242, s[20:23], s59 offen lds
    s_add_u32 m0, s54, 7168
    s_add_u32 s59, s59, 10752
    buffer_load_dwordx4 v242, s[20:23], s59 offen lds
    s_lshl_b32 s58, s39, 7
    s_add_u32 s58, s58, s40
    s_mul_i32 s59, s39, 172032
    s_add_u32 s59, s59, s41
    s_add_u32 s39, s39, 1
    s_cmp_eq_u32 s39, 7
    s_cselect_b32 s39, 0, s39
    s_add_u32 m0, s43, 122880
    s_nop 0
    buffer_load_dwordx4 v240, s[16:19], s58 offen lds
    s_add_u32 m0, s54, 16384
    s_nop 0
    buffer_load_dwordx4 v242, s[20:23], s59 offen lds
    s_add_u32 m0, s54, 17408
    s_add_u32 s59, s59, 10752
    buffer_load_dwordx4 v242, s[20:23], s59 offen lds
    s_add_u32 m0, s43, 123904
    s_add_u32 s58, s58, 458752
    buffer_load_dwordx4 v241, s[16:19], s58 offen lds
    s_add_u32 m0, s54, 18432
    s_add_u32 s59, s59, 10752
    buffer_load_dwordx4 v242, s[20:23], s59 offen lds
    s_add_u32 m0, s54, 19456
    s_add_u32 s59, s59, 10752
    buffer_load_dwordx4 v242, s[20:23], s59 offen lds
    s_add_u32 m0, s43, 124928
    s_add_u32 s58, s58, 458752
    buffer_load_dwordx4 v240, s[16:19], s58 offen lds
    s_add_u32 m0, s54, 20480
    s_add_u32 s59, s59, 10752
    buffer_load_dwordx4 v242, s[20:23], s59 offen lds
    s_add_u32 m0, s54, 21504
    s_add_u32 s59, s59, 10752
    buffer_load_dwordx4 v242, s[20:23], s59 offen lds
    s_add_u32 m0, s43, 125952
    s_add_u32 s58, s58, 458752
    buffer_load_dwordx4 v241, s[16:19], s58 offen lds
    s_add_u32 m0, s54, 22528
    s_add_u32 s59, s59, 10752
    buffer_load_dwordx4 v242, s[20:23], s59 offen lds
    s_add_u32 m0, s54, 23552
    s_add_u32 s59, s59, 10752
    buffer_load_dwordx4 v242, s[20:23], s59 offen lds
    s_waitcnt vmcnt(12)
    s_barrier
    s_lshl_b32 s58, s39, 7
    s_add_u32 s58, s58, s40
    s_mul_i32 s59, s39, 172032
    s_add_u32 s59, s59, s41
    s_add_u32 s39, s39, 1
    s_cmp_eq_u32 s39, 7
    s_cselect_b32 s39, 0, s39
    s_add_u32 m0, s43, 131072
    s_nop 0
    buffer_load_dwordx4 v240, s[16:19], s58 offen lds
    s_add_u32 m0, s54, 32768
    s_nop 0
    buffer_load_dwordx4 v242, s[20:23], s59 offen lds
    s_add_u32 m0, s54, 33792
    s_add_u32 s59, s59, 10752
    buffer_load_dwordx4 v242, s[20:23], s59 offen lds
    s_add_u32 m0, s43, 132096
    s_add_u32 s58, s58, 458752
    buffer_load_dwordx4 v241, s[16:19], s58 offen lds
    s_add_u32 m0, s54, 34816
    s_add_u32 s59, s59, 10752
    buffer_load_dwordx4 v242, s[20:23], s59 offen lds
    s_add_u32 m0, s54, 35840
    s_add_u32 s59, s59, 10752
    buffer_load_dwordx4 v242, s[20:23], s59 offen lds
    s_add_u32 m0, s43, 133120
    s_add_u32 s58, s58, 458752
    buffer_load_dwordx4 v240, s[16:19], s58 offen lds
    s_add_u32 m0, s54, 36864
    s_add_u32 s59, s59, 10752
    buffer_load_dwordx4 v242, s[20:23], s59 offen lds
    s_add_u32 m0, s54, 37888
    s_add_u32 s59, s59, 10752
    buffer_load_dwordx4 v242, s[20:23], s59 offen lds
    s_add_u32 m0, s43, 134144
    s_add_u32 s58, s58, 458752
    buffer_load_dwordx4 v241, s[16:19], s58 offen lds
    s_add_u32 m0, s54, 38912
    s_add_u32 s59, s59, 10752
    buffer_load_dwordx4 v242, s[20:23], s59 offen lds
    s_add_u32 m0, s54, 39936
    s_add_u32 s59, s59, 10752
    buffer_load_dwordx4 v242, s[20:23], s59 offen lds
    v_and_b32 v4, 15, v1
    v_lshrrev_b32 v6, 4, v1
    s_lshl_b32 s44, s36, 4
    v_add_u32 v5, s44, v4
    v_cvt_f32_u32 v5, v5
    v_and_b32 v16, 1, v1
    v_mul_u32_u24 v16, 0x8000, v16
    v_lshl_or_b32 v16, v16, 16, v16
    v_mul_f32 v7, 0x3c800000, v5
    v_lshrrev_b32 v8, 5, v1
    v_lshlrev_b32 v8, 2, v8
    v_cvt_f32_u32 v8, v8
    v_and_b32 v9, 1, v6
    v_cvt_f32_u32 v9, v9
    v_mul_f32 v9, 0x3e800000, v9
    v_fma_f32 v8, v8, v7, v9
    v_fmamk_f32 v12, v7, 0x0, v8
    v_fmamk_f32 v14, v7, 0x3f800000, v8
    v_sin_f32 v13, v12
    v_cos_f32 v12, v12
    v_sin_f32 v15, v14
    v_cos_f32 v14, v14
    v_cvt_pk_bf16_f32 v76, v12, v13
    v_cvt_pk_bf16_f32 v77, v14, v15
    v_fmamk_f32 v12, v7, 0x40000000, v8
    v_fmamk_f32 v14, v7, 0x40400000, v8
    v_sin_f32 v13, v12
    v_cos_f32 v12, v12
    v_sin_f32 v15, v14
    v_cos_f32 v14, v14
    v_cvt_pk_bf16_f32 v78, v12, v13
    v_cvt_pk_bf16_f32 v79, v14, v15
    v_fmamk_f32 v12, v7, 0x41000000, v8
    v_fmamk_f32 v14, v7, 0x41100000, v8
    v_sin_f32 v13, v12
    v_cos_f32 v12, v12
    v_sin_f32 v15, v14
    v_cos_f32 v14, v14
    v_cvt_pk_bf16_f32 v80, v12, v13
    v_cvt_pk_bf16_f32 v81, v14, v15
    v_fmamk_f32 v12, v7, 0x41200000, v8
    s_waitcnt vmcnt(12)
    s_barrier
    s_lshl_b32 s58, s39, 7
    s_add_u32 s58, s58, s40
    s_mul_i32 s59, s39, 172032
    s_add_u32 s59, s59, s41
    s_add_u32 s39, s39, 1
    s_cmp_eq_u32 s39, 7
    s_cselect_b32 s39, 0, s39
    s_add_u32 m0, s43, 139264
    s_nop 0
    buffer_load_dwordx4 v240, s[16:19], s58 offen lds
    s_add_u32 m0, s54, 49152
    s_nop 0
    buffer_load_dwordx4 v242, s[20:23], s59 offen lds
    s_add_u32 m0, s54, 50176
    s_add_u32 s59, s59, 10752
    buffer_load_dwordx4 v242, s[20:23], s59 offen lds
    s_add_u32 m0, s43, 140288
    s_add_u32 s58, s58, 458752
    buffer_load_dwordx4 v241, s[16:19], s58 offen lds
    s_add_u32 m0, s54, 51200
    s_add_u32 s59, s59, 10752
    buffer_load_dwordx4 v242, s[20:23], s59 offen lds
    s_add_u32 m0, s54, 52224
    s_add_u32 s59, s59, 10752
    buffer_load_dwordx4 v242, s[20:23], s59 offen lds
    s_add_u32 m0, s43, 141312
    s_add_u32 s58, s58, 458752
    buffer_load_dwordx4 v240, s[16:19], s58 offen lds
    s_add_u32 m0, s54, 53248
    s_add_u32 s59, s59, 10752
    buffer_load_dwordx4 v242, s[20:23], s59 offen lds
    s_add_u32 m0, s54, 54272
    s_add_u32 s59, s59, 10752
    buffer_load_dwordx4 v242, s[20:23], s59 offen lds
    s_add_u32 m0, s43, 142336
    s_add_u32 s58, s58, 458752
    buffer_load_dwordx4 v241, s[16:19], s58 offen lds
    s_add_u32 m0, s54, 55296
    s_add_u32 s59, s59, 10752
    buffer_load_dwordx4 v242, s[20:23], s59 offen lds
    s_add_u32 m0, s54, 56320
    s_add_u32 s59, s59, 10752
    buffer_load_dwordx4 v242, s[20:23], s59 offen lds
    v_fmamk_f32 v14, v7, 0x41300000, v8
    v_sin_f32 v13, v12
    v_cos_f32 v12, v12
    v_sin_f32 v15, v14
    v_cos_f32 v14, v14
    v_cvt_pk_bf16_f32 v82, v12, v13
    v_cvt_pk_bf16_f32 v83, v14, v15
    v_fmamk_f32 v12, v7, 0x41800000, v8
    v_fmamk_f32 v14, v7, 0x41880000, v8
    v_sin_f32 v13, v12
    v_cos_f32 v12, v12
    v_sin_f32 v15, v14
    v_cos_f32 v14, v14
    v_cvt_pk_bf16_f32 v84, v12, v13
    v_cvt_pk_bf16_f32 v85, v14, v15
    v_fmamk_f32 v12, v7, 0x41900000, v8
    v_fmamk_f32 v14, v7, 0x41980000, v8
    v_sin_f32 v13, v12
    v_cos_f32 v12, v12
    v_sin_f32 v15, v14
    v_cos_f32 v14, v14
    v_cvt_pk_bf16_f32 v86, v12, v13
    v_cvt_pk_bf16_f32 v87, v14, v15
    v_fmamk_f32 v12, v7, 0x41c00000, v8
    v_fmamk_f32 v14, v7, 0x41c80000, v8
    v_sin_f32 v13, v12
    v_cos_f32 v12, v12
    v_sin_f32 v15, v14
    v_cos_f32 v14, v14
    v_cvt_pk_bf16_f32 v88, v12, v13
    v_cvt_pk_bf16_f32 v89, v14, v15
    v_fmamk_f32 v12, v7, 0x41d00000, v8
    v_fmamk_f32 v14, v7, 0x41d80000, v8
    v_sin_f32 v13, v12
    v_cos_f32 v12, v12
    v_sin_f32 v15, v14
    v_cos_f32 v14, v14
    v_cvt_pk_bf16_f32 v90, v12, v13
    v_cvt_pk_bf16_f32 v91, v14, v15
    v_xor_b32 v92, v16, v76
    v_xor_b32 v93, v16, v77
    s_waitcnt vmcnt(12)
    s_barrier
    s_lshl_b32 s58, s39, 7
    s_add_u32 s58, s58, s40
    s_mul_i32 s59, s39, 172032
    s_add_u32 s59, s59, s41
    s_add_u32 s39, s39, 1
    s_cmp_eq_u32 s39, 7
    s_cselect_b32 s39, 0, s39
    s_add_u32 m0, s43, 147456
    s_nop 0
    buffer_load_dwordx4 v240, s[16:19], s58 offen lds
    s_add_u32 m0, s54, 65536
    s_nop 0
    buffer_load_dwordx4 v242, s[20:23], s59 offen lds
    s_add_u32 m0, s54, 66560
    s_add_u32 s59, s59, 10752
    buffer_load_dwordx4 v242, s[20:23], s59 offen lds
    s_add_u32 m0, s43, 148480
    s_add_u32 s58, s58, 458752
    buffer_load_dwordx4 v241, s[16:19], s58 offen lds
    s_add_u32 m0, s54, 67584
    s_add_u32 s59, s59, 10752
    buffer_load_dwordx4 v242, s[20:23], s59 offen lds
    s_add_u32 m0, s54, 68608
    s_add_u32 s59, s59, 10752
    buffer_load_dwordx4 v242, s[20:23], s59 offen lds
    s_add_u32 m0, s43, 149504
    s_add_u32 s58, s58, 458752
    buffer_load_dwordx4 v240, s[16:19], s58 offen lds
    s_add_u32 m0, s54, 69632
    s_add_u32 s59, s59, 10752
    buffer_load_dwordx4 v242, s[20:23], s59 offen lds
    s_add_u32 m0, s54, 70656
    s_add_u32 s59, s59, 10752
    buffer_load_dwordx4 v242, s[20:23], s59 offen lds
    s_add_u32 m0, s43, 150528
    s_add_u32 s58, s58, 458752
    buffer_load_dwordx4 v241, s[16:19], s58 offen lds
    s_add_u32 m0, s54, 71680
    s_add_u32 s59, s59, 10752
    buffer_load_dwordx4 v242, s[20:23], s59 offen lds
    s_add_u32 m0, s54, 72704
    s_add_u32 s59, s59, 10752
    buffer_load_dwordx4 v242, s[20:23], s59 offen lds
    v_xor_b32 v94, v16, v78
    v_xor_b32 v95, v16, v79
    v_xor_b32 v96, v16, v80
    v_xor_b32 v97, v16, v81
    v_xor_b32 v98, v16, v82
    v_xor_b32 v99, v16, v83
    v_xor_b32 v100, v16, v84
    v_xor_b32 v101, v16, v85
    v_xor_b32 v102, v16, v86
    v_xor_b32 v103, v16, v87
    v_xor_b32 v104, v16, v88
    v_xor_b32 v105, v16, v89
    v_xor_b32 v106, v16, v90
    v_xor_b32 v107, v16, v91
    v_lshlrev_b32 v9, 2, v6
    v_cvt_f32_u32 v9, v9
    v_mul_f32 v8, v9, v7
    v_fmamk_f32 v12, v7, 0x0, v8
    v_fmamk_f32 v14, v7, 0x3f800000, v8
    v_sin_f32 v13, v12
    v_cos_f32 v12, v12
    v_sin_f32 v15, v14
    v_cos_f32 v14, v14
    v_cvt_pk_bf16_f32 v108, v12, -v13
    v_cvt_pk_bf16_f32 v124, v13, v12
    v_cvt_pk_bf16_f32 v109, v14, -v15
    v_cvt_pk_bf16_f32 v125, v15, v14
    v_fmamk_f32 v12, v7, 0x40000000, v8
    v_fmamk_f32 v14, v7, 0x40400000, v8
    v_sin_f32 v13, v12
    v_cos_f32 v12, v12
    v_sin_f32 v15, v14
    v_cos_f32 v14, v14
    v_cvt_pk_bf16_f32 v110, v12, -v13
    v_cvt_pk_bf16_f32 v126, v13, v12
    v_cvt_pk_bf16_f32 v111, v14, -v15
    v_cvt_pk_bf16_f32 v127, v15, v14
    v_fmamk_f32 v12, v7, 0x41800000, v8
    v_fmamk_f32 v14, v7, 0x41880000, v8
    v_sin_f32 v13, v12
    v_cos_f32 v12, v12
    s_waitcnt vmcnt(12)
    s_barrier
    s_lshl_b32 s58, s39, 7
    s_add_u32 s58, s58, s40
    s_mul_i32 s59, s39, 172032
    s_add_u32 s59, s59, s41
    s_add_u32 s39, s39, 1
    s_cmp_eq_u32 s39, 7
    s_cselect_b32 s39, 0, s39
    s_add_u32 m0, s43, 155648
    s_nop 0
    buffer_load_dwordx4 v240, s[16:19], s58 offen lds
    s_add_u32 m0, s54, 81920
    s_nop 0
    buffer_load_dwordx4 v242, s[20:23], s59 offen lds
    s_add_u32 m0, s54, 82944
    s_add_u32 s59, s59, 10752
    buffer_load_dwordx4 v242, s[20:23], s59 offen lds
    s_add_u32 m0, s43, 156672
    s_add_u32 s58, s58, 458752
    buffer_load_dwordx4 v241, s[16:19], s58 offen lds
    s_add_u32 m0, s54, 83968
    s_add_u32 s59, s59, 10752
    buffer_load_dwordx4 v242, s[20:23], s59 offen lds
    s_add_u32 m0, s54, 84992
    s_add_u32 s59, s59, 10752
    buffer_load_dwordx4 v242, s[20:23], s59 offen lds
    s_add_u32 m0, s43, 157696
    s_add_u32 s58, s58, 458752
    buffer_load_dwordx4 v240, s[16:19], s58 offen lds
    s_add_u32 m0, s54, 86016
    s_add_u32 s59, s59, 10752
    buffer_load_dwordx4 v242, s[20:23], s59 offen lds
    s_add_u32 m0, s54, 87040
    s_add_u32 s59, s59, 10752
    buffer_load_dwordx4 v242, s[20:23], s59 offen lds
    s_add_u32 m0, s43, 158720
    s_add_u32 s58, s58, 458752
    buffer_load_dwordx4 v241, s[16:19], s58 offen lds
    s_add_u32 m0, s54, 88064
    s_add_u32 s59, s59, 10752
    buffer_load_dwordx4 v242, s[20:23], s59 offen lds
    s_add_u32 m0, s54, 89088
    s_add_u32 s59, s59, 10752
    buffer_load_dwordx4 v242, s[20:23], s59 offen lds
    v_sin_f32 v15, v14
    v_cos_f32 v14, v14
    v_cvt_pk_bf16_f32 v112, v12, -v13
    v_cvt_pk_bf16_f32 v128, v13, v12
    v_cvt_pk_bf16_f32 v113, v14, -v15
    v_cvt_pk_bf16_f32 v129, v15, v14
    v_fmamk_f32 v12, v7, 0x41900000, v8
    v_fmamk_f32 v14, v7, 0x41980000, v8
    v_sin_f32 v13, v12
    v_cos_f32 v12, v12
    v_sin_f32 v15, v14
    v_cos_f32 v14, v14
    v_cvt_pk_bf16_f32 v114, v12, -v13
    v_cvt_pk_bf16_f32 v130, v13, v12
    v_cvt_pk_bf16_f32 v115, v14, -v15
    v_cvt_pk_bf16_f32 v131, v15, v14
    v_xor_b32 v116, v16, v108
    v_xor_b32 v117, v16, v109
    v_xor_b32 v118, v16, v110
    v_xor_b32 v119, v16, v111
    v_xor_b32 v120, v16, v112
    v_xor_b32 v121, v16, v113
    v_xor_b32 v122, v16, v114
    v_xor_b32 v123, v16, v115
    v_xor_b32 v132, v16, v124
    v_xor_b32 v133, v16, v125
    v_xor_b32 v134, v16, v126
    v_xor_b32 v135, v16, v127
    v_xor_b32 v136, v16, v128
    v_xor_b32 v137, v16, v129
    v_xor_b32 v138, v16, v130
    v_xor_b32 v139, v16, v131
    v_cvt_f32_u32 v7, v4
    v_mul_f32 v7, 0x3d000000, v7
    v_mul_f32 v8, v9, v7
    v_fmamk_f32 v12, v7, 0x0, v8
    v_sin_f32 v13, v12
    v_cos_f32 v12, v12
    s_nop 0
    v_cvt_pk_bf16_f32 v140, v12, -v13
    v_cvt_pk_bf16_f32 v148, v13, v12
    s_waitcnt vmcnt(12)
    s_barrier
    s_lshl_b32 s58, s39, 7
    s_add_u32 s58, s58, s40
    s_mul_i32 s59, s39, 172032
    s_add_u32 s59, s59, s41
    s_add_u32 s39, s39, 1
    s_cmp_eq_u32 s39, 7
    s_cselect_b32 s39, 0, s39
    s_add_u32 m0, s43, 114688
    s_nop 0
    buffer_load_dwordx4 v240, s[16:19], s58 offen lds
    s_add_u32 m0, s54, 98304
    s_nop 0
    buffer_load_dwordx4 v242, s[20:23], s59 offen lds
    s_add_u32 m0, s54, 99328
    s_add_u32 s59, s59, 10752
    buffer_load_dwordx4 v242, s[20:23], s59 offen lds
    s_add_u32 m0, s43, 115712
    s_add_u32 s58, s58, 458752
    buffer_load_dwordx4 v241, s[16:19], s58 offen lds
    s_add_u32 m0, s54, 100352
    s_add_u32 s59, s59, 10752
    buffer_load_dwordx4 v242, s[20:23], s59 offen lds
    s_add_u32 m0, s54, 101376
    s_add_u32 s59, s59, 10752
    buffer_load_dwordx4 v242, s[20:23], s59 offen lds
    s_add_u32 m0, s43, 116736
    s_add_u32 s58, s58, 458752
    buffer_load_dwordx4 v240, s[16:19], s58 offen lds
    s_add_u32 m0, s54, 102400
    s_add_u32 s59, s59, 10752
    buffer_load_dwordx4 v242, s[20:23], s59 offen lds
    s_add_u32 m0, s54, 103424
    s_add_u32 s59, s59, 10752
    buffer_load_dwordx4 v242, s[20:23], s59 offen lds
    s_add_u32 m0, s43, 117760
    s_add_u32 s58, s58, 458752
    buffer_load_dwordx4 v241, s[16:19], s58 offen lds
    s_add_u32 m0, s54, 104448
    s_add_u32 s59, s59, 10752
    buffer_load_dwordx4 v242, s[20:23], s59 offen lds
    s_add_u32 m0, s54, 105472
    s_add_u32 s59, s59, 10752
    buffer_load_dwordx4 v242, s[20:23], s59 offen lds
    v_cvt_pk_bf16_f32 v156, v12, -v13
    v_cvt_pk_bf16_f32 v164, v13, v12
    v_fmamk_f32 v12, v7, 0x3f800000, v8
    v_sin_f32 v13, v12
    v_cos_f32 v12, v12
    s_nop 0
    v_cvt_pk_bf16_f32 v141, v12, -v13
    v_cvt_pk_bf16_f32 v149, v13, v12
    v_cvt_pk_bf16_f32 v157, -v12, v13
    v_cvt_pk_bf16_f32 v165, -v13, -v12
    v_fmamk_f32 v12, v7, 0x40000000, v8
    v_sin_f32 v13, v12
    v_cos_f32 v12, v12
    s_nop 0
    v_cvt_pk_bf16_f32 v142, v12, -v13
    v_cvt_pk_bf16_f32 v150, v13, v12
    v_cvt_pk_bf16_f32 v158, v12, -v13
    v_cvt_pk_bf16_f32 v166, v13, v12
    v_fmamk_f32 v12, v7, 0x40400000, v8
    v_sin_f32 v13, v12
    v_cos_f32 v12, v12
    s_nop 0
    v_cvt_pk_bf16_f32 v143, v12, -v13
    v_cvt_pk_bf16_f32 v151, v13, v12
    v_cvt_pk_bf16_f32 v159, -v12, v13
    v_cvt_pk_bf16_f32 v167, -v13, -v12
    v_xor_b32 v144, v16, v140
    v_xor_b32 v145, v16, v141
    v_xor_b32 v146, v16, v142
    v_xor_b32 v147, v16, v143
    v_xor_b32 v152, v16, v148
    v_xor_b32 v153, v16, v149
    v_xor_b32 v154, v16, v150
    v_xor_b32 v155, v16, v151
    v_xor_b32 v160, v16, v156
    v_xor_b32 v161, v16, v157
    v_xor_b32 v162, v16, v158
    v_xor_b32 v163, v16, v159
    v_xor_b32 v168, v16, v164
    v_xor_b32 v169, v16, v165
    v_xor_b32 v170, v16, v166
    s_waitcnt vmcnt(12)
    s_barrier
    s_lshl_b32 s58, s39, 7
    s_add_u32 s58, s58, s40
    s_add_u32 s58, s58, 1792
    s_add_u32 s39, s39, 1
    s_cmp_eq_u32 s39, 7
    s_cselect_b32 s39, 0, s39
    s_add_u32 m0, s43, 122880
    s_nop 0
    buffer_load_dwordx4 v240, s[16:19], s58 offen lds
    s_add_u32 m0, s43, 123904
    s_add_u32 s58, s58, 458752
    buffer_load_dwordx4 v241, s[16:19], s58 offen lds
    s_add_u32 m0, s43, 124928
    s_add_u32 s58, s58, 458752
    buffer_load_dwordx4 v240, s[16:19], s58 offen lds
    s_add_u32 m0, s43, 125952
    s_add_u32 s58, s58, 458752
    buffer_load_dwordx4 v241, s[16:19], s58 offen lds
    s_lshl_b32 s58, s39, 7
    s_add_u32 s58, s58, s40
    s_add_u32 s58, s58, 1792
    s_add_u32 s39, s39, 1
    s_cmp_eq_u32 s39, 7
    s_cselect_b32 s39, 0, s39
    s_add_u32 m0, s43, 131072
    s_nop 0
    buffer_load_dwordx4 v240, s[16:19], s58 offen lds
    s_add_u32 m0, s43, 132096
    s_add_u32 s58, s58, 458752
    buffer_load_dwordx4 v241, s[16:19], s58 offen lds
    s_add_u32 m0, s43, 133120
    s_add_u32 s58, s58, 458752
    buffer_load_dwordx4 v240, s[16:19], s58 offen lds
    s_add_u32 m0, s43, 134144
    s_add_u32 s58, s58, 458752
    buffer_load_dwordx4 v241, s[16:19], s58 offen lds
    v_xor_b32 v171, v16, v167
    v_mul_f32 v5, 0x3a000000, v5
    v_mul_f32 v7, v9, v5
    v_fmamk_f32 v8, v5, 0x0, v7
    v_cos_f32 v188, v8
    v_sin_f32 v189, v8
    v_fmamk_f32 v8, v5, 0x3f800000, v7
    v_cos_f32 v190, v8
    v_sin_f32 v191, v8
    v_fmamk_f32 v8, v5, 0x40000000, v7
    v_cos_f32 v192, v8
    v_sin_f32 v193, v8
    v_fmamk_f32 v8, v5, 0x40400000, v7
    v_cos_f32 v194, v8
    v_sin_f32 v195, v8
    v_fmamk_f32 v8, v5, 0x41800000, v7
    v_cos_f32 v196, v8
    v_sin_f32 v197, v8
    v_fmamk_f32 v8, v5, 0x41880000, v7
    v_cos_f32 v198, v8
    v_sin_f32 v199, v8
    v_fmamk_f32 v8, v5, 0x41900000, v7
    v_cos_f32 v200, v8
    v_sin_f32 v201, v8
    v_fmamk_f32 v8, v5, 0x41980000, v7
    v_cos_f32 v202, v8
    v_sin_f32 v203, v8
    s_lshl_b32 s44, s36, 11
    s_add_u32 s44, s44, 57344
    v_add_u32 v205, s44, v2
    v_lshlrev_b32 v206, 4, v4
    v_lshl_add_u32 v206, v6, 9, v206
    v_add_u32 v206, 57344, v206
    v_mul_u32_u24 v204, 28672, v4
    v_and_b32 v7, 1, v6
    v_lshl_add_u32 v204, v7, 5, v204
    v_lshrrev_b32 v7, 1, v6
    v_lshl_add_u32 v204, v7, 4, v204
    v_lshlrev_b32 v207, 9, v1
    s_waitcnt vmcnt(8)
    s_barrier
    s_lshl_b32 s58, s39, 7
    s_add_u32 s58, s58, s40
    s_add_u32 s58, s58, 1792
    s_add_u32 s39, s39, 1
    s_cmp_eq_u32 s39, 7
    s_cselect_b32 s39, 0, s39
    s_add_u32 m0, s43, 139264
    s_nop 0
    buffer_load_dwordx4 v240, s[16:19], s58 offen lds
    s_add_u32 m0, s43, 140288
    s_add_u32 s58, s58, 458752
    buffer_load_dwordx4 v241, s[16:19], s58 offen lds
    s_add_u32 m0, s43, 141312
    s_add_u32 s58, s58, 458752
    buffer_load_dwordx4 v240, s[16:19], s58 offen lds
    s_add_u32 m0, s43, 142336
    s_add_u32 s58, s58, 458752
    buffer_load_dwordx4 v241, s[16:19], s58 offen lds
    s_waitcnt vmcnt(8)
    s_barrier
    s_lshl_b32 s58, s39, 7
    s_add_u32 s58, s58, s40
    s_add_u32 s58, s58, 1792
    s_add_u32 s39, s39, 1
    s_cmp_eq_u32 s39, 7
    s_cselect_b32 s39, 0, s39
    s_add_u32 m0, s43, 147456
    s_nop 0
    buffer_load_dwordx4 v240, s[16:19], s58 offen lds
    s_add_u32 m0, s43, 148480
    s_add_u32 s58, s58, 458752
    buffer_load_dwordx4 v241, s[16:19], s58 offen lds
    s_add_u32 m0, s43, 149504
    s_add_u32 s58, s58, 458752
    buffer_load_dwordx4 v240, s[16:19], s58 offen lds
    s_add_u32 m0, s43, 150528
    s_add_u32 s58, s58, 458752
    buffer_load_dwordx4 v241, s[16:19], s58 offen lds
    s_waitcnt vmcnt(8)
    s_barrier
    s_lshl_b32 s58, s39, 7
    s_add_u32 s58, s58, s40
    s_add_u32 s58, s58, 1792
    s_add_u32 s39, s39, 1
    s_cmp_eq_u32 s39, 7
    s_cselect_b32 s39, 0, s39
    s_add_u32 m0, s43, 155648
    s_nop 0
    buffer_load_dwordx4 v240, s[16:19], s58 offen lds
    s_add_u32 m0, s43, 156672
    s_add_u32 s58, s58, 458752
    buffer_load_dwordx4 v241, s[16:19], s58 offen lds
    s_add_u32 m0, s43, 157696
    s_add_u32 s58, s58, 458752
    buffer_load_dwordx4 v240, s[16:19], s58 offen lds
    s_add_u32 m0, s43, 158720
    s_add_u32 s58, s58, 458752
    buffer_load_dwordx4 v241, s[16:19], s58 offen lds
    s_waitcnt vmcnt(8)
    s_barrier
    s_lshl_b32 s58, s39, 7
    s_add_u32 s58, s58, s40
    s_add_u32 s58, s58, 1792
    s_add_u32 s39, s39, 1
    s_cmp_eq_u32 s39, 7
    s_cselect_b32 s39, 0, s39
    s_add_u32 m0, s43, 114688
    s_nop 0
    buffer_load_dwordx4 v240, s[16:19], s58 offen lds
    s_add_u32 m0, s43, 115712
    s_add_u32 s58, s58, 458752
    buffer_load_dwordx4 v241, s[16:19], s58 offen lds
    s_add_u32 m0, s43, 116736
    s_add_u32 s58, s58, 458752
    buffer_load_dwordx4 v240, s[16:19], s58 offen lds
    s_add_u32 m0, s43, 117760
    s_add_u32 s58, s58, 458752
    buffer_load_dwordx4 v241, s[16:19], s58 offen lds
    s_waitcnt vmcnt(8)
    s_barrier
    s_lshl_b32 s58, s39, 7
    s_add_u32 s58, s58, s40
    s_add_u32 s58, s58, 1792
    s_add_u32 s39, s39, 1
    s_cmp_eq_u32 s39, 7
    s_cselect_b32 s39, 0, s39
    s_add_u32 m0, s43, 122880
    s_nop 0
    buffer_load_dwordx4 v240, s[16:19], s58 offen lds
    s_add_u32 m0, s43, 123904
    s_add_u32 s58, s58, 458752
    buffer_load_dwordx4 v241, s[16:19], s58 offen lds
    s_add_u32 m0, s43, 124928
    s_add_u32 s58, s58, 458752
    buffer_load_dwordx4 v240, s[16:19], s58 offen lds
    s_add_u32 m0, s43, 125952
    s_add_u32 s58, s58, 458752
    buffer_load_dwordx4 v241, s[16:19], s58 offen lds
    s_waitcnt vmcnt(8)
    s_barrier
    s_waitcnt vmcnt(4)
    s_barrier
    s_waitcnt vmcnt(0)
    s_barrier
    s_branch K1_LDE
K1_LDQ:
    s_lshl_b32 s58, s39, 7
    s_add_u32 s58, s58, s40
    s_mul_i32 s59, s39, 172032
    s_add_u32 s59, s59, s41
    s_add_u32 s39, s39, 1
    s_cmp_eq_u32 s39, 7
    s_cselect_b32 s39, 0, s39
    s_add_u32 m0, s43, 98304
    s_nop 0
    buffer_load_dwordx4 v240, s[16:19], s58 offen lds
    s_add_u32 m0, s54, 0
    s_nop 0
    buffer_load_dwordx4 v242, s[20:23], s59 offen lds
    s_add_u32 m0, s54, 1024
    s_add_u32 s59, s59, 10752
    buffer_load_dwordx4 v242, s[20:23], s59 offen lds
    s_add_u32 m0, s43, 99328
    s_add_u32 s58, s58, 458752
    buffer_load_dwordx4 v241, s[16:19], s58 offen lds
    s_add_u32 m0, s54, 2048
    s_add_u32 s59, s59, 10752
    buffer_load_dwordx4 v242, s[20:23], s59 offen lds
    s_add_u32 m0, s54, 3072
    s_add_u32 s59, s59, 10752
    buffer_load_dwordx4 v242, s[20:23], s59 offen lds
    s_add_u32 m0, s43, 100352
    s_add_u32 s58, s58, 458752
    buffer_load_dwordx4 v240, s[16:19], s58 offen lds
    s_add_u32 m0, s54, 4096
    s_add_u32 s59, s59, 10752
    buffer_load_dwordx4 v242, s[20:23], s59 offen lds
    s_add_u32 m0, s54, 5120
    s_add_u32 s59, s59, 10752
    buffer_load_dwordx4 v242, s[20:23], s59 offen lds
    s_add_u32 m0, s43, 101376
    s_add_u32 s58, s58, 458752
    buffer_load_dwordx4 v241, s[16:19], s58 offen lds
    s_add_u32 m0, s54, 6144
    s_add_u32 s59, s59, 10752
    buffer_load_dwordx4 v242, s[20:23], s59 offen lds
    s_add_u32 m0, s54, 7168
    s_add_u32 s59, s59, 10752
    buffer_load_dwordx4 v242, s[20:23], s59 offen lds
    s_lshl_b32 s58, s39, 7
    s_add_u32 s58, s58, s40
    s_mul_i32 s59, s39, 172032
    s_add_u32 s59, s59, s41
    s_add_u32 s39, s39, 1
    s_cmp_eq_u32 s39, 7
    s_cselect_b32 s39, 0, s39
    s_add_u32 m0, s43, 106496
    s_nop 0
    buffer_load_dwordx4 v240, s[16:19], s58 offen lds
    s_add_u32 m0, s54, 16384
    s_nop 0
    buffer_load_dwordx4 v242, s[20:23], s59 offen lds
    s_add_u32 m0, s54, 17408
    s_add_u32 s59, s59, 10752
    buffer_load_dwordx4 v242, s[20:23], s59 offen lds
    s_add_u32 m0, s43, 107520
    s_add_u32 s58, s58, 458752
    buffer_load_dwordx4 v241, s[16:19], s58 offen lds
    s_add_u32 m0, s54, 18432
    s_add_u32 s59, s59, 10752
    buffer_load_dwordx4 v242, s[20:23], s59 offen lds
    s_add_u32 m0, s54, 19456
    s_add_u32 s59, s59, 10752
    buffer_load_dwordx4 v242, s[20:23], s59 offen lds
    s_add_u32 m0, s43, 108544
    s_add_u32 s58, s58, 458752
    buffer_load_dwordx4 v240, s[16:19], s58 offen lds
    s_add_u32 m0, s54, 20480
    s_add_u32 s59, s59, 10752
    buffer_load_dwordx4 v242, s[20:23], s59 offen lds
    s_add_u32 m0, s54, 21504
    s_add_u32 s59, s59, 10752
    buffer_load_dwordx4 v242, s[20:23], s59 offen lds
    s_add_u32 m0, s43, 109568
    s_add_u32 s58, s58, 458752
    buffer_load_dwordx4 v241, s[16:19], s58 offen lds
    s_add_u32 m0, s54, 22528
    s_add_u32 s59, s59, 10752
    buffer_load_dwordx4 v242, s[20:23], s59 offen lds
    s_add_u32 m0, s54, 23552
    s_add_u32 s59, s59, 10752
    buffer_load_dwordx4 v242, s[20:23], s59 offen lds
    s_waitcnt vmcnt(12)
    s_barrier
    s_lshl_b32 s58, s39, 7
    s_add_u32 s58, s58, s40
    s_mul_i32 s59, s39, 172032
    s_add_u32 s59, s59, s41
    s_add_u32 s39, s39, 1
    s_cmp_eq_u32 s39, 7
    s_cselect_b32 s39, 0, s39
    s_add_u32 m0, s43, 114688
    s_nop 0
    buffer_load_dwordx4 v240, s[16:19], s58 offen lds
    s_add_u32 m0, s54, 32768
    s_nop 0
    buffer_load_dwordx4 v242, s[20:23], s59 offen lds
    s_add_u32 m0, s54, 33792
    s_add_u32 s59, s59, 10752
    buffer_load_dwordx4 v242, s[20:23], s59 offen lds
    s_add_u32 m0, s43, 115712
    s_add_u32 s58, s58, 458752
    buffer_load_dwordx4 v241, s[16:19], s58 offen lds
    s_add_u32 m0, s54, 34816
    s_add_u32 s59, s59, 10752
    buffer_load_dwordx4 v242, s[20:23], s59 offen lds
    s_add_u32 m0, s54, 35840
    s_add_u32 s59, s59, 10752
    buffer_load_dwordx4 v242, s[20:23], s59 offen lds
    s_add_u32 m0, s43, 116736
    s_add_u32 s58, s58, 458752
    buffer_load_dwordx4 v240, s[16:19], s58 offen lds
    s_add_u32 m0, s54, 36864
    s_add_u32 s59, s59, 10752
    buffer_load_dwordx4 v242, s[20:23], s59 offen lds
    s_add_u32 m0, s54, 37888
    s_add_u32 s59, s59, 10752
    buffer_load_dwordx4 v242, s[20:23], s59 offen lds
    s_add_u32 m0, s43, 117760
    s_add_u32 s58, s58, 458752
    buffer_load_dwordx4 v241, s[16:19], s58 offen lds
    s_add_u32 m0, s54, 38912
    s_add_u32 s59, s59, 10752
    buffer_load_dwordx4 v242, s[20:23], s59 offen lds
    s_add_u32 m0, s54, 39936
    s_add_u32 s59, s59, 10752
    buffer_load_dwordx4 v242, s[20:23], s59 offen lds
    v_and_b32 v4, 15, v1
    v_lshrrev_b32 v6, 4, v1
    s_lshl_b32 s44, s36, 4
    v_add_u32 v5, s44, v4
    v_cvt_f32_u32 v5, v5
    v_and_b32 v16, 1, v1
    v_mul_u32_u24 v16, 0x8000, v16
    v_lshl_or_b32 v16, v16, 16, v16
    v_mul_f32 v7, 0x3c800000, v5
    v_lshrrev_b32 v8, 5, v1
    v_lshlrev_b32 v8, 2, v8
    v_cvt_f32_u32 v8, v8
    v_and_b32 v9, 1, v6
    v_cvt_f32_u32 v9, v9
    v_mul_f32 v9, 0x3e800000, v9
    v_fma_f32 v8, v8, v7, v9
    v_fmamk_f32 v12, v7, 0x0, v8
    v_fmamk_f32 v14, v7, 0x3f800000, v8
    v_sin_f32 v13, v12
    v_cos_f32 v12, v12
    v_sin_f32 v15, v14
    v_cos_f32 v14, v14
    v_cvt_pk_bf16_f32 v76, v12, v13
    v_cvt_pk_bf16_f32 v77, v14, v15
    v_fmamk_f32 v12, v7, 0x40000000, v8
    v_fmamk_f32 v14, v7, 0x40400000, v8
    v_sin_f32 v13, v12
    v_cos_f32 v12, v12
    v_sin_f32 v15, v14
    v_cos_f32 v14, v14
    v_cvt_pk_bf16_f32 v78, v12, v13
    v_cvt_pk_bf16_f32 v79, v14, v15
    v_fmamk_f32 v12, v7, 0x41000000, v8
    v_fmamk_f32 v14, v7, 0x41100000, v8
    v_sin_f32 v13, v12
    v_cos_f32 v12, v12
    v_sin_f32 v15, v14
    v_cos_f32 v14, v14
    v_cvt_pk_bf16_f32 v80, v12, v13
    v_cvt_pk_bf16_f32 v81, v14, v15
    v_fmamk_f32 v12, v7, 0x41200000, v8
    s_waitcnt vmcnt(12)
    s_barrier
    s_lshl_b32 s58, s39, 7
    s_add_u32 s58, s58, s40
    s_mul_i32 s59, s39, 172032
    s_add_u32 s59, s59, s41
    s_add_u32 s39, s39, 1
    s_cmp_eq_u32 s39, 7
    s_cselect_b32 s39, 0, s39
    s_add_u32 m0, s43, 122880
    s_nop 0
    buffer_load_dwordx4 v240, s[16:19], s58 offen lds
    s_add_u32 m0, s54, 49152
    s_nop 0
    buffer_load_dwordx4 v242, s[20:23], s59 offen lds
    s_add_u32 m0, s54, 50176
    s_add_u32 s59, s59, 10752
    buffer_load_dwordx4 v242, s[20:23], s59 offen lds
    s_add_u32 m0, s43, 123904
    s_add_u32 s58, s58, 458752
    buffer_load_dwordx4 v241, s[16:19], s58 offen lds
    s_add_u32 m0, s54, 51200
    s_add_u32 s59, s59, 10752
    buffer_load_dwordx4 v242, s[20:23], s59 offen lds
    s_add_u32 m0, s54, 52224
    s_add_u32 s59, s59, 10752
    buffer_load_dwordx4 v242, s[20:23], s59 offen lds
    s_add_u32 m0, s43, 124928
    s_add_u32 s58, s58, 458752
    buffer_load_dwordx4 v240, s[16:19], s58 offen lds
    s_add_u32 m0, s54, 53248
    s_add_u32 s59, s59, 10752
    buffer_load_dwordx4 v242, s[20:23], s59 offen lds
    s_add_u32 m0, s54, 54272
    s_add_u32 s59, s59, 10752
    buffer_load_dwordx4 v242, s[20:23], s59 offen lds
    s_add_u32 m0, s43, 125952
    s_add_u32 s58, s58, 458752
    buffer_load_dwordx4 v241, s[16:19], s58 offen lds
    s_add_u32 m0, s54, 55296
    s_add_u32 s59, s59, 10752
    buffer_load_dwordx4 v242, s[20:23], s59 offen lds
    s_add_u32 m0, s54, 56320
    s_add_u32 s59, s59, 10752
    buffer_load_dwordx4 v242, s[20:23], s59 offen lds
    v_fmamk_f32 v14, v7, 0x41300000, v8
    v_sin_f32 v13, v12
    v_cos_f32 v12, v12
    v_sin_f32 v15, v14
    v_cos_f32 v14, v14
    v_cvt_pk_bf16_f32 v82, v12, v13
    v_cvt_pk_bf16_f32 v83, v14, v15
    v_fmamk_f32 v12, v7, 0x41800000, v8
    v_fmamk_f32 v14, v7, 0x41880000, v8
    v_sin_f32 v13, v12
    v_cos_f32 v12, v12
    v_sin_f32 v15, v14
    v_cos_f32 v14, v14
    v_cvt_pk_bf16_f32 v84, v12, v13
    v_cvt_pk_bf16_f32 v85, v14, v15
    v_fmamk_f32 v12, v7, 0x41900000, v8
    v_fmamk_f32 v14, v7, 0x41980000, v8
    v_sin_f32 v13, v12
    v_cos_f32 v12, v12
    v_sin_f32 v15, v14
    v_cos_f32 v14, v14
    v_cvt_pk_bf16_f32 v86, v12, v13
    v_cvt_pk_bf16_f32 v87, v14, v15
    v_fmamk_f32 v12, v7, 0x41c00000, v8
    v_fmamk_f32 v14, v7, 0x41c80000, v8
    v_sin_f32 v13, v12
    v_cos_f32 v12, v12
    v_sin_f32 v15, v14
    v_cos_f32 v14, v14
    v_cvt_pk_bf16_f32 v88, v12, v13
    v_cvt_pk_bf16_f32 v89, v14, v15
    v_fmamk_f32 v12, v7, 0x41d00000, v8
    v_fmamk_f32 v14, v7, 0x41d80000, v8
    v_sin_f32 v13, v12
    v_cos_f32 v12, v12
    v_sin_f32 v15, v14
    v_cos_f32 v14, v14
    v_cvt_pk_bf16_f32 v90, v12, v13
    v_cvt_pk_bf16_f32 v91, v14, v15
    v_xor_b32 v92, v16, v76
    v_xor_b32 v93, v16, v77
    s_waitcnt vmcnt(12)
    s_barrier
    s_lshl_b32 s58, s39, 7
    s_add_u32 s58, s58, s40
    s_mul_i32 s59, s39, 172032
    s_add_u32 s59, s59, s41
    s_add_u32 s39, s39, 1
    s_cmp_eq_u32 s39, 7
    s_cselect_b32 s39, 0, s39
    s_add_u32 m0, s43, 131072
    s_nop 0
    buffer_load_dwordx4 v240, s[16:19], s58 offen lds
    s_add_u32 m0, s54, 65536
    s_nop 0
    buffer_load_dwordx4 v242, s[20:23], s59 offen lds
    s_add_u32 m0, s54, 66560
    s_add_u32 s59, s59, 10752
    buffer_load_dwordx4 v242, s[20:23], s59 offen lds
    s_add_u32 m0, s43, 132096
    s_add_u32 s58, s58, 458752
    buffer_load_dwordx4 v241, s[16:19], s58 offen lds
    s_add_u32 m0, s54, 67584
    s_add_u32 s59, s59, 10752
    buffer_load_dwordx4 v242, s[20:23], s59 offen lds
    s_add_u32 m0, s54, 68608
    s_add_u32 s59, s59, 10752
    buffer_load_dwordx4 v242, s[20:23], s59 offen lds
    s_add_u32 m0, s43, 133120
    s_add_u32 s58, s58, 458752
    buffer_load_dwordx4 v240, s[16:19], s58 offen lds
    s_add_u32 m0, s54, 69632
    s_add_u32 s59, s59, 10752
    buffer_load_dwordx4 v242, s[20:23], s59 offen lds
    s_add_u32 m0, s54, 70656
    s_add_u32 s59, s59, 10752
    buffer_load_dwordx4 v242, s[20:23], s59 offen lds
    s_add_u32 m0, s43, 134144
    s_add_u32 s58, s58, 458752
    buffer_load_dwordx4 v241, s[16:19], s58 offen lds
    s_add_u32 m0, s54, 71680
    s_add_u32 s59, s59, 10752
    buffer_load_dwordx4 v242, s[20:23], s59 offen lds
    s_add_u32 m0, s54, 72704
    s_add_u32 s59, s59, 10752
    buffer_load_dwordx4 v242, s[20:23], s59 offen lds
    v_xor_b32 v94, v16, v78
    v_xor_b32 v95, v16, v79
    v_xor_b32 v96, v16, v80
    v_xor_b32 v97, v16, v81
    v_xor_b32 v98, v16, v82
    v_xor_b32 v99, v16, v83
    v_xor_b32 v100, v16, v84
    v_xor_b32 v101, v16, v85
    v_xor_b32 v102, v16, v86
    v_xor_b32 v103, v16, v87
    v_xor_b32 v104, v16, v88
    v_xor_b32 v105, v16, v89
    v_xor_b32 v106, v16, v90
    v_xor_b32 v107, v16, v91
    v_lshlrev_b32 v9, 2, v6
    v_cvt_f32_u32 v9, v9
    v_mul_f32 v8, v9, v7
    v_fmamk_f32 v12, v7, 0x0, v8
    v_fmamk_f32 v14, v7, 0x3f800000, v8
    v_sin_f32 v13, v12
    v_cos_f32 v12, v12
    v_sin_f32 v15, v14
    v_cos_f32 v14, v14
    v_cvt_pk_bf16_f32 v108, v12, -v13
    v_cvt_pk_bf16_f32 v124, v13, v12
    v_cvt_pk_bf16_f32 v109, v14, -v15
    v_cvt_pk_bf16_f32 v125, v15, v14
    v_fmamk_f32 v12, v7, 0x40000000, v8
    v_fmamk_f32 v14, v7, 0x40400000, v8
    v_sin_f32 v13, v12
    v_cos_f32 v12, v12
    v_sin_f32 v15, v14
    v_cos_f32 v14, v14
    v_cvt_pk_bf16_f32 v110, v12, -v13
    v_cvt_pk_bf16_f32 v126, v13, v12
    v_cvt_pk_bf16_f32 v111, v14, -v15
    v_cvt_pk_bf16_f32 v127, v15, v14
    v_fmamk_f32 v12, v7, 0x41800000, v8
    v_fmamk_f32 v14, v7, 0x41880000, v8
    v_sin_f32 v13, v12
    v_cos_f32 v12, v12
    s_waitcnt vmcnt(12)
    s_barrier
    s_lshl_b32 s58, s39, 7
    s_add_u32 s58, s58, s40
    s_mul_i32 s59, s39, 172032
    s_add_u32 s59, s59, s41
    s_add_u32 s39, s39, 1
    s_cmp_eq_u32 s39, 7
    s_cselect_b32 s39, 0, s39
    s_add_u32 m0, s43, 139264
    s_nop 0
    buffer_load_dwordx4 v240, s[16:19], s58 offen lds
    s_add_u32 m0, s54, 81920
    s_nop 0
    buffer_load_dwordx4 v242, s[20:23], s59 offen lds
    s_add_u32 m0, s54, 82944
    s_add_u32 s59, s59, 10752
    buffer_load_dwordx4 v242, s[20:23], s59 offen lds
    s_add_u32 m0, s43, 140288
    s_add_u32 s58, s58, 458752
    buffer_load_dwordx4 v241, s[16:19], s58 offen lds
    s_add_u32 m0, s54, 83968
    s_add_u32 s59, s59, 10752
    buffer_load_dwordx4 v242, s[20:23], s59 offen lds
    s_add_u32 m0, s54, 84992
    s_add_u32 s59, s59, 10752
    buffer_load_dwordx4 v242, s[20:23], s59 offen lds
    s_add_u32 m0, s43, 141312
    s_add_u32 s58, s58, 458752
    buffer_load_dwordx4 v240, s[16:19], s58 offen lds
    s_add_u32 m0, s54, 86016
    s_add_u32 s59, s59, 10752
    buffer_load_dwordx4 v242, s[20:23], s59 offen lds
    s_add_u32 m0, s54, 87040
    s_add_u32 s59, s59, 10752
    buffer_load_dwordx4 v242, s[20:23], s59 offen lds
    s_add_u32 m0, s43, 142336
    s_add_u32 s58, s58, 458752
    buffer_load_dwordx4 v241, s[16:19], s58 offen lds
    s_add_u32 m0, s54, 88064
    s_add_u32 s59, s59, 10752
    buffer_load_dwordx4 v242, s[20:23], s59 offen lds
    s_add_u32 m0, s54, 89088
    s_add_u32 s59, s59, 10752
    buffer_load_dwordx4 v242, s[20:23], s59 offen lds
    v_sin_f32 v15, v14
    v_cos_f32 v14, v14
    v_cvt_pk_bf16_f32 v112, v12, -v13
    v_cvt_pk_bf16_f32 v128, v13, v12
    v_cvt_pk_bf16_f32 v113, v14, -v15
    v_cvt_pk_bf16_f32 v129, v15, v14
    v_fmamk_f32 v12, v7, 0x41900000, v8
    v_fmamk_f32 v14, v7, 0x41980000, v8
    v_sin_f32 v13, v12
    v_cos_f32 v12, v12
    v_sin_f32 v15, v14
    v_cos_f32 v14, v14
    v_cvt_pk_bf16_f32 v114, v12, -v13
    v_cvt_pk_bf16_f32 v130, v13, v12
    v_cvt_pk_bf16_f32 v115, v14, -v15
    v_cvt_pk_bf16_f32 v131, v15, v14
    v_xor_b32 v116, v16, v108
    v_xor_b32 v117, v16, v109
    v_xor_b32 v118, v16, v110
    v_xor_b32 v119, v16, v111
    v_xor_b32 v120, v16, v112
    v_xor_b32 v121, v16, v113
    v_xor_b32 v122, v16, v114
    v_xor_b32 v123, v16, v115
    v_xor_b32 v132, v16, v124
    v_xor_b32 v133, v16, v125
    v_xor_b32 v134, v16, v126
    v_xor_b32 v135, v16, v127
    v_xor_b32 v136, v16, v128
    v_xor_b32 v137, v16, v129
    v_xor_b32 v138, v16, v130
    v_xor_b32 v139, v16, v131
    v_cvt_f32_u32 v7, v4
    v_mul_f32 v7, 0x3d000000, v7
    v_mul_f32 v8, v9, v7
    v_fmamk_f32 v12, v7, 0x0, v8
    v_sin_f32 v13, v12
    v_cos_f32 v12, v12
    s_nop 0
    v_cvt_pk_bf16_f32 v140, v12, -v13
    v_cvt_pk_bf16_f32 v148, v13, v12
    s_waitcnt vmcnt(12)
    s_barrier
    s_lshl_b32 s58, s39, 7
    s_add_u32 s58, s58, s40
    s_mul_i32 s59, s39, 172032
    s_add_u32 s59, s59, s41
    s_add_u32 s39, s39, 1
    s_cmp_eq_u32 s39, 7
    s_cselect_b32 s39, 0, s39
    s_add_u32 m0, s43, 147456
    s_nop 0
    buffer_load_dwordx4 v240, s[16:19], s58 offen lds
    s_add_u32 m0, s54, 0
    s_nop 0
    buffer_load_dwordx4 v242, s[20:23], s59 offen lds
    s_add_u32 m0, s54, 1024
    s_add_u32 s59, s59, 10752
    buffer_load_dwordx4 v242, s[20:23], s59 offen lds
    s_add_u32 m0, s43, 148480
    s_add_u32 s58, s58, 458752
    buffer_load_dwordx4 v241, s[16:19], s58 offen lds
    s_add_u32 m0, s54, 2048
    s_add_u32 s59, s59, 10752
    buffer_load_dwordx4 v242, s[20:23], s59 offen lds
    s_add_u32 m0, s54, 3072
    s_add_u32 s59, s59, 10752
    buffer_load_dwordx4 v242, s[20:23], s59 offen lds
    s_add_u32 m0, s43, 149504
    s_add_u32 s58, s58, 458752
    buffer_load_dwordx4 v240, s[16:19], s58 offen lds
    s_add_u32 m0, s54, 4096
    s_add_u32 s59, s59, 10752
    buffer_load_dwordx4 v242, s[20:23], s59 offen lds
    s_add_u32 m0, s54, 5120
    s_add_u32 s59, s59, 10752
    buffer_load_dwordx4 v242, s[20:23], s59 offen lds
    s_add_u32 m0, s43, 150528
    s_add_u32 s58, s58, 458752
    buffer_load_dwordx4 v241, s[16:19], s58 offen lds
    s_add_u32 m0, s54, 6144
    s_add_u32 s59, s59, 10752
    buffer_load_dwordx4 v242, s[20:23], s59 offen lds
    s_add_u32 m0, s54, 7168
    s_add_u32 s59, s59, 10752
    buffer_load_dwordx4 v242, s[20:23], s59 offen lds
    v_cvt_pk_bf16_f32 v156, v12, -v13
    v_cvt_pk_bf16_f32 v164, v13, v12
    v_fmamk_f32 v12, v7, 0x3f800000, v8
    v_sin_f32 v13, v12
    v_cos_f32 v12, v12
    s_nop 0
    v_cvt_pk_bf16_f32 v141, v12, -v13
    v_cvt_pk_bf16_f32 v149, v13, v12
    v_cvt_pk_bf16_f32 v157, -v12, v13
    v_cvt_pk_bf16_f32 v165, -v13, -v12
    v_fmamk_f32 v12, v7, 0x40000000, v8
    v_sin_f32 v13, v12
    v_cos_f32 v12, v12
    s_nop 0
    v_cvt_pk_bf16_f32 v142, v12, -v13
    v_cvt_pk_bf16_f32 v150, v13, v12
    v_cvt_pk_bf16_f32 v158, v12, -v13
    v_cvt_pk_bf16_f32 v166, v13, v12
    v_fmamk_f32 v12, v7, 0x40400000, v8
    v_sin_f32 v13, v12
    v_cos_f32 v12, v12
    s_nop 0
    v_cvt_pk_bf16_f32 v143, v12, -v13
    v_cvt_pk_bf16_f32 v151, v13, v12
    v_cvt_pk_bf16_f32 v159, -v12, v13
    v_cvt_pk_bf16_f32 v167, -v13, -v12
    v_xor_b32 v144, v16, v140
    v_xor_b32 v145, v16, v141
    v_xor_b32 v146, v16, v142
    v_xor_b32 v147, v16, v143
    v_xor_b32 v152, v16, v148
    v_xor_b32 v153, v16, v149
    v_xor_b32 v154, v16, v150
    v_xor_b32 v155, v16, v151
    v_xor_b32 v160, v16, v156
    v_xor_b32 v161, v16, v157
    v_xor_b32 v162, v16, v158
    v_xor_b32 v163, v16, v159
    v_xor_b32 v168, v16, v164
    v_xor_b32 v169, v16, v165
    v_xor_b32 v170, v16, v166
    s_waitcnt vmcnt(12)
    s_barrier
    v_xor_b32 v171, v16, v167
    v_mul_f32 v5, 0x3a000000, v5
    v_mul_f32 v7, v9, v5
    v_fmamk_f32 v8, v5, 0x0, v7
    v_cos_f32 v188, v8
    v_sin_f32 v189, v8
    v_fmamk_f32 v8, v5, 0x3f800000, v7
    v_cos_f32 v190, v8
    v_sin_f32 v191, v8
    v_fmamk_f32 v8, v5, 0x40000000, v7
    v_cos_f32 v192, v8
    v_sin_f32 v193, v8
    v_fmamk_f32 v8, v5, 0x40400000, v7
    v_cos_f32 v194, v8
    v_sin_f32 v195, v8
    v_fmamk_f32 v8, v5, 0x41800000, v7
    v_cos_f32 v196, v8
    v_sin_f32 v197, v8
    v_fmamk_f32 v8, v5, 0x41880000, v7
    v_cos_f32 v198, v8
    v_sin_f32 v199, v8
    v_fmamk_f32 v8, v5, 0x41900000, v7
    v_cos_f32 v200, v8
    v_sin_f32 v201, v8
    v_fmamk_f32 v8, v5, 0x41980000, v7
    v_cos_f32 v202, v8
    v_sin_f32 v203, v8
    s_lshl_b32 s44, s36, 11
    s_add_u32 s44, s44, 57344
    v_add_u32 v205, s44, v2
    v_lshlrev_b32 v206, 4, v4
    v_lshl_add_u32 v206, v6, 9, v206
    v_add_u32 v206, 57344, v206
    v_mul_u32_u24 v204, 28672, v4
    v_and_b32 v7, 1, v6
    v_lshl_add_u32 v204, v7, 5, v204
    v_lshrrev_b32 v7, 1, v6
    v_lshl_add_u32 v204, v7, 4, v204
    v_lshlrev_b32 v207, 9, v1
    s_waitcnt vmcnt(0)
    s_barrier
    s_barrier
    s_sleep 28
K1_LDE:
    s_mov_b32 s24, s12
    s_and_b32 s25, s13, 0xffff
    s_mov_b32 s26, 20971520
    s_mov_b32 s27, 0x20000
    s_mov_b32 s32, s14
    s_and_b32 s33, s15, 0xffff
    s_mov_b32 s34, 256
    s_mov_b32 s35, 0x20000
    v_mov_b32 v10, 0
    buffer_load_dwordx2 v[8:9], v10, s[32:35], 0 offen sc1
    s_cmp_eq_u32 s36, 1
    s_cbranch_scc1 K1_HLP
    s_bfe_u32 s44, s2, 0x20001
    s_and_b32 s45, s2, 1
    s_lshl_b32 s45, s45, 1
    v_and_b32 v209, 1, v1
    v_bfe_u32 v208, v1, 1, 4
    v_lshl_add_u32 v208, v208, 2, v209
    v_lshrrev_b32 v7, 5, v1
    v_lshl_add_u32 v208, v7, 8, v208
    v_lshlrev_b32 v208, 7, v208
    v_bfe_u32 v7, v1, 1, 1
    v_lshl_add_u32 v209, v7, 2, v209
    v_lshlrev_b32 v209, 7, v209
    s_lshl_b32 s50, s44, 6
    s_add_u32 s50, s50, s45
    s_lshl_b32 s50, s50, 7
    s_add_u32 s50, s50, 15728640
    s_lshl_b32 s51, s44, 4
    s_lshr_b32 s44, s2, 4
    s_add_u32 s51, s51, s44
    s_lshl_b32 s51, s51, 3
    s_add_u32 s51, s51, s45
    s_lshl_b32 s51, s51, 7
    s_add_u32 s51, s51, 15859712
    s_mov_b32 s61, 200000
EP1:
    s_waitcnt vmcnt(0)
    v_readfirstlane_b32 s63, v9
    v_readfirstlane_b32 s62, v8
    s_sub_u32 s61, s61, 1
    s_cbranch_scc1 EP1_X
    s_cmp_lg_u32 s63, 0
    s_cbranch_scc1 EP1_X
    buffer_load_dwordx2 v[8:9], v10, s[32:35], 0 offen sc1
    s_branch EP1
EP1_X:
    s_mov_b32 s61, 200000
POLL2:
    buffer_load_dwordx2 v[60:61], v208, s[24:27], s50 offen offset:0 sc1
    buffer_load_dwordx2 v[62:63], v209, s[24:27], s51 offen offset:0 sc1
    s_waitcnt vmcnt(0)
    v_xor_b32 v60, s62, v60
    v_xor_b32 v61, s63, v61
    v_xor_b32 v62, s62, v62
    v_xor_b32 v63, s63, v63
    v_or_b32 v60, v60, v61
    v_or_b32 v60, v60, v62
    v_or_b32 v60, v60, v63
    v_cmp_ne_u32 vcc, 0, v60
    s_sub_u32 s61, s61, 1
    s_cbranch_scc1 POLL2_X
    s_cmp_eq_u64 vcc, 0
    s_cbranch_scc1 POLL2_X
    s_sleep 2
    s_branch POLL2
POLL2_X:
    s_branch K2_FFT
K1_SIDE:
    s_waitcnt lgkmcnt(0)
    s_mov_b32 s24, s12
    s_and_b32 s25, s13, 0xffff
    s_mov_b32 s26, 20971520
    s_mov_b32 s27, 0x20000
    s_cmp_eq_u32 s36, 2
    s_cbranch_scc1 K1_T6
    s_sub_u32 s44, s38, 1
    s_cmp_lt_u32 s44, 2
    s_cbranch_scc1 K1_TG
    s_getpc_b64 s[44:45]
K1_PC:
    s_sub_u32 s44, s44, K1_PC-gated_mix__spectral_gfnet__softmax_full_mha__prompt_kernel
    s_subb_u32 s45, s45, 0
    s_mov_b32 s28, s44
    s_and_b32 s29, s45, 0xffff
    s_mov_b32 s30, K_END-gated_mix__spectral_gfnet__softmax_full_mha__prompt_kernel
    s_mov_b32 s31, 0x20000
    s_bfe_u32 s46, s2, 0x20003
    s_lshl_b32 s46, s46, 13
    v_lshl_add_u32 v6, v1, 7, s46
    buffer_load_dword v0, v6, s[28:31], 0 offen
    v_add_u32 v6, 32768, v6
    buffer_load_dword v0, v6, s[28:31], 0 offen
    s_bfe_u32 s44, s2, 0x20001
    s_and_b32 s45, s2, 1
    s_lshl_b32 s45, s45, 1
    v_and_b32 v209, 1, v1
    v_bfe_u32 v208, v1, 1, 4
    v_lshl_add_u32 v208, v208, 2, v209
    v_lshrrev_b32 v7, 5, v1
    v_lshl_add_u32 v208, v7, 8, v208
    v_lshlrev_b32 v208, 7, v208
    v_bfe_u32 v7, v1, 1, 1
    v_lshl_add_u32 v209, v7, 2, v209
    v_lshlrev_b32 v209, 7, v209
    s_lshl_b32 s50, s44, 6
    s_add_u32 s50, s50, s45
    s_lshl_b32 s50, s50, 7
    s_add_u32 s50, s50, 15728640
    s_lshl_b32 s51, s44, 4
    s_lshr_b32 s44, s2, 4
    s_add_u32 s51, s51, s44
    s_lshl_b32 s51, s51, 3
    s_add_u32 s51, s51, s45
    s_lshl_b32 s51, s51, 7
    s_add_u32 s51, s51, 15859712
    buffer_load_dword v0, v208, s[24:27], s50 offen sc1
    buffer_load_dword v0, v209, s[24:27], s51 offen sc1
    s_cmp_lg_u32 s2, 0
    s_cbranch_scc1 K1_TG
    s_mov_b32 s32, s14
    s_and_b32 s33, s15, 0xffff
    s_mov_b32 s34, 256
    s_mov_b32 s35, 0x20000
    v_mov_b32 v5, 2146435072
    v_cmp_eq_u32 vcc, 0, v1
    s_memrealtime s[62:63]
    s_waitcnt lgkmcnt(0)
    v_cndmask_b32 v6, v5, 0, vcc
    s_or_b32 s63, s63, 0x80000000
    v_mov_b32 v8, s62
    v_mov_b32 v9, s63
    buffer_store_dwordx2 v[8:9], v6, s[32:35], 0 offen sc1
    s_branch K1_TG
K1_T6:
K1_TG:
    v_and_b32 v4, 15, v1
    v_lshrrev_b32 v6, 4, v1
    s_lshl_b32 s44, s36, 4
    v_add_u32 v5, s44, v4
    v_cvt_f32_u32 v5, v5
    v_and_b32 v16, 1, v1
    v_mul_u32_u24 v16, 0x8000, v16
    v_lshl_or_b32 v16, v16, 16, v16
    v_mul_f32 v7, 0x3c800000, v5
    v_lshrrev_b32 v8, 5, v1
    v_lshlrev_b32 v8, 2, v8
    v_cvt_f32_u32 v8, v8
    v_and_b32 v9, 1, v6
    v_cvt_f32_u32 v9, v9
    v_mul_f32 v9, 0x3e800000, v9
    v_fma_f32 v8, v8, v7, v9
    v_fmamk_f32 v12, v7, 0x0, v8
    v_fmamk_f32 v14, v7, 0x3f800000, v8
    v_sin_f32 v13, v12
    v_cos_f32 v12, v12
    v_sin_f32 v15, v14
    v_cos_f32 v14, v14
    v_cvt_pk_bf16_f32 v76, v12, v13
    v_cvt_pk_bf16_f32 v77, v14, v15
    v_fmamk_f32 v12, v7, 0x40000000, v8
    v_fmamk_f32 v14, v7, 0x40400000, v8
    v_sin_f32 v13, v12
    v_cos_f32 v12, v12
    v_sin_f32 v15, v14
    v_cos_f32 v14, v14
    v_cvt_pk_bf16_f32 v78, v12, v13
    v_cvt_pk_bf16_f32 v79, v14, v15
    v_fmamk_f32 v12, v7, 0x41000000, v8
    v_fmamk_f32 v14, v7, 0x41100000, v8
    v_sin_f32 v13, v12
    v_cos_f32 v12, v12
    v_sin_f32 v15, v14
    v_cos_f32 v14, v14
    v_cvt_pk_bf16_f32 v80, v12, v13
    v_cvt_pk_bf16_f32 v81, v14, v15
    v_fmamk_f32 v12, v7, 0x41200000, v8
    v_fmamk_f32 v14, v7, 0x41300000, v8
    v_sin_f32 v13, v12
    v_cos_f32 v12, v12
    v_sin_f32 v15, v14
    v_cos_f32 v14, v14
    v_cvt_pk_bf16_f32 v82, v12, v13
    v_cvt_pk_bf16_f32 v83, v14, v15
    v_fmamk_f32 v12, v7, 0x41800000, v8
    v_fmamk_f32 v14, v7, 0x41880000, v8
    v_sin_f32 v13, v12
    v_cos_f32 v12, v12
    v_sin_f32 v15, v14
    v_cos_f32 v14, v14
    v_cvt_pk_bf16_f32 v84, v12, v13
    v_cvt_pk_bf16_f32 v85, v14, v15
    v_fmamk_f32 v12, v7, 0x41900000, v8
    v_fmamk_f32 v14, v7, 0x41980000, v8
    v_sin_f32 v13, v12
    v_cos_f32 v12, v12
    v_sin_f32 v15, v14
    v_cos_f32 v14, v14
    v_cvt_pk_bf16_f32 v86, v12, v13
    v_cvt_pk_bf16_f32 v87, v14, v15
    v_fmamk_f32 v12, v7, 0x41c00000, v8
    v_fmamk_f32 v14, v7, 0x41c80000, v8
    v_sin_f32 v13, v12
    v_cos_f32 v12, v12
    v_sin_f32 v15, v14
    v_cos_f32 v14, v14
    v_cvt_pk_bf16_f32 v88, v12, v13
    v_cvt_pk_bf16_f32 v89, v14, v15
    v_fmamk_f32 v12, v7, 0x41d00000, v8
    v_fmamk_f32 v14, v7, 0x41d80000, v8
    v_sin_f32 v13, v12
    v_cos_f32 v12, v12
    v_sin_f32 v15, v14
    v_cos_f32 v14, v14
    v_cvt_pk_bf16_f32 v90, v12, v13
    v_cvt_pk_bf16_f32 v91, v14, v15
    v_xor_b32 v92, v16, v76
    v_xor_b32 v93, v16, v77
    v_xor_b32 v94, v16, v78
    v_xor_b32 v95, v16, v79
    v_xor_b32 v96, v16, v80
    v_xor_b32 v97, v16, v81
    v_xor_b32 v98, v16, v82
    v_xor_b32 v99, v16, v83
    v_xor_b32 v100, v16, v84
    v_xor_b32 v101, v16, v85
    v_xor_b32 v102, v16, v86
    v_xor_b32 v103, v16, v87
    v_xor_b32 v104, v16, v88
    v_xor_b32 v105, v16, v89
    v_xor_b32 v106, v16, v90
    v_xor_b32 v107, v16, v91
    v_lshlrev_b32 v9, 2, v6
    v_cvt_f32_u32 v9, v9
    v_mul_f32 v8, v9, v7
    v_fmamk_f32 v12, v7, 0x0, v8
    v_fmamk_f32 v14, v7, 0x3f800000, v8
    v_sin_f32 v13, v12
    v_cos_f32 v12, v12
    v_sin_f32 v15, v14
    v_cos_f32 v14, v14
    v_cvt_pk_bf16_f32 v108, v12, -v13
    v_cvt_pk_bf16_f32 v124, v13, v12
    v_cvt_pk_bf16_f32 v109, v14, -v15
    v_cvt_pk_bf16_f32 v125, v15, v14
    v_fmamk_f32 v12, v7, 0x40000000, v8
    v_fmamk_f32 v14, v7, 0x40400000, v8
    v_sin_f32 v13, v12
    v_cos_f32 v12, v12
    v_sin_f32 v15, v14
    v_cos_f32 v14, v14
    v_cvt_pk_bf16_f32 v110, v12, -v13
    v_cvt_pk_bf16_f32 v126, v13, v12
    v_cvt_pk_bf16_f32 v111, v14, -v15
    v_cvt_pk_bf16_f32 v127, v15, v14
    v_fmamk_f32 v12, v7, 0x41800000, v8
    v_fmamk_f32 v14, v7, 0x41880000, v8
    v_sin_f32 v13, v12
    v_cos_f32 v12, v12
    v_sin_f32 v15, v14
    v_cos_f32 v14, v14
    v_cvt_pk_bf16_f32 v112, v12, -v13
    v_cvt_pk_bf16_f32 v128, v13, v12
    v_cvt_pk_bf16_f32 v113, v14, -v15
    v_cvt_pk_bf16_f32 v129, v15, v14
    v_fmamk_f32 v12, v7, 0x41900000, v8
    v_fmamk_f32 v14, v7, 0x41980000, v8
    v_sin_f32 v13, v12
    v_cos_f32 v12, v12
    v_sin_f32 v15, v14
    v_cos_f32 v14, v14
    v_cvt_pk_bf16_f32 v114, v12, -v13
    v_cvt_pk_bf16_f32 v130, v13, v12
    v_cvt_pk_bf16_f32 v115, v14, -v15
    v_cvt_pk_bf16_f32 v131, v15, v14
    v_xor_b32 v116, v16, v108
    v_xor_b32 v117, v16, v109
    v_xor_b32 v118, v16, v110
    v_xor_b32 v119, v16, v111
    v_xor_b32 v120, v16, v112
    v_xor_b32 v121, v16, v113
    v_xor_b32 v122, v16, v114
    v_xor_b32 v123, v16, v115
    v_xor_b32 v132, v16, v124
    v_xor_b32 v133, v16, v125
    v_xor_b32 v134, v16, v126
    v_xor_b32 v135, v16, v127
    v_xor_b32 v136, v16, v128
    v_xor_b32 v137, v16, v129
    v_xor_b32 v138, v16, v130
    v_xor_b32 v139, v16, v131
    v_cvt_f32_u32 v7, v4
    v_mul_f32 v7, 0x3d000000, v7
    v_mul_f32 v8, v9, v7
    v_fmamk_f32 v12, v7, 0x0, v8
    v_sin_f32 v13, v12
    v_cos_f32 v12, v12
    s_nop 0
    v_cvt_pk_bf16_f32 v140, v12, -v13
    v_cvt_pk_bf16_f32 v148, v13, v12
    v_cvt_pk_bf16_f32 v156, v12, -v13
    v_cvt_pk_bf16_f32 v164, v13, v12
    v_fmamk_f32 v12, v7, 0x3f800000, v8
    v_sin_f32 v13, v12
    v_cos_f32 v12, v12
    s_nop 0
    v_cvt_pk_bf16_f32 v141, v12, -v13
    v_cvt_pk_bf16_f32 v149, v13, v12
    v_cvt_pk_bf16_f32 v157, -v12, v13
    v_cvt_pk_bf16_f32 v165, -v13, -v12
    v_fmamk_f32 v12, v7, 0x40000000, v8
    v_sin_f32 v13, v12
    v_cos_f32 v12, v12
    s_nop 0
    v_cvt_pk_bf16_f32 v142, v12, -v13
    v_cvt_pk_bf16_f32 v150, v13, v12
    v_cvt_pk_bf16_f32 v158, v12, -v13
    v_cvt_pk_bf16_f32 v166, v13, v12
    v_fmamk_f32 v12, v7, 0x40400000, v8
    v_sin_f32 v13, v12
    v_cos_f32 v12, v12
    s_nop 0
    v_cvt_pk_bf16_f32 v143, v12, -v13
    v_cvt_pk_bf16_f32 v151, v13, v12
    v_cvt_pk_bf16_f32 v159, -v12, v13
    v_cvt_pk_bf16_f32 v167, -v13, -v12
    v_xor_b32 v144, v16, v140
    v_xor_b32 v145, v16, v141
    v_xor_b32 v146, v16, v142
    v_xor_b32 v147, v16, v143
    v_xor_b32 v152, v16, v148
    v_xor_b32 v153, v16, v149
    v_xor_b32 v154, v16, v150
    v_xor_b32 v155, v16, v151
    v_xor_b32 v160, v16, v156
    v_xor_b32 v161, v16, v157
    v_xor_b32 v162, v16, v158
    v_xor_b32 v163, v16, v159
    v_xor_b32 v168, v16, v164
    v_xor_b32 v169, v16, v165
    v_xor_b32 v170, v16, v166
    v_xor_b32 v171, v16, v167
    v_mul_f32 v5, 0x3a000000, v5
    v_mul_f32 v7, v9, v5
    v_fmamk_f32 v8, v5, 0x0, v7
    v_cos_f32 v188, v8
    v_sin_f32 v189, v8
    v_fmamk_f32 v8, v5, 0x3f800000, v7
    v_cos_f32 v190, v8
    v_sin_f32 v191, v8
    v_fmamk_f32 v8, v5, 0x40000000, v7
    v_cos_f32 v192, v8
    v_sin_f32 v193, v8
    v_fmamk_f32 v8, v5, 0x40400000, v7
    v_cos_f32 v194, v8
    v_sin_f32 v195, v8
    v_fmamk_f32 v8, v5, 0x41800000, v7
    v_cos_f32 v196, v8
    v_sin_f32 v197, v8
    v_fmamk_f32 v8, v5, 0x41880000, v7
    v_cos_f32 v198, v8
    v_sin_f32 v199, v8
    v_fmamk_f32 v8, v5, 0x41900000, v7
    v_cos_f32 v200, v8
    v_sin_f32 v201, v8
    v_fmamk_f32 v8, v5, 0x41980000, v7
    v_cos_f32 v202, v8
    v_sin_f32 v203, v8
    s_lshl_b32 s44, s36, 11
    s_add_u32 s44, s44, 57344
    v_add_u32 v205, s44, v2
    v_lshlrev_b32 v206, 4, v4
    v_lshl_add_u32 v206, v6, 9, v206
    v_add_u32 v206, 57344, v206
    v_mul_u32_u24 v204, 28672, v4
    v_and_b32 v7, 1, v6
    v_lshl_add_u32 v204, v7, 5, v204
    v_lshrrev_b32 v7, 1, v6
    v_lshl_add_u32 v204, v7, 4, v204
    v_lshlrev_b32 v207, 9, v1
    s_cmp_ge_u32 s3, 128
    s_cbranch_scc1 K1_SWT
    s_cmp_eq_u32 s36, 2
    s_cbranch_scc1 K1_GATE
    s_barrier
    s_barrier
    s_barrier
    s_barrier
    s_barrier
    s_barrier
    s_barrier
    s_barrier
    s_barrier
    s_barrier
    s_barrier
    s_barrier
    s_barrier
    s_barrier
    s_mov_b32 s32, s14
    s_and_b32 s33, s15, 0xffff
    s_mov_b32 s34, 256
    s_mov_b32 s35, 0x20000
    v_mov_b32 v10, 0
    buffer_load_dwordx2 v[8:9], v10, s[32:35], 0 offen sc1
K1_HLP:
    s_mov_b32 s61, 200000
EP3:
    s_waitcnt vmcnt(0)
    v_readfirstlane_b32 s63, v9
    v_readfirstlane_b32 s62, v8
    s_sub_u32 s61, s61, 1
    s_cbranch_scc1 EP3_X
    s_cmp_lg_u32 s63, 0
    s_cbranch_scc1 EP3_X
    buffer_load_dwordx2 v[8:9], v10, s[32:35], 0 offen sc1
    s_branch EP3
EP3_X:
    s_branch K2_FFT
K1_GATE:
    s_mov_b32 s16, s4
    s_and_b32 s17, s5, 0xffff
    s_mov_b32 s18, 1835008
    s_mov_b32 s19, 0x20000
    s_mov_b32 s28, s10
    s_and_b32 s29, s11, 0xffff
    s_mov_b32 s30, 896
    s_mov_b32 s31, 0x20000
    v_cmp_gt_u32 vcc, 56, v1
    v_mov_b32 v5, 2146435072
    s_lshl_b32 s44, s37, 2
    s_add_u32 s44, s44, s38
    v_cndmask_b32 v208, v5, v2, vcc
    buffer_load_dwordx4 v[216:219], v208, s[28:31], 0 offen
    s_lshl_b32 s53, s44, 1
    s_add_u32 s53, s53, s55
    s_lshl_b32 s45, s55, 10
    s_add_u32 s44, s44, s45
    s_mul_i32 s60, s44, 896
    v_mov_b32 v172, 0
    v_mov_b32 v173, 0
    v_mov_b32 v174, 0
    v_mov_b32 v175, 0
    v_mov_b32 v176, 0
    v_mov_b32 v177, 0
    v_mov_b32 v178, 0
    v_mov_b32 v179, 0
    v_mov_b32 v180, 0
    v_mov_b32 v181, 0
    v_mov_b32 v182, 0
    v_mov_b32 v183, 0
    v_mov_b32 v184, 0
    v_mov_b32 v185, 0
    v_mov_b32 v186, 0
    v_mov_b32 v187, 0
    s_barrier
    s_barrier
    s_barrier
    s_barrier
    s_barrier
    s_barrier
    buffer_load_dwordx4 v[12:15], v208, s[16:19], s60 offen
    s_add_u32 s60, s60, 57344
    buffer_load_dwordx4 v[16:19], v208, s[16:19], s60 offen
    s_add_u32 s60, s60, 57344
    buffer_load_dwordx4 v[20:23], v208, s[16:19], s60 offen
    s_add_u32 s60, s60, 57344
    buffer_load_dwordx4 v[24:27], v208, s[16:19], s60 offen
    s_add_u32 s60, s60, 57344
    buffer_load_dwordx4 v[28:31], v208, s[16:19], s60 offen
    s_add_u32 s60, s60, 57344
    buffer_load_dwordx4 v[32:35], v208, s[16:19], s60 offen
    s_add_u32 s60, s60, 57344
    buffer_load_dwordx4 v[36:39], v208, s[16:19], s60 offen
    s_add_u32 s60, s60, 57344
    buffer_load_dwordx4 v[40:43], v208, s[16:19], s60 offen
    s_add_u32 s60, s60, 57344
    s_barrier
    buffer_load_dwordx4 v[44:47], v208, s[16:19], s60 offen
    s_add_u32 s60, s60, 57344
    buffer_load_dwordx4 v[48:51], v208, s[16:19], s60 offen
    s_add_u32 s60, s60, 57344
    buffer_load_dwordx4 v[52:55], v208, s[16:19], s60 offen
    s_add_u32 s60, s60, 57344
    buffer_load_dwordx4 v[56:59], v208, s[16:19], s60 offen
    s_add_u32 s60, s60, 57344
    buffer_load_dwordx4 v[60:63], v208, s[16:19], s60 offen
    s_add_u32 s60, s60, 57344
    buffer_load_dwordx4 v[64:67], v208, s[16:19], s60 offen
    s_add_u32 s60, s60, 57344
    buffer_load_dwordx4 v[68:71], v208, s[16:19], s60 offen
    s_add_u32 s60, s60, 57344
    buffer_load_dwordx4 v[72:75], v208, s[16:19], s60 offen
    s_add_u32 s60, s60, 57344
    s_barrier
    s_barrier
    s_barrier
    s_barrier
    s_barrier
    s_barrier
    s_barrier
    s_mov_b32 s32, s14
    s_and_b32 s33, s15, 0xffff
    s_mov_b32 s34, 256
    s_mov_b32 s35, 0x20000
    v_mov_b32 v10, 0
    buffer_load_dwordx2 v[8:9], v10, s[32:35], 0 offen sc1
    s_mov_b32 s61, 200000
EP4:
    s_waitcnt vmcnt(0)
    v_readfirstlane_b32 s63, v9
    v_readfirstlane_b32 s62, v8
    s_sub_u32 s61, s61, 1
    s_cbranch_scc1 EP4_X
    s_cmp_lg_u32 s63, 0
    s_cbranch_scc1 EP4_X
    buffer_load_dwordx2 v[8:9], v10, s[32:35], 0 offen sc1
    s_branch EP4
EP4_X:
    v_dot2c_f32_bf16 v172, v12, v216
    v_dot2c_f32_bf16 v173, v16, v216
    v_dot2c_f32_bf16 v174, v20, v216
    v_dot2c_f32_bf16 v175, v24, v216
    v_dot2c_f32_bf16 v176, v28, v216
    v_dot2c_f32_bf16 v177, v32, v216
    v_dot2c_f32_bf16 v178, v36, v216
    v_dot2c_f32_bf16 v179, v40, v216
    v_dot2c_f32_bf16 v180, v44, v216
    v_dot2c_f32_bf16 v181, v48, v216
    v_dot2c_f32_bf16 v182, v52, v216
    v_dot2c_f32_bf16 v183, v56, v216
    v_dot2c_f32_bf16 v184, v60, v216
    v_dot2c_f32_bf16 v185, v64, v216
    v_dot2c_f32_bf16 v186, v68, v216
    v_dot2c_f32_bf16 v187, v72, v216
    v_dot2c_f32_bf16 v172, v13, v217
    v_dot2c_f32_bf16 v173, v17, v217
    v_dot2c_f32_bf16 v174, v21, v217
    v_dot2c_f32_bf16 v175, v25, v217
    v_dot2c_f32_bf16 v176, v29, v217
    v_dot2c_f32_bf16 v177, v33, v217
    v_dot2c_f32_bf16 v178, v37, v217
    v_dot2c_f32_bf16 v179, v41, v217
    v_dot2c_f32_bf16 v180, v45, v217
    v_dot2c_f32_bf16 v181, v49, v217
    v_dot2c_f32_bf16 v182, v53, v217
    v_dot2c_f32_bf16 v183, v57, v217
    v_dot2c_f32_bf16 v184, v61, v217
    v_dot2c_f32_bf16 v185, v65, v217
    v_dot2c_f32_bf16 v186, v69, v217
    v_dot2c_f32_bf16 v187, v73, v217
    v_dot2c_f32_bf16 v172, v14, v218
    v_dot2c_f32_bf16 v173, v18, v218
    v_dot2c_f32_bf16 v174, v22, v218
    v_dot2c_f32_bf16 v175, v26, v218
    v_dot2c_f32_bf16 v176, v30, v218
    v_dot2c_f32_bf16 v177, v34, v218
    v_dot2c_f32_bf16 v178, v38, v218
    v_dot2c_f32_bf16 v179, v42, v218
    v_dot2c_f32_bf16 v180, v46, v218
    v_dot2c_f32_bf16 v181, v50, v218
    v_dot2c_f32_bf16 v182, v54, v218
    v_dot2c_f32_bf16 v183, v58, v218
    v_dot2c_f32_bf16 v184, v62, v218
    v_dot2c_f32_bf16 v185, v66, v218
    v_dot2c_f32_bf16 v186, v70, v218
    v_dot2c_f32_bf16 v187, v74, v218
    v_dot2c_f32_bf16 v172, v15, v219
    v_dot2c_f32_bf16 v173, v19, v219
    v_dot2c_f32_bf16 v174, v23, v219
    v_dot2c_f32_bf16 v175, v27, v219
    v_dot2c_f32_bf16 v176, v31, v219
    v_dot2c_f32_bf16 v177, v35, v219
    v_dot2c_f32_bf16 v178, v39, v219
    v_dot2c_f32_bf16 v179, v43, v219
    v_dot2c_f32_bf16 v180, v47, v219
    v_dot2c_f32_bf16 v181, v51, v219
    v_dot2c_f32_bf16 v182, v55, v219
    v_dot2c_f32_bf16 v183, v59, v219
    v_dot2c_f32_bf16 v184, v63, v219
    v_dot2c_f32_bf16 v185, v67, v219
    v_dot2c_f32_bf16 v186, v71, v219
    v_dot2c_f32_bf16 v187, v75, v219
    v_add_f32_dpp v172, v172, v172 row_shr:1 row_mask:0xf bank_mask:0xf bound_ctrl:0
    v_add_f32_dpp v173, v173, v173 row_shr:1 row_mask:0xf bank_mask:0xf bound_ctrl:0
    v_add_f32_dpp v174, v174, v174 row_shr:1 row_mask:0xf bank_mask:0xf bound_ctrl:0
    v_add_f32_dpp v175, v175, v175 row_shr:1 row_mask:0xf bank_mask:0xf bound_ctrl:0
    v_add_f32_dpp v176, v176, v176 row_shr:1 row_mask:0xf bank_mask:0xf bound_ctrl:0
    v_add_f32_dpp v177, v177, v177 row_shr:1 row_mask:0xf bank_mask:0xf bound_ctrl:0
    v_add_f32_dpp v178, v178, v178 row_shr:1 row_mask:0xf bank_mask:0xf bound_ctrl:0
    v_add_f32_dpp v179, v179, v179 row_shr:1 row_mask:0xf bank_mask:0xf bound_ctrl:0
    v_add_f32_dpp v180, v180, v180 row_shr:1 row_mask:0xf bank_mask:0xf bound_ctrl:0
    v_add_f32_dpp v181, v181, v181 row_shr:1 row_mask:0xf bank_mask:0xf bound_ctrl:0
    v_add_f32_dpp v182, v182, v182 row_shr:1 row_mask:0xf bank_mask:0xf bound_ctrl:0
    v_add_f32_dpp v183, v183, v183 row_shr:1 row_mask:0xf bank_mask:0xf bound_ctrl:0
    v_add_f32_dpp v184, v184, v184 row_shr:1 row_mask:0xf bank_mask:0xf bound_ctrl:0
    v_add_f32_dpp v185, v185, v185 row_shr:1 row_mask:0xf bank_mask:0xf bound_ctrl:0
    v_add_f32_dpp v186, v186, v186 row_shr:1 row_mask:0xf bank_mask:0xf bound_ctrl:0
    v_add_f32_dpp v187, v187, v187 row_shr:1 row_mask:0xf bank_mask:0xf bound_ctrl:0
    v_add_f32_dpp v172, v172, v172 row_shr:2 row_mask:0xf bank_mask:0xf bound_ctrl:0
    v_add_f32_dpp v173, v173, v173 row_shr:2 row_mask:0xf bank_mask:0xf bound_ctrl:0
    v_add_f32_dpp v174, v174, v174 row_shr:2 row_mask:0xf bank_mask:0xf bound_ctrl:0
    v_add_f32_dpp v175, v175, v175 row_shr:2 row_mask:0xf bank_mask:0xf bound_ctrl:0
    v_add_f32_dpp v176, v176, v176 row_shr:2 row_mask:0xf bank_mask:0xf bound_ctrl:0
    v_add_f32_dpp v177, v177, v177 row_shr:2 row_mask:0xf bank_mask:0xf bound_ctrl:0
    v_add_f32_dpp v178, v178, v178 row_shr:2 row_mask:0xf bank_mask:0xf bound_ctrl:0
    v_add_f32_dpp v179, v179, v179 row_shr:2 row_mask:0xf bank_mask:0xf bound_ctrl:0
    v_add_f32_dpp v180, v180, v180 row_shr:2 row_mask:0xf bank_mask:0xf bound_ctrl:0
    v_add_f32_dpp v181, v181, v181 row_shr:2 row_mask:0xf bank_mask:0xf bound_ctrl:0
    v_add_f32_dpp v182, v182, v182 row_shr:2 row_mask:0xf bank_mask:0xf bound_ctrl:0
    v_add_f32_dpp v183, v183, v183 row_shr:2 row_mask:0xf bank_mask:0xf bound_ctrl:0
    v_add_f32_dpp v184, v184, v184 row_shr:2 row_mask:0xf bank_mask:0xf bound_ctrl:0
    v_add_f32_dpp v185, v185, v185 row_shr:2 row_mask:0xf bank_mask:0xf bound_ctrl:0
    v_add_f32_dpp v186, v186, v186 row_shr:2 row_mask:0xf bank_mask:0xf bound_ctrl:0
    v_add_f32_dpp v187, v187, v187 row_shr:2 row_mask:0xf bank_mask:0xf bound_ctrl:0
    v_add_f32_dpp v172, v172, v172 row_shr:4 row_mask:0xf bank_mask:0xf bound_ctrl:0
    v_add_f32_dpp v173, v173, v173 row_shr:4 row_mask:0xf bank_mask:0xf bound_ctrl:0
    v_add_f32_dpp v174, v174, v174 row_shr:4 row_mask:0xf bank_mask:0xf bound_ctrl:0
    v_add_f32_dpp v175, v175, v175 row_shr:4 row_mask:0xf bank_mask:0xf bound_ctrl:0
    v_add_f32_dpp v176, v176, v176 row_shr:4 row_mask:0xf bank_mask:0xf bound_ctrl:0
    v_add_f32_dpp v177, v177, v177 row_shr:4 row_mask:0xf bank_mask:0xf bound_ctrl:0
    v_add_f32_dpp v178, v178, v178 row_shr:4 row_mask:0xf bank_mask:0xf bound_ctrl:0
    v_add_f32_dpp v179, v179, v179 row_shr:4 row_mask:0xf bank_mask:0xf bound_ctrl:0
    v_add_f32_dpp v180, v180, v180 row_shr:4 row_mask:0xf bank_mask:0xf bound_ctrl:0
    v_add_f32_dpp v181, v181, v181 row_shr:4 row_mask:0xf bank_mask:0xf bound_ctrl:0
    v_add_f32_dpp v182, v182, v182 row_shr:4 row_mask:0xf bank_mask:0xf bound_ctrl:0
    v_add_f32_dpp v183, v183, v183 row_shr:4 row_mask:0xf bank_mask:0xf bound_ctrl:0
    v_add_f32_dpp v184, v184, v184 row_shr:4 row_mask:0xf bank_mask:0xf bound_ctrl:0
    v_add_f32_dpp v185, v185, v185 row_shr:4 row_mask:0xf bank_mask:0xf bound_ctrl:0
    v_add_f32_dpp v186, v186, v186 row_shr:4 row_mask:0xf bank_mask:0xf bound_ctrl:0
    v_add_f32_dpp v187, v187, v187 row_shr:4 row_mask:0xf bank_mask:0xf bound_ctrl:0
    v_add_f32_dpp v172, v172, v172 row_shr:8 row_mask:0xf bank_mask:0xf bound_ctrl:0
    v_add_f32_dpp v173, v173, v173 row_shr:8 row_mask:0xf bank_mask:0xf bound_ctrl:0
    v_add_f32_dpp v174, v174, v174 row_shr:8 row_mask:0xf bank_mask:0xf bound_ctrl:0
    v_add_f32_dpp v175, v175, v175 row_shr:8 row_mask:0xf bank_mask:0xf bound_ctrl:0
    v_add_f32_dpp v176, v176, v176 row_shr:8 row_mask:0xf bank_mask:0xf bound_ctrl:0
    v_add_f32_dpp v177, v177, v177 row_shr:8 row_mask:0xf bank_mask:0xf bound_ctrl:0
    v_add_f32_dpp v178, v178, v178 row_shr:8 row_mask:0xf bank_mask:0xf bound_ctrl:0
    v_add_f32_dpp v179, v179, v179 row_shr:8 row_mask:0xf bank_mask:0xf bound_ctrl:0
    v_add_f32_dpp v180, v180, v180 row_shr:8 row_mask:0xf bank_mask:0xf bound_ctrl:0
    v_add_f32_dpp v181, v181, v181 row_shr:8 row_mask:0xf bank_mask:0xf bound_ctrl:0
    v_add_f32_dpp v182, v182, v182 row_shr:8 row_mask:0xf bank_mask:0xf bound_ctrl:0
    v_add_f32_dpp v183, v183, v183 row_shr:8 row_mask:0xf bank_mask:0xf bound_ctrl:0
    v_add_f32_dpp v184, v184, v184 row_shr:8 row_mask:0xf bank_mask:0xf bound_ctrl:0
    v_add_f32_dpp v185, v185, v185 row_shr:8 row_mask:0xf bank_mask:0xf bound_ctrl:0
    v_add_f32_dpp v186, v186, v186 row_shr:8 row_mask:0xf bank_mask:0xf bound_ctrl:0
    v_add_f32_dpp v187, v187, v187 row_shr:8 row_mask:0xf bank_mask:0xf bound_ctrl:0
    v_add_f32_dpp v172, v172, v172 row_bcast:15 row_mask:0xa bank_mask:0xf
    v_add_f32_dpp v173, v173, v173 row_bcast:15 row_mask:0xa bank_mask:0xf
    v_add_f32_dpp v174, v174, v174 row_bcast:15 row_mask:0xa bank_mask:0xf
    v_add_f32_dpp v175, v175, v175 row_bcast:15 row_mask:0xa bank_mask:0xf
    v_add_f32_dpp v176, v176, v176 row_bcast:15 row_mask:0xa bank_mask:0xf
    v_add_f32_dpp v177, v177, v177 row_bcast:15 row_mask:0xa bank_mask:0xf
    v_add_f32_dpp v178, v178, v178 row_bcast:15 row_mask:0xa bank_mask:0xf
    v_add_f32_dpp v179, v179, v179 row_bcast:15 row_mask:0xa bank_mask:0xf
    v_add_f32_dpp v180, v180, v180 row_bcast:15 row_mask:0xa bank_mask:0xf
    v_add_f32_dpp v181, v181, v181 row_bcast:15 row_mask:0xa bank_mask:0xf
    v_add_f32_dpp v182, v182, v182 row_bcast:15 row_mask:0xa bank_mask:0xf
    v_add_f32_dpp v183, v183, v183 row_bcast:15 row_mask:0xa bank_mask:0xf
    v_add_f32_dpp v184, v184, v184 row_bcast:15 row_mask:0xa bank_mask:0xf
    v_add_f32_dpp v185, v185, v185 row_bcast:15 row_mask:0xa bank_mask:0xf
    v_add_f32_dpp v186, v186, v186 row_bcast:15 row_mask:0xa bank_mask:0xf
    v_add_f32_dpp v187, v187, v187 row_bcast:15 row_mask:0xa bank_mask:0xf
    v_add_f32_dpp v172, v172, v172 row_bcast:31 row_mask:0xc bank_mask:0xf
    v_add_f32_dpp v173, v173, v173 row_bcast:31 row_mask:0xc bank_mask:0xf
    v_add_f32_dpp v174, v174, v174 row_bcast:31 row_mask:0xc bank_mask:0xf
    v_add_f32_dpp v175, v175, v175 row_bcast:31 row_mask:0xc bank_mask:0xf
    v_add_f32_dpp v176, v176, v176 row_bcast:31 row_mask:0xc bank_mask:0xf
    v_add_f32_dpp v177, v177, v177 row_bcast:31 row_mask:0xc bank_mask:0xf
    v_add_f32_dpp v178, v178, v178 row_bcast:31 row_mask:0xc bank_mask:0xf
    v_add_f32_dpp v179, v179, v179 row_bcast:31 row_mask:0xc bank_mask:0xf
    v_add_f32_dpp v180, v180, v180 row_bcast:31 row_mask:0xc bank_mask:0xf
    v_add_f32_dpp v181, v181, v181 row_bcast:31 row_mask:0xc bank_mask:0xf
    v_add_f32_dpp v182, v182, v182 row_bcast:31 row_mask:0xc bank_mask:0xf
    v_add_f32_dpp v183, v183, v183 row_bcast:31 row_mask:0xc bank_mask:0xf
    v_add_f32_dpp v184, v184, v184 row_bcast:31 row_mask:0xc bank_mask:0xf
    v_add_f32_dpp v185, v185, v185 row_bcast:31 row_mask:0xc bank_mask:0xf
    v_add_f32_dpp v186, v186, v186 row_bcast:31 row_mask:0xc bank_mask:0xf
    v_add_f32_dpp v187, v187, v187 row_bcast:31 row_mask:0xc bank_mask:0xf
    v_readlane_b32 s44, v172, 63
    v_readlane_b32 s45, v173, 63
    v_readlane_b32 s46, v174, 63
    v_readlane_b32 s47, v175, 63
    s_nop 0
    v_writelane_b32 v6, s44, 0
    v_writelane_b32 v6, s45, 1
    v_writelane_b32 v6, s46, 2
    v_writelane_b32 v6, s47, 3
    v_readlane_b32 s44, v176, 63
    v_readlane_b32 s45, v177, 63
    v_readlane_b32 s46, v178, 63
    v_readlane_b32 s47, v179, 63
    s_nop 0
    v_writelane_b32 v6, s44, 4
    v_writelane_b32 v6, s45, 5
    v_writelane_b32 v6, s46, 6
    v_writelane_b32 v6, s47, 7
    v_readlane_b32 s44, v180, 63
    v_readlane_b32 s45, v181, 63
    v_readlane_b32 s46, v182, 63
    v_readlane_b32 s47, v183, 63
    s_nop 0
    v_writelane_b32 v6, s44, 8
    v_writelane_b32 v6, s45, 9
    v_writelane_b32 v6, s46, 10
    v_writelane_b32 v6, s47, 11
    v_readlane_b32 s44, v184, 63
    v_readlane_b32 s45, v185, 63
    v_readlane_b32 s46, v186, 63
    v_readlane_b32 s47, v187, 63
    s_nop 0
    v_writelane_b32 v6, s44, 12
    v_writelane_b32 v6, s45, 13
    v_writelane_b32 v6, s46, 14
    v_writelane_b32 v6, s47, 15
    v_cvt_pk_bf16_f32 v6, v6, v6
    v_lshlrev_b32 v6, 16, v6
    v_mul_f32 v6, 0xbfb8aa3b, v6
    v_exp_f32 v6, v6
    v_cmp_gt_u32 vcc, 16, v1
    v_add_f32 v6, 1.0, v6
    v_rcp_f32 v6, v6
    v_lshlrev_b32 v208, 3, v1
    v_cvt_pk_bf16_f32 v6, v6, v6
    v_lshlrev_b32 v6, 16, v6
    v_sub_f32 v7, 1.0, v6
    v_cvt_pk_bf16_f32 v7, v7, v7
    v_lshlrev_b32 v7, 16, v7
    v_mul_f32 v6, 0x36124925, v6
    v_cndmask_b32 v208, v5, v208, vcc
    s_lshl_b32 s60, s53, 7
    s_add_u32 s60, s60, 13631488
    buffer_store_dwordx2 v[6:7], v208, s[24:27], s60 offen sc1
    s_lshl_b32 s52, s53, 7
    s_add_u32 s52, s52, 16023552
    s_barrier
    s_barrier
    s_branch K2_FFS
K1_SWT:
    s_sub_u32 s50, s3, 128
    s_lshl_b32 s50, s50, 1
    s_add_u32 s50, s50, s36
    s_sub_u32 s50, s50, 2
    s_lshl_b32 s51, s36, 13
    s_add_u32 s51, s51, 49152
    s_mov_b32 s28, s96
    s_and_b32 s29, s97, 0xffff
    s_mov_b32 s30, 921604
    s_mov_b32 s31, 0x20000
    s_mov_b32 s32, s98
    s_and_b32 s33, s99, 0xffff
    s_mov_b32 s34, 921604
    s_mov_b32 s35, 0x20000
    v_bfe_u32 v8, v1, 2, 2
    v_and_b32 v9, 3, v1
    s_and_b32 s44, s50, 3
    s_lshl_b32 s44, s44, 6
    v_lshrrev_b32 v6, 3, v1
    v_and_b32 v7, 3, v6
    v_mul_u32_u24 v208, 14400, v7
    v_lshrrev_b32 v7, 2, v6
    v_mul_u32_u24 v7, 450, v7
    v_and_b32 v10, 7, v1
    v_lshlrev_b32 v10, 4, v10
    v_add3_u32 v208, v208, v7, v10
    s_lshr_b32 s60, s50, 4
    s_lshl_b32 s60, s60, 7
    s_bfe_u32 s61, s50, 0x20002
    s_lshl_b32 s61, s61, 3
    s_add_u32 s60, s60, s61
    s_mul_i32 s60, s60, 450
    s_lshl_b32 s45, s44, 1
    v_add_u32 v208, s45, v208
    v_add_u32 v208, s60, v208
    v_lshrrev_b32 v6, 4, v1
    v_lshlrev_b32 v209, 9, v6
    v_and_b32 v7, 1, v8
    v_lshl_add_u32 v209, v7, 12, v209
    v_lshrrev_b32 v7, 1, v8
    v_lshl_add_u32 v209, v7, 7, v209
    v_and_b32 v7, 1, v9
    v_lshl_add_u32 v209, v7, 3, v209
    v_lshrrev_b32 v7, 1, v9
    v_lshl_add_u32 v209, v7, 11, v209
    v_add_u32 v209, s51, v209
    v_and_b32 v7, 7, v1
    v_add_u32 v7, s44, v7
    v_lshlrev_b32 v210, 13, v7
    v_lshl_add_u32 v210, v6, 4, v210
    v_bfe_u32 v7, v1, 3, 1
    v_lshl_add_u32 v210, v7, 6, v210
    s_lshr_b32 s60, s50, 2
    s_lshl_b32 s60, s60, 7
    s_add_u32 s60, s60, 16777216
    s_barrier
    s_barrier
    s_barrier
    s_barrier
    s_barrier
    s_barrier
    s_barrier
    s_barrier
    s_add_u32 m0, s51, 0
    s_nop 0
    buffer_load_dwordx4 v208, s[28:31], 0 offen offset:0 lds
    s_add_u32 m0, s51, 124
    s_nop 0
    buffer_load_dwordx4 v208, s[28:31], 0 offen offset:900 lds
    s_add_u32 m0, s51, 248
    s_nop 0
    buffer_load_dwordx4 v208, s[28:31], 0 offen offset:1800 lds
    s_add_u32 m0, s51, 372
    s_nop 0
    buffer_load_dwordx4 v208, s[28:31], 0 offen offset:2700 lds
    s_add_u32 m0, s51, 4096
    s_nop 0
    buffer_load_dwordx4 v208, s[32:35], 0 offen offset:0 lds
    s_add_u32 m0, s51, 4220
    s_nop 0
    buffer_load_dwordx4 v208, s[32:35], 0 offen offset:900 lds
    s_add_u32 m0, s51, 4344
    s_nop 0
    buffer_load_dwordx4 v208, s[32:35], 0 offen offset:1800 lds
    s_add_u32 m0, s51, 4468
    s_nop 0
    buffer_load_dwordx4 v208, s[32:35], 0 offen offset:2700 lds
    s_mov_b32 s32, s14
    s_and_b32 s33, s15, 0xffff
    s_mov_b32 s34, 256
    s_mov_b32 s35, 0x20000
    v_mov_b32 v242, 0
    buffer_load_dwordx2 v[240:241], v242, s[32:35], 0 offen sc1
    s_mov_b32 s61, 200000
EP5:
    s_waitcnt vmcnt(0)
    v_readfirstlane_b32 s63, v241
    v_readfirstlane_b32 s62, v240
    s_sub_u32 s61, s61, 1
    s_cbranch_scc1 EP5_X
    s_cmp_lg_u32 s63, 0
    s_cbranch_scc1 EP5_X
    buffer_load_dwordx2 v[240:241], v242, s[32:35], 0 offen sc1
    s_branch EP5
EP5_X:
    ds_read_b64_tr_b16 v[12:13], v209 offset:0
    ds_read_b64_tr_b16 v[14:15], v209 offset:256
    ds_read_b64_tr_b16 v[16:17], v209 offset:16
    ds_read_b64_tr_b16 v[18:19], v209 offset:272
    ds_read_b64_tr_b16 v[20:21], v209 offset:32
    ds_read_b64_tr_b16 v[22:23], v209 offset:288
    ds_read_b64_tr_b16 v[24:25], v209 offset:48
    ds_read_b64_tr_b16 v[26:27], v209 offset:304
    ds_read_b64_tr_b16 v[28:29], v209 offset:64
    ds_read_b64_tr_b16 v[30:31], v209 offset:320
    ds_read_b64_tr_b16 v[32:33], v209 offset:80
    ds_read_b64_tr_b16 v[34:35], v209 offset:336
    ds_read_b64_tr_b16 v[36:37], v209 offset:96
    ds_read_b64_tr_b16 v[38:39], v209 offset:352
    ds_read_b64_tr_b16 v[40:41], v209 offset:112
    ds_read_b64_tr_b16 v[42:43], v209 offset:368
    s_cmp_eq_u32 s44, 192
    s_waitcnt lgkmcnt(12)
    buffer_store_dwordx4 v[12:15], v210, s[24:27], s60 offen sc1
    v_add_u32 v210, 65536, v210
    buffer_store_dwordx4 v[16:19], v210, s[24:27], s60 offen sc1
    v_add_u32 v210, 65536, v210
    s_waitcnt lgkmcnt(8)
    buffer_store_dwordx4 v[20:23], v210, s[24:27], s60 offen sc1
    v_add_u32 v210, 65536, v210
    buffer_store_dwordx4 v[24:27], v210, s[24:27], s60 offen sc1
    v_add_u32 v210, 65536, v210
    s_waitcnt lgkmcnt(4)
    buffer_store_dwordx4 v[28:31], v210, s[24:27], s60 offen sc1
    v_add_u32 v210, 65536, v210
    s_cselect_b32 s45, 2146435072, 0
    v_max_u32 v210, s45, v210
    buffer_store_dwordx4 v[32:35], v210, s[24:27], s60 offen sc1
    v_add_u32 v210, 65536, v210
    s_waitcnt lgkmcnt(0)
    buffer_store_dwordx4 v[36:39], v210, s[24:27], s60 offen sc1
    v_add_u32 v210, 65536, v210
    buffer_store_dwordx4 v[40:43], v210, s[24:27], s60 offen sc1
    v_add_u32 v210, 65536, v210
    s_lshl_b32 s52, s50, 7
    s_add_u32 s52, s52, 15990784
    s_barrier
    s_barrier
    s_branch K2_FFS
K1_COMP:
    s_mov_b32 s48, 0
    s_mov_b32 s49, -1
    v_and_b32 v4, 31, v1
    v_lshrrev_b32 v24, 5, v1
    v_bfe_u32 v6, v4, 2, 1
    v_bfe_u32 v7, v4, 3, 1
    v_xor_b32 v6, v6, v7
    v_mul_u32_u24 v6, 12, v6
    s_cmp_ge_u32 s3, 128
    s_cselect_b32 s44, 0, s55
    s_cselect_b32 s45, 0, 16384
    s_add_u32 s45, s45, 98304
    s_mul_i32 s44, s44, 15
    v_and_b32 v6, s44, v6
    v_xor_b32 v4, v4, v6
    v_bfe_u32 v6, v4, 1, 3
    v_xor_b32 v6, v6, v24
    v_lshlrev_b32 v4, 7, v4
    v_lshl_add_u32 v4, v6, 4, v4
    v_add_u32 v4, s45, v4
    s_and_b32 s44, s36, 1
    s_lshl_b32 s44, s44, 12
    v_xor_b32 v20, 0, v4
    v_add_u32 v12, s44, v20
    v_xor_b32 v21, 32, v4
    v_add_u32 v13, s44, v21
    v_xor_b32 v22, 64, v4
    v_add_u32 v14, s44, v22
    v_xor_b32 v23, 96, v4
    v_add_u32 v15, s44, v23
    s_lshr_b32 s47, s36, 1
    v_bfe_u32 v4, v1, 2, 2
    v_lshl_add_u32 v5, v24, 3, v4
    v_lshlrev_b32 v5, 8, v5
    v_lshlrev_b32 v4, 6, v4
    v_bfe_u32 v6, v1, 4, 1
    v_lshl_add_u32 v4, v6, 5, v4
    v_and_b32 v6, 3, v1
    v_lshl_add_u32 v4, v6, 3, v4
    s_mul_i32 s44, s47, 112
    v_add_u32 v4, s44, v4
    v_and_b32 v6, 255, v4
    v_add_u32 v16, v5, v6
    v_add_u32 v18, 65536, v16
    v_add_u32 v4, 56, v4
    v_and_b32 v6, 255, v4
    v_add_u32 v17, v5, v6
    v_add_u32 v19, 65536, v17
    s_lshl_b32 s44, s38, 1
    s_add_u32 s44, s44, s47
    s_and_b32 s46, s36, 1
    s_waitcnt lgkmcnt(0)
    s_mov_b32 s24, s12
    s_and_b32 s25, s13, 0xffff
    s_mov_b32 s26, 20971520
    s_mov_b32 s27, 0x20000
    s_cmp_ge_u32 s3, 128
    s_cbranch_scc1 K1_Q
    s_lshl_b32 s53, s44, 19
    s_lshr_b32 s44, s37, 2
    s_lshl_b32 s44, s44, 3
    s_and_b32 s45, s37, 3
    s_add_u32 s44, s44, s45
    s_lshl_b32 s44, s44, 1
    s_add_u32 s44, s44, s46
    s_lshl_b32 s44, s44, 1
    s_add_u32 s44, s44, s55
    s_lshl_b32 s44, s44, 11
    s_add_u32 s53, s53, s44
    s_add_u32 s53, s53, 2097152
    s_mov_b32 s54, 262144
    s_lshl_b32 s44, s55, 2
    s_add_u32 s44, s44, s38
    s_lshl_b32 s44, s44, 4
    s_add_u32 s44, s44, s37
    s_lshl_b32 s44, s44, 2
    s_add_u32 s44, s44, s36
    s_lshl_b32 s40, s44, 7
    s_add_u32 s40, s40, 15728640
    s_cmp_eq_u32 s55, 1
    s_cbranch_scc1 K1_V
    s_barrier
    ds_read_b128 v[128:131], v12 offset:0
    ds_read_b64_tr_b16 v[132:133], v16 offset:0
    ds_read_b64_tr_b16 v[134:135], v16 offset:1024
    ds_read_b64_tr_b16 v[136:137], v17 offset:0
    ds_read_b64_tr_b16 v[138:139], v17 offset:1024
    ds_read_b128 v[140:143], v13 offset:0
    ds_read_b64_tr_b16 v[144:145], v16 offset:4096
    ds_read_b64_tr_b16 v[146:147], v16 offset:5120
    ds_read_b64_tr_b16 v[148:149], v17 offset:4096
    ds_read_b64_tr_b16 v[150:151], v17 offset:5120
    ds_read_b128 v[152:155], v14 offset:0
    ds_read_b64_tr_b16 v[156:157], v16 offset:8192
    ds_read_b64_tr_b16 v[158:159], v16 offset:9216
    ds_read_b64_tr_b16 v[160:161], v17 offset:8192
    ds_read_b64_tr_b16 v[162:163], v17 offset:9216
    s_waitcnt lgkmcnt(10)
    v_mfma_f32_32x32x16_bf16 v[64:79], v[132:135], v[128:131], 0
    ds_read_b128 v[164:167], v15 offset:0
    ds_read_b64_tr_b16 v[168:169], v16 offset:12288
    v_mfma_f32_32x32x16_bf16 v[80:95], v[136:139], v[128:131], 0
    ds_read_b64_tr_b16 v[170:171], v16 offset:13312
    ds_read_b64_tr_b16 v[172:173], v17 offset:12288
    ds_read_b64_tr_b16 v[174:175], v17 offset:13312
    s_waitcnt lgkmcnt(10)
    s_barrier
    v_mfma_f32_32x32x16_bf16 v[64:79], v[144:147], v[140:143], v[64:79]
    ds_read_b128 v[128:131], v12 offset:8192
    ds_read_b64_tr_b16 v[132:133], v16 offset:16384
    v_mfma_f32_32x32x16_bf16 v[80:95], v[148:151], v[140:143], v[80:95]
    ds_read_b64_tr_b16 v[134:135], v16 offset:17408
    ds_read_b64_tr_b16 v[136:137], v17 offset:16384
    ds_read_b64_tr_b16 v[138:139], v17 offset:17408
    s_waitcnt lgkmcnt(10)
    v_mfma_f32_32x32x16_bf16 v[64:79], v[156:159], v[152:155], v[64:79]
    ds_read_b128 v[140:143], v13 offset:8192
    ds_read_b64_tr_b16 v[144:145], v16 offset:20480
    v_mfma_f32_32x32x16_bf16 v[80:95], v[160:163], v[152:155], v[80:95]
    ds_read_b64_tr_b16 v[146:147], v16 offset:21504
    ds_read_b64_tr_b16 v[148:149], v17 offset:20480
    ds_read_b64_tr_b16 v[150:151], v17 offset:21504
    s_waitcnt lgkmcnt(10)
    v_mfma_f32_32x32x16_bf16 v[64:79], v[168:171], v[164:167], v[64:79]
    ds_read_b128 v[152:155], v14 offset:8192
    ds_read_b64_tr_b16 v[156:157], v16 offset:24576
    v_mfma_f32_32x32x16_bf16 v[80:95], v[172:175], v[164:167], v[80:95]
    ds_read_b64_tr_b16 v[158:159], v16 offset:25600
    ds_read_b64_tr_b16 v[160:161], v17 offset:24576
    ds_read_b64_tr_b16 v[162:163], v17 offset:25600
    s_waitcnt lgkmcnt(10)
    v_mfma_f32_32x32x16_bf16 v[64:79], v[132:135], v[128:131], v[64:79]
    ds_read_b128 v[164:167], v15 offset:8192
    ds_read_b64_tr_b16 v[168:169], v16 offset:28672
    v_mfma_f32_32x32x16_bf16 v[80:95], v[136:139], v[128:131], v[80:95]
    ds_read_b64_tr_b16 v[170:171], v16 offset:29696
    ds_read_b64_tr_b16 v[172:173], v17 offset:28672
    ds_read_b64_tr_b16 v[174:175], v17 offset:29696
    s_waitcnt lgkmcnt(10)
    s_barrier
    v_mfma_f32_32x32x16_bf16 v[64:79], v[144:147], v[140:143], v[64:79]
    ds_read_b128 v[128:131], v12 offset:16384
    ds_read_b64_tr_b16 v[132:133], v16 offset:32768
    v_mfma_f32_32x32x16_bf16 v[80:95], v[148:151], v[140:143], v[80:95]
    ds_read_b64_tr_b16 v[134:135], v16 offset:33792
    ds_read_b64_tr_b16 v[136:137], v17 offset:32768
    ds_read_b64_tr_b16 v[138:139], v17 offset:33792
    s_waitcnt lgkmcnt(10)
    v_mfma_f32_32x32x16_bf16 v[64:79], v[156:159], v[152:155], v[64:79]
    ds_read_b128 v[140:143], v13 offset:16384
    ds_read_b64_tr_b16 v[144:145], v16 offset:36864
    v_mfma_f32_32x32x16_bf16 v[80:95], v[160:163], v[152:155], v[80:95]
    ds_read_b64_tr_b16 v[146:147], v16 offset:37888
    ds_read_b64_tr_b16 v[148:149], v17 offset:36864
    ds_read_b64_tr_b16 v[150:151], v17 offset:37888
    s_waitcnt lgkmcnt(10)
    v_mfma_f32_32x32x16_bf16 v[64:79], v[168:171], v[164:167], v[64:79]
    ds_read_b128 v[152:155], v14 offset:16384
    ds_read_b64_tr_b16 v[156:157], v16 offset:40960
    v_mfma_f32_32x32x16_bf16 v[80:95], v[172:175], v[164:167], v[80:95]
    ds_read_b64_tr_b16 v[158:159], v16 offset:41984
    ds_read_b64_tr_b16 v[160:161], v17 offset:40960
    ds_read_b64_tr_b16 v[162:163], v17 offset:41984
    s_waitcnt lgkmcnt(10)
    v_mfma_f32_32x32x16_bf16 v[64:79], v[132:135], v[128:131], v[64:79]
    ds_read_b128 v[164:167], v15 offset:16384
    ds_read_b64_tr_b16 v[168:169], v16 offset:45056
    v_mfma_f32_32x32x16_bf16 v[80:95], v[136:139], v[128:131], v[80:95]
    ds_read_b64_tr_b16 v[170:171], v16 offset:46080
    ds_read_b64_tr_b16 v[172:173], v17 offset:45056
    ds_read_b64_tr_b16 v[174:175], v17 offset:46080
    s_waitcnt lgkmcnt(10)
    s_barrier
    v_mfma_f32_32x32x16_bf16 v[64:79], v[144:147], v[140:143], v[64:79]
    ds_read_b128 v[128:131], v12 offset:24576
    ds_read_b64_tr_b16 v[132:133], v16 offset:49152
    v_mfma_f32_32x32x16_bf16 v[80:95], v[148:151], v[140:143], v[80:95]
    ds_read_b64_tr_b16 v[134:135], v16 offset:50176
    ds_read_b64_tr_b16 v[136:137], v17 offset:49152
    ds_read_b64_tr_b16 v[138:139], v17 offset:50176
    s_waitcnt lgkmcnt(10)
    v_mfma_f32_32x32x16_bf16 v[64:79], v[156:159], v[152:155], v[64:79]
    ds_read_b128 v[140:143], v13 offset:24576
    ds_read_b64_tr_b16 v[144:145], v16 offset:53248
    v_mfma_f32_32x32x16_bf16 v[80:95], v[160:163], v[152:155], v[80:95]
    ds_read_b64_tr_b16 v[146:147], v16 offset:54272
    ds_read_b64_tr_b16 v[148:149], v17 offset:53248
    ds_read_b64_tr_b16 v[150:151], v17 offset:54272
    s_waitcnt lgkmcnt(10)
    v_mfma_f32_32x32x16_bf16 v[64:79], v[168:171], v[164:167], v[64:79]
    ds_read_b128 v[152:155], v14 offset:24576
    ds_read_b64_tr_b16 v[156:157], v16 offset:57344
    v_mfma_f32_32x32x16_bf16 v[80:95], v[172:175], v[164:167], v[80:95]
    ds_read_b64_tr_b16 v[158:159], v16 offset:58368
    ds_read_b64_tr_b16 v[160:161], v17 offset:57344
    ds_read_b64_tr_b16 v[162:163], v17 offset:58368
    s_waitcnt lgkmcnt(10)
    v_mfma_f32_32x32x16_bf16 v[64:79], v[132:135], v[128:131], v[64:79]
    ds_read_b128 v[164:167], v15 offset:24576
    ds_read_b64_tr_b16 v[168:169], v16 offset:61440
    v_mfma_f32_32x32x16_bf16 v[80:95], v[136:139], v[128:131], v[80:95]
    ds_read_b64_tr_b16 v[170:171], v16 offset:62464
    ds_read_b64_tr_b16 v[172:173], v17 offset:61440
    ds_read_b64_tr_b16 v[174:175], v17 offset:62464
    s_waitcnt lgkmcnt(10)
    s_barrier
    v_mfma_f32_32x32x16_bf16 v[64:79], v[144:147], v[140:143], v[64:79]
    ds_read_b128 v[128:131], v12 offset:32768
    ds_read_b64_tr_b16 v[132:133], v18 offset:0
    v_mfma_f32_32x32x16_bf16 v[80:95], v[148:151], v[140:143], v[80:95]
    ds_read_b64_tr_b16 v[134:135], v18 offset:1024
    ds_read_b64_tr_b16 v[136:137], v19 offset:0
    ds_read_b64_tr_b16 v[138:139], v19 offset:1024
    s_waitcnt lgkmcnt(10)
    v_mfma_f32_32x32x16_bf16 v[64:79], v[156:159], v[152:155], v[64:79]
    ds_read_b128 v[140:143], v13 offset:32768
    ds_read_b64_tr_b16 v[144:145], v18 offset:4096
    v_mfma_f32_32x32x16_bf16 v[80:95], v[160:163], v[152:155], v[80:95]
    ds_read_b64_tr_b16 v[146:147], v18 offset:5120
    ds_read_b64_tr_b16 v[148:149], v19 offset:4096
    ds_read_b64_tr_b16 v[150:151], v19 offset:5120
    s_waitcnt lgkmcnt(10)
    v_mfma_f32_32x32x16_bf16 v[64:79], v[168:171], v[164:167], v[64:79]
    ds_read_b128 v[152:155], v14 offset:32768
    ds_read_b64_tr_b16 v[156:157], v18 offset:8192
    v_mfma_f32_32x32x16_bf16 v[80:95], v[172:175], v[164:167], v[80:95]
    ds_read_b64_tr_b16 v[158:159], v18 offset:9216
    ds_read_b64_tr_b16 v[160:161], v19 offset:8192
    ds_read_b64_tr_b16 v[162:163], v19 offset:9216
    s_waitcnt lgkmcnt(10)
    v_mfma_f32_32x32x16_bf16 v[64:79], v[132:135], v[128:131], v[64:79]
    ds_read_b128 v[164:167], v15 offset:32768
    ds_read_b64_tr_b16 v[168:169], v18 offset:12288
    v_mfma_f32_32x32x16_bf16 v[80:95], v[136:139], v[128:131], v[80:95]
    ds_read_b64_tr_b16 v[170:171], v18 offset:13312
    ds_read_b64_tr_b16 v[172:173], v19 offset:12288
    ds_read_b64_tr_b16 v[174:175], v19 offset:13312
    s_waitcnt lgkmcnt(10)
    s_barrier
    v_mfma_f32_32x32x16_bf16 v[64:79], v[144:147], v[140:143], v[64:79]
    ds_read_b128 v[128:131], v12 offset:40960
    ds_read_b64_tr_b16 v[132:133], v18 offset:16384
    v_mfma_f32_32x32x16_bf16 v[80:95], v[148:151], v[140:143], v[80:95]
    ds_read_b64_tr_b16 v[134:135], v18 offset:17408
    ds_read_b64_tr_b16 v[136:137], v19 offset:16384
    ds_read_b64_tr_b16 v[138:139], v19 offset:17408
    s_waitcnt lgkmcnt(10)
    v_mfma_f32_32x32x16_bf16 v[64:79], v[156:159], v[152:155], v[64:79]
    ds_read_b128 v[140:143], v13 offset:40960
    ds_read_b64_tr_b16 v[144:145], v18 offset:20480
    v_mfma_f32_32x32x16_bf16 v[80:95], v[160:163], v[152:155], v[80:95]
    ds_read_b64_tr_b16 v[146:147], v18 offset:21504
    ds_read_b64_tr_b16 v[148:149], v19 offset:20480
    ds_read_b64_tr_b16 v[150:151], v19 offset:21504
    s_waitcnt lgkmcnt(10)
    v_mfma_f32_32x32x16_bf16 v[64:79], v[168:171], v[164:167], v[64:79]
    ds_read_b128 v[152:155], v14 offset:40960
    ds_read_b64_tr_b16 v[156:157], v18 offset:24576
    v_mfma_f32_32x32x16_bf16 v[80:95], v[172:175], v[164:167], v[80:95]
    ds_read_b64_tr_b16 v[158:159], v18 offset:25600
    ds_read_b64_tr_b16 v[160:161], v19 offset:24576
    ds_read_b64_tr_b16 v[162:163], v19 offset:25600
    s_waitcnt lgkmcnt(10)
    v_mfma_f32_32x32x16_bf16 v[64:79], v[132:135], v[128:131], v[64:79]
    ds_read_b128 v[164:167], v15 offset:40960
    ds_read_b64_tr_b16 v[168:169], v18 offset:28672
    v_mfma_f32_32x32x16_bf16 v[80:95], v[136:139], v[128:131], v[80:95]
    ds_read_b64_tr_b16 v[170:171], v18 offset:29696
    ds_read_b64_tr_b16 v[172:173], v19 offset:28672
    ds_read_b64_tr_b16 v[174:175], v19 offset:29696
    s_waitcnt lgkmcnt(10)
    s_barrier
    v_mfma_f32_32x32x16_bf16 v[64:79], v[144:147], v[140:143], v[64:79]
    ds_read_b128 v[128:131], v12 offset:0
    ds_read_b64_tr_b16 v[132:133], v18 offset:32768
    v_mfma_f32_32x32x16_bf16 v[80:95], v[148:151], v[140:143], v[80:95]
    ds_read_b64_tr_b16 v[134:135], v18 offset:33792
    ds_read_b64_tr_b16 v[136:137], v19 offset:32768
    ds_read_b64_tr_b16 v[138:139], v19 offset:33792
    s_waitcnt lgkmcnt(10)
    v_mfma_f32_32x32x16_bf16 v[64:79], v[156:159], v[152:155], v[64:79]
    ds_read_b128 v[140:143], v13 offset:0
    ds_read_b64_tr_b16 v[144:145], v18 offset:36864
    v_mfma_f32_32x32x16_bf16 v[80:95], v[160:163], v[152:155], v[80:95]
    ds_read_b64_tr_b16 v[146:147], v18 offset:37888
    ds_read_b64_tr_b16 v[148:149], v19 offset:36864
    ds_read_b64_tr_b16 v[150:151], v19 offset:37888
    s_waitcnt lgkmcnt(10)
    v_mfma_f32_32x32x16_bf16 v[64:79], v[168:171], v[164:167], v[64:79]
    ds_read_b128 v[152:155], v14 offset:0
    ds_read_b64_tr_b16 v[156:157], v18 offset:40960
    v_mfma_f32_32x32x16_bf16 v[80:95], v[172:175], v[164:167], v[80:95]
    ds_read_b64_tr_b16 v[158:159], v18 offset:41984
    ds_read_b64_tr_b16 v[160:161], v19 offset:40960
    ds_read_b64_tr_b16 v[162:163], v19 offset:41984
    s_waitcnt lgkmcnt(10)
    v_mfma_f32_32x32x16_bf16 v[64:79], v[132:135], v[128:131], v[64:79]
    ds_read_b128 v[164:167], v15 offset:0
    ds_read_b64_tr_b16 v[168:169], v18 offset:45056
    v_mfma_f32_32x32x16_bf16 v[80:95], v[136:139], v[128:131], v[80:95]
    ds_read_b64_tr_b16 v[170:171], v18 offset:46080
    ds_read_b64_tr_b16 v[172:173], v19 offset:45056
    ds_read_b64_tr_b16 v[174:175], v19 offset:46080
    s_waitcnt lgkmcnt(10)
    s_barrier
    v_mfma_f32_32x32x16_bf16 v[64:79], v[144:147], v[140:143], v[64:79]
    ds_read_b128 v[128:131], v12 offset:8192
    ds_read_b64_tr_b16 v[132:133], v16 offset:0
    v_mfma_f32_32x32x16_bf16 v[80:95], v[148:151], v[140:143], v[80:95]
    ds_read_b64_tr_b16 v[134:135], v16 offset:1024
    ds_read_b64_tr_b16 v[136:137], v17 offset:0
    ds_read_b64_tr_b16 v[138:139], v17 offset:1024
    s_waitcnt lgkmcnt(10)
    v_mfma_f32_32x32x16_bf16 v[64:79], v[156:159], v[152:155], v[64:79]
    ds_read_b128 v[140:143], v13 offset:8192
    ds_read_b64_tr_b16 v[144:145], v16 offset:4096
    v_mfma_f32_32x32x16_bf16 v[80:95], v[160:163], v[152:155], v[80:95]
    ds_read_b64_tr_b16 v[146:147], v16 offset:5120
    ds_read_b64_tr_b16 v[148:149], v17 offset:4096
    ds_read_b64_tr_b16 v[150:151], v17 offset:5120
    s_waitcnt lgkmcnt(10)
    v_mfma_f32_32x32x16_bf16 v[64:79], v[168:171], v[164:167], v[64:79]
    ds_read_b128 v[152:155], v14 offset:8192
    ds_read_b64_tr_b16 v[156:157], v16 offset:8192
    v_mfma_f32_32x32x16_bf16 v[80:95], v[172:175], v[164:167], v[80:95]
    ds_read_b64_tr_b16 v[158:159], v16 offset:9216
    ds_read_b64_tr_b16 v[160:161], v17 offset:8192
    ds_read_b64_tr_b16 v[162:163], v17 offset:9216
    s_waitcnt lgkmcnt(10)
    v_mfma_f32_32x32x16_bf16 v[96:111], v[132:135], v[128:131], 0
    ds_read_b128 v[164:167], v15 offset:8192
    ds_read_b64_tr_b16 v[168:169], v16 offset:12288
    v_mfma_f32_32x32x16_bf16 v[112:127], v[136:139], v[128:131], 0
    ds_read_b64_tr_b16 v[170:171], v16 offset:13312
    ds_read_b64_tr_b16 v[172:173], v17 offset:12288
    ds_read_b64_tr_b16 v[174:175], v17 offset:13312
    s_waitcnt lgkmcnt(10)
    s_barrier
    v_mfma_f32_32x32x16_bf16 v[96:111], v[144:147], v[140:143], v[96:111]
    ds_read_b128 v[128:131], v12 offset:16384
    ds_read_b64_tr_b16 v[132:133], v16 offset:16384
    v_mfma_f32_32x32x16_bf16 v[112:127], v[148:151], v[140:143], v[112:127]
    ds_read_b64_tr_b16 v[134:135], v16 offset:17408
    ds_read_b64_tr_b16 v[136:137], v17 offset:16384
    ds_read_b64_tr_b16 v[138:139], v17 offset:17408
    s_waitcnt lgkmcnt(10)
    v_mfma_f32_32x32x16_bf16 v[96:111], v[156:159], v[152:155], v[96:111]
    ds_read_b128 v[140:143], v13 offset:16384
    ds_read_b64_tr_b16 v[144:145], v16 offset:20480
    ds_read_b64_tr_b16 v[146:147], v16 offset:21504
    ds_read_b64_tr_b16 v[148:149], v17 offset:20480
    ds_read_b64_tr_b16 v[150:151], v17 offset:21504
    v_cvt_pk_bf16_f32 v32, v64, v65
    v_cvt_pk_bf16_f32 v33, v66, v67
    v_cvt_pk_bf16_f32 v34, v68, v69
    v_cvt_pk_bf16_f32 v35, v70, v71
    v_mfma_f32_32x32x16_bf16 v[112:127], v[160:163], v[152:155], v[112:127]
    v_cvt_pk_bf16_f32 v36, v72, v73
    v_cvt_pk_bf16_f32 v37, v74, v75
    v_cvt_pk_bf16_f32 v38, v76, v77
    v_cvt_pk_bf16_f32 v39, v78, v79
    v_cndmask_b32 v38, v38, 0, s[48:49]
    v_cndmask_b32 v39, v39, 0, s[48:49]
    buffer_store_dwordx4 v[32:35], v2, s[24:27], s53 offen sc1
    buffer_store_dwordx4 v[36:39], v2, s[24:27], s53 offen offset:1024 sc1
    v_cvt_pk_bf16_f32 v40, v80, v81
    s_waitcnt lgkmcnt(10)
    v_mfma_f32_32x32x16_bf16 v[96:111], v[168:171], v[164:167], v[96:111]
    ds_read_b128 v[152:155], v14 offset:16384
    ds_read_b64_tr_b16 v[156:157], v16 offset:24576
    ds_read_b64_tr_b16 v[158:159], v16 offset:25600
    ds_read_b64_tr_b16 v[160:161], v17 offset:24576
    ds_read_b64_tr_b16 v[162:163], v17 offset:25600
    v_cvt_pk_bf16_f32 v41, v82, v83
    v_cvt_pk_bf16_f32 v42, v84, v85
    v_cvt_pk_bf16_f32 v43, v86, v87
    v_mfma_f32_32x32x16_bf16 v[112:127], v[172:175], v[164:167], v[112:127]
    v_cvt_pk_bf16_f32 v44, v88, v89
    v_cvt_pk_bf16_f32 v45, v90, v91
    v_cvt_pk_bf16_f32 v46, v92, v93
    v_cvt_pk_bf16_f32 v47, v94, v95
    v_cndmask_b32 v46, v46, 0, s[48:49]
    v_cndmask_b32 v47, v47, 0, s[48:49]
    s_add_u32 s46, s53, s54
    buffer_store_dwordx4 v[40:43], v2, s[24:27], s46 offen sc1
    buffer_store_dwordx4 v[44:47], v2, s[24:27], s46 offen offset:1024 sc1
    s_mov_b32 s32, s14
    s_and_b32 s33, s15, 0xffff
    s_mov_b32 s34, 256
    s_mov_b32 s35, 0x20000
    v_mov_b32 v10, 0
    buffer_load_dwordx2 v[8:9], v10, s[32:35], 0 offen sc1
    s_waitcnt lgkmcnt(10)
    v_mfma_f32_32x32x16_bf16 v[96:111], v[132:135], v[128:131], v[96:111]
    ds_read_b128 v[164:167], v15 offset:16384
    ds_read_b64_tr_b16 v[168:169], v16 offset:28672
    v_mfma_f32_32x32x16_bf16 v[112:127], v[136:139], v[128:131], v[112:127]
    ds_read_b64_tr_b16 v[170:171], v16 offset:29696
    ds_read_b64_tr_b16 v[172:173], v17 offset:28672
    ds_read_b64_tr_b16 v[174:175], v17 offset:29696
    s_waitcnt lgkmcnt(10)
    s_barrier
    v_mfma_f32_32x32x16_bf16 v[96:111], v[144:147], v[140:143], v[96:111]
    ds_read_b128 v[128:131], v12 offset:24576
    ds_read_b64_tr_b16 v[132:133], v16 offset:32768
    v_mfma_f32_32x32x16_bf16 v[112:127], v[148:151], v[140:143], v[112:127]
    ds_read_b64_tr_b16 v[134:135], v16 offset:33792
    ds_read_b64_tr_b16 v[136:137], v17 offset:32768
    ds_read_b64_tr_b16 v[138:139], v17 offset:33792
    s_waitcnt lgkmcnt(10)
    v_mfma_f32_32x32x16_bf16 v[96:111], v[156:159], v[152:155], v[96:111]
    ds_read_b128 v[140:143], v13 offset:24576
    ds_read_b64_tr_b16 v[144:145], v16 offset:36864
    v_mfma_f32_32x32x16_bf16 v[112:127], v[160:163], v[152:155], v[112:127]
    ds_read_b64_tr_b16 v[146:147], v16 offset:37888
    ds_read_b64_tr_b16 v[148:149], v17 offset:36864
    ds_read_b64_tr_b16 v[150:151], v17 offset:37888
    s_waitcnt lgkmcnt(10)
    v_mfma_f32_32x32x16_bf16 v[96:111], v[168:171], v[164:167], v[96:111]
    ds_read_b128 v[152:155], v14 offset:24576
    ds_read_b64_tr_b16 v[156:157], v16 offset:40960
    v_mfma_f32_32x32x16_bf16 v[112:127], v[172:175], v[164:167], v[112:127]
    ds_read_b64_tr_b16 v[158:159], v16 offset:41984
    ds_read_b64_tr_b16 v[160:161], v17 offset:40960
    ds_read_b64_tr_b16 v[162:163], v17 offset:41984
    s_waitcnt lgkmcnt(10)
    v_mfma_f32_32x32x16_bf16 v[96:111], v[132:135], v[128:131], v[96:111]
    ds_read_b128 v[164:167], v15 offset:24576
    ds_read_b64_tr_b16 v[168:169], v16 offset:45056
    v_mfma_f32_32x32x16_bf16 v[112:127], v[136:139], v[128:131], v[112:127]
    ds_read_b64_tr_b16 v[170:171], v16 offset:46080
    ds_read_b64_tr_b16 v[172:173], v17 offset:45056
    ds_read_b64_tr_b16 v[174:175], v17 offset:46080
    s_waitcnt lgkmcnt(10)
    s_barrier
    v_mfma_f32_32x32x16_bf16 v[96:111], v[144:147], v[140:143], v[96:111]
    ds_read_b128 v[128:131], v12 offset:32768
    ds_read_b64_tr_b16 v[132:133], v16 offset:49152
    v_mfma_f32_32x32x16_bf16 v[112:127], v[148:151], v[140:143], v[112:127]
    ds_read_b64_tr_b16 v[134:135], v16 offset:50176
    ds_read_b64_tr_b16 v[136:137], v17 offset:49152
    ds_read_b64_tr_b16 v[138:139], v17 offset:50176
    s_waitcnt lgkmcnt(10)
    v_mfma_f32_32x32x16_bf16 v[96:111], v[156:159], v[152:155], v[96:111]
    ds_read_b128 v[140:143], v13 offset:32768
    ds_read_b64_tr_b16 v[144:145], v16 offset:53248
    v_mfma_f32_32x32x16_bf16 v[112:127], v[160:163], v[152:155], v[112:127]
    ds_read_b64_tr_b16 v[146:147], v16 offset:54272
    ds_read_b64_tr_b16 v[148:149], v17 offset:53248
    ds_read_b64_tr_b16 v[150:151], v17 offset:54272
    s_waitcnt lgkmcnt(10)
    v_mfma_f32_32x32x16_bf16 v[96:111], v[168:171], v[164:167], v[96:111]
    ds_read_b128 v[152:155], v14 offset:32768
    ds_read_b64_tr_b16 v[156:157], v16 offset:57344
    v_mfma_f32_32x32x16_bf16 v[112:127], v[172:175], v[164:167], v[112:127]
    ds_read_b64_tr_b16 v[158:159], v16 offset:58368
    ds_read_b64_tr_b16 v[160:161], v17 offset:57344
    ds_read_b64_tr_b16 v[162:163], v17 offset:58368
    s_mov_b32 s61, 200000
EP6:
    s_waitcnt vmcnt(0)
    v_readfirstlane_b32 s63, v9
    v_readfirstlane_b32 s62, v8
    s_sub_u32 s61, s61, 1
    s_cbranch_scc1 EP6_X
    s_cmp_lg_u32 s63, 0
    s_cbranch_scc1 EP6_X
    buffer_load_dwordx2 v[8:9], v10, s[32:35], 0 offen sc1
    s_branch EP6
EP6_X:
    v_cmp_gt_u32 vcc, 16, v1
    v_lshlrev_b32 v8, 3, v1
    v_mov_b32 v10, 2146435072
    v_cndmask_b32 v10, v10, v8, vcc
    v_mov_b32 v8, s62
    v_mov_b32 v9, s63
    buffer_store_dwordx2 v[8:9], v10, s[24:27], s40 offen sc1
    s_waitcnt lgkmcnt(10)
    v_mfma_f32_32x32x16_bf16 v[96:111], v[132:135], v[128:131], v[96:111]
    ds_read_b128 v[164:167], v15 offset:32768
    ds_read_b64_tr_b16 v[168:169], v16 offset:61440
    v_mfma_f32_32x32x16_bf16 v[112:127], v[136:139], v[128:131], v[112:127]
    ds_read_b64_tr_b16 v[170:171], v16 offset:62464
    ds_read_b64_tr_b16 v[172:173], v17 offset:61440
    ds_read_b64_tr_b16 v[174:175], v17 offset:62464
    s_waitcnt lgkmcnt(10)
    s_barrier
    v_mfma_f32_32x32x16_bf16 v[96:111], v[144:147], v[140:143], v[96:111]
    ds_read_b128 v[128:131], v12 offset:40960
    ds_read_b64_tr_b16 v[132:133], v18 offset:0
    v_mfma_f32_32x32x16_bf16 v[112:127], v[148:151], v[140:143], v[112:127]
    ds_read_b64_tr_b16 v[134:135], v18 offset:1024
    ds_read_b64_tr_b16 v[136:137], v19 offset:0
    ds_read_b64_tr_b16 v[138:139], v19 offset:1024
    s_waitcnt lgkmcnt(10)
    v_mfma_f32_32x32x16_bf16 v[96:111], v[156:159], v[152:155], v[96:111]
    ds_read_b128 v[140:143], v13 offset:40960
    ds_read_b64_tr_b16 v[144:145], v18 offset:4096
    v_mfma_f32_32x32x16_bf16 v[112:127], v[160:163], v[152:155], v[112:127]
    ds_read_b64_tr_b16 v[146:147], v18 offset:5120
    ds_read_b64_tr_b16 v[148:149], v19 offset:4096
    ds_read_b64_tr_b16 v[150:151], v19 offset:5120
    s_waitcnt lgkmcnt(10)
    v_mfma_f32_32x32x16_bf16 v[96:111], v[168:171], v[164:167], v[96:111]
    ds_read_b128 v[152:155], v14 offset:40960
    ds_read_b64_tr_b16 v[156:157], v18 offset:8192
    v_mfma_f32_32x32x16_bf16 v[112:127], v[172:175], v[164:167], v[112:127]
    ds_read_b64_tr_b16 v[158:159], v18 offset:9216
    ds_read_b64_tr_b16 v[160:161], v19 offset:8192
    ds_read_b64_tr_b16 v[162:163], v19 offset:9216
    s_waitcnt lgkmcnt(10)
    v_mfma_f32_32x32x16_bf16 v[96:111], v[132:135], v[128:131], v[96:111]
    ds_read_b128 v[164:167], v15 offset:40960
    ds_read_b64_tr_b16 v[168:169], v18 offset:12288
    v_mfma_f32_32x32x16_bf16 v[112:127], v[136:139], v[128:131], v[112:127]
    ds_read_b64_tr_b16 v[170:171], v18 offset:13312
    ds_read_b64_tr_b16 v[172:173], v19 offset:12288
    ds_read_b64_tr_b16 v[174:175], v19 offset:13312
    s_waitcnt lgkmcnt(10)
    s_barrier
    v_mfma_f32_32x32x16_bf16 v[96:111], v[144:147], v[140:143], v[96:111]
    ds_read_b128 v[128:131], v12 offset:0
    ds_read_b64_tr_b16 v[132:133], v18 offset:16384
    v_mfma_f32_32x32x16_bf16 v[112:127], v[148:151], v[140:143], v[112:127]
    ds_read_b64_tr_b16 v[134:135], v18 offset:17408
    ds_read_b64_tr_b16 v[136:137], v19 offset:16384
    ds_read_b64_tr_b16 v[138:139], v19 offset:17408
    s_waitcnt lgkmcnt(10)
    v_mfma_f32_32x32x16_bf16 v[96:111], v[156:159], v[152:155], v[96:111]
    ds_read_b128 v[140:143], v13 offset:0
    ds_read_b64_tr_b16 v[144:145], v18 offset:20480
    v_mfma_f32_32x32x16_bf16 v[112:127], v[160:163], v[152:155], v[112:127]
    ds_read_b64_tr_b16 v[146:147], v18 offset:21504
    ds_read_b64_tr_b16 v[148:149], v19 offset:20480
    ds_read_b64_tr_b16 v[150:151], v19 offset:21504
    s_waitcnt lgkmcnt(10)
    v_mfma_f32_32x32x16_bf16 v[96:111], v[168:171], v[164:167], v[96:111]
    ds_read_b128 v[152:155], v14 offset:0
    ds_read_b64_tr_b16 v[156:157], v18 offset:24576
    v_mfma_f32_32x32x16_bf16 v[112:127], v[172:175], v[164:167], v[112:127]
    ds_read_b64_tr_b16 v[158:159], v18 offset:25600
    ds_read_b64_tr_b16 v[160:161], v19 offset:24576
    ds_read_b64_tr_b16 v[162:163], v19 offset:25600
    s_waitcnt lgkmcnt(10)
    v_mfma_f32_32x32x16_bf16 v[96:111], v[132:135], v[128:131], v[96:111]
    ds_read_b128 v[164:167], v15 offset:0
    ds_read_b64_tr_b16 v[168:169], v18 offset:28672
    v_mfma_f32_32x32x16_bf16 v[112:127], v[136:139], v[128:131], v[112:127]
    ds_read_b64_tr_b16 v[170:171], v18 offset:29696
    ds_read_b64_tr_b16 v[172:173], v19 offset:28672
    ds_read_b64_tr_b16 v[174:175], v19 offset:29696
    s_waitcnt lgkmcnt(10)
    s_barrier
    v_mfma_f32_32x32x16_bf16 v[96:111], v[144:147], v[140:143], v[96:111]
    ds_read_b128 v[128:131], v12 offset:8192
    ds_read_b64_tr_b16 v[132:133], v18 offset:32768
    v_mfma_f32_32x32x16_bf16 v[112:127], v[148:151], v[140:143], v[112:127]
    ds_read_b64_tr_b16 v[134:135], v18 offset:33792
    ds_read_b64_tr_b16 v[136:137], v19 offset:32768
    ds_read_b64_tr_b16 v[138:139], v19 offset:33792
    s_waitcnt lgkmcnt(10)
    v_mfma_f32_32x32x16_bf16 v[96:111], v[156:159], v[152:155], v[96:111]
    ds_read_b128 v[140:143], v13 offset:8192
    ds_read_b64_tr_b16 v[144:145], v18 offset:36864
    v_mfma_f32_32x32x16_bf16 v[112:127], v[160:163], v[152:155], v[112:127]
    ds_read_b64_tr_b16 v[146:147], v18 offset:37888
    ds_read_b64_tr_b16 v[148:149], v19 offset:36864
    ds_read_b64_tr_b16 v[150:151], v19 offset:37888
    s_waitcnt lgkmcnt(10)
    v_mfma_f32_32x32x16_bf16 v[96:111], v[168:171], v[164:167], v[96:111]
    ds_read_b128 v[152:155], v14 offset:8192
    ds_read_b64_tr_b16 v[156:157], v18 offset:40960
    v_mfma_f32_32x32x16_bf16 v[112:127], v[172:175], v[164:167], v[112:127]
    ds_read_b64_tr_b16 v[158:159], v18 offset:41984
    ds_read_b64_tr_b16 v[160:161], v19 offset:40960
    ds_read_b64_tr_b16 v[162:163], v19 offset:41984
    s_waitcnt lgkmcnt(10)
    v_mfma_f32_32x32x16_bf16 v[96:111], v[132:135], v[128:131], v[96:111]
    ds_read_b128 v[164:167], v15 offset:8192
    ds_read_b64_tr_b16 v[168:169], v18 offset:45056
    v_mfma_f32_32x32x16_bf16 v[112:127], v[136:139], v[128:131], v[112:127]
    ds_read_b64_tr_b16 v[170:171], v18 offset:46080
    ds_read_b64_tr_b16 v[172:173], v19 offset:45056
    ds_read_b64_tr_b16 v[174:175], v19 offset:46080
    s_waitcnt lgkmcnt(10)
    v_mfma_f32_32x32x16_bf16 v[96:111], v[144:147], v[140:143], v[96:111]
    v_mfma_f32_32x32x16_bf16 v[112:127], v[148:151], v[140:143], v[112:127]
    s_waitcnt lgkmcnt(5)
    v_mfma_f32_32x32x16_bf16 v[96:111], v[156:159], v[152:155], v[96:111]
    v_mfma_f32_32x32x16_bf16 v[112:127], v[160:163], v[152:155], v[112:127]
    s_waitcnt lgkmcnt(0)
    v_mfma_f32_32x32x16_bf16 v[96:111], v[168:171], v[164:167], v[96:111]
    v_mfma_f32_32x32x16_bf16 v[112:127], v[172:175], v[164:167], v[112:127]
    s_lshl_b32 s44, s36, 12
    s_add_u32 s44, s44, 81920
    v_add_u32 v20, s44, v2
    s_nop 7
    v_cvt_pk_bf16_f32 v144, v96, v97
    v_cvt_pk_bf16_f32 v145, v98, v99
    v_cvt_pk_bf16_f32 v146, v100, v101
    v_cvt_pk_bf16_f32 v147, v102, v103
    v_cvt_pk_bf16_f32 v148, v104, v105
    v_cvt_pk_bf16_f32 v149, v106, v107
    v_cvt_pk_bf16_f32 v150, v108, v109
    v_cvt_pk_bf16_f32 v151, v110, v111
    v_cndmask_b32 v150, v150, 0, s[48:49]
    v_cndmask_b32 v151, v151, 0, s[48:49]
    v_cvt_pk_bf16_f32 v152, v112, v113
    v_cvt_pk_bf16_f32 v153, v114, v115
    v_cvt_pk_bf16_f32 v154, v116, v117
    v_cvt_pk_bf16_f32 v155, v118, v119
    v_cvt_pk_bf16_f32 v156, v120, v121
    v_cvt_pk_bf16_f32 v157, v122, v123
    v_cvt_pk_bf16_f32 v158, v124, v125
    v_cvt_pk_bf16_f32 v159, v126, v127
    v_cndmask_b32 v158, v158, 0, s[48:49]
    v_cndmask_b32 v159, v159, 0, s[48:49]
    s_and_b32 s31, s2, 7
    s_lshr_b32 s30, s2, 3
    s_and_b32 s44, s30, 1
    s_lshl_b32 s28, s31, 1
    s_add_u32 s28, s28, s44
    s_lshr_b32 s29, s30, 1
    s_lshl_b32 s47, s28, 17
    s_lshl_b32 s44, s29, 13
    s_add_u32 s47, s47, s44
    s_add_u32 s44, s36, 1
    s_and_b32 s44, s44, 3
    s_lshl_b32 s44, s44, 11
    s_add_u32 s32, s44, s47
    s_add_u32 s44, s36, 2
    s_and_b32 s44, s44, 3
    s_lshl_b32 s44, s44, 11
    s_add_u32 s33, s44, s47
    s_add_u32 s44, s36, 3
    s_and_b32 s44, s44, 3
    s_lshl_b32 s44, s44, 11
    s_add_u32 s34, s44, s47
    s_add_u32 s44, s36, 4
    s_and_b32 s44, s44, 3
    s_lshl_b32 s44, s44, 11
    s_add_u32 s35, s44, s47
    s_lshl_b32 s41, s28, 18
    s_lshl_b32 s44, s36, 16
    s_add_u32 s41, s41, s44
    s_add_u32 s41, s41, 2097152
    s_and_b32 s39, s29, 1
    s_lshl_b32 s39, s39, 14
    s_mov_b32 s43, 0
    s_add_u32 s51, s39, s41
    v_add_u32 v26, 4096, v2
    v_add_u32 v27, 8192, v2
    v_add_u32 v28, 12288, v2
    v_mov_b32 v64, 0
    v_mov_b32 v65, 0
    v_mov_b32 v66, 0
    v_mov_b32 v67, 0
    v_mov_b32 v68, 0
    v_mov_b32 v69, 0
    v_mov_b32 v70, 0
    v_mov_b32 v71, 0
    v_mov_b32 v72, 0
    v_mov_b32 v73, 0
    v_mov_b32 v74, 0
    v_mov_b32 v75, 0
    v_mov_b32 v76, 0
    v_mov_b32 v77, 0
    v_mov_b32 v78, 0
    v_mov_b32 v79, 0
    v_mov_b32 v80, 0
    v_mov_b32 v81, 0
    v_mov_b32 v82, 0
    v_mov_b32 v83, 0
    v_mov_b32 v84, 0
    v_mov_b32 v85, 0
    v_mov_b32 v86, 0
    v_mov_b32 v87, 0
    v_mov_b32 v88, 0
    v_mov_b32 v89, 0
    v_mov_b32 v90, 0
    v_mov_b32 v91, 0
    v_mov_b32 v92, 0
    v_mov_b32 v93, 0
    v_mov_b32 v94, 0
    v_mov_b32 v95, 0
    v_mov_b32 v96, 0
    v_mov_b32 v97, 0
    v_mov_b32 v98, 0
    v_mov_b32 v99, 0
    v_mov_b32 v100, 0
    v_mov_b32 v101, 0
    v_mov_b32 v102, 0
    v_mov_b32 v103, 0
    v_mov_b32 v104, 0
    v_mov_b32 v105, 0
    v_mov_b32 v106, 0
    v_mov_b32 v107, 0
    v_mov_b32 v108, 0
    v_mov_b32 v109, 0
    v_mov_b32 v110, 0
    v_mov_b32 v111, 0
    v_mov_b32 v112, 0
    v_mov_b32 v113, 0
    v_mov_b32 v114, 0
    v_mov_b32 v115, 0
    v_mov_b32 v116, 0
    v_mov_b32 v117, 0
    v_mov_b32 v118, 0
    v_mov_b32 v119, 0
    v_mov_b32 v120, 0
    v_mov_b32 v121, 0
    v_mov_b32 v122, 0
    v_mov_b32 v123, 0
    v_mov_b32 v124, 0
    v_mov_b32 v125, 0
    v_mov_b32 v126, 0
    v_mov_b32 v127, 0
    v_mov_b32 v184, 0
    v_mov_b32 v185, 0
    v_mov_b32 v186, 0
    v_mov_b32 v187, 0
    v_mov_b32 v188, 0
    v_mov_b32 v189, 0
    v_mov_b32 v190, 0
    v_mov_b32 v191, 0
    v_mov_b32 v252, 0
    v_mov_b32 v253, 0
    v_mov_b32 v254, 0
    v_mov_b32 v255, 0
    v_mov_b32 v12, 0xdddddddd
    s_add_u32 s44, s36, 1
    s_and_b32 s44, s44, 3
    s_mul_i32 s44, s44, 12288
    s_add_u32 s44, s44, 57344
    v_add_u32 v13, s44, v2
    s_add_u32 s44, s36, 2
    s_and_b32 s44, s44, 3
    s_mul_i32 s44, s44, 12288
    s_add_u32 s44, s44, 61440
    v_add_u32 v14, s44, v2
    s_add_u32 s44, s36, 3
    s_and_b32 s44, s44, 3
    s_mul_i32 s44, s44, 12288
    s_add_u32 s44, s44, 65536
    v_add_u32 v15, s44, v2
    s_mul_i32 s44, s36, 12288
    s_add_u32 s44, s44, 57344
    v_add_u32 v16, s44, v2
    s_barrier
    buffer_load_dwordx4 v[32:35], v2, s[24:27], s32 offen sc1
    buffer_load_dwordx4 v[36:39], v2, s[24:27], s32 offen offset:1024 sc1
    buffer_load_dwordx4 v[192:195], v2, s[24:27], s51 offen offset:0 sc1
    buffer_load_dwordx4 v[196:199], v2, s[24:27], s51 offen offset:1024 sc1
    buffer_load_dwordx4 v[200:203], v2, s[24:27], s51 offen offset:2048 sc1
    buffer_load_dwordx4 v[204:207], v2, s[24:27], s51 offen offset:3072 sc1
    buffer_load_dwordx4 v[40:43], v2, s[24:27], s33 offen sc1
    buffer_load_dwordx4 v[44:47], v2, s[24:27], s33 offen offset:1024 sc1
    ds_write_b128 v20, v[144:147] offset:0
    ds_write_b128 v20, v[148:151] offset:1024
    ds_write_b128 v20, v[152:155] offset:2048
    ds_write_b128 v20, v[156:159] offset:3072
    s_waitcnt lgkmcnt(0)
    s_barrier
    buffer_load_dwordx4 v[48:51], v2, s[24:27], s34 offen sc1
    buffer_load_dwordx4 v[52:55], v2, s[24:27], s34 offen offset:1024 sc1
    buffer_load_dwordx4 v[56:59], v2, s[24:27], s35 offen sc1
    buffer_load_dwordx4 v[60:63], v2, s[24:27], s35 offen offset:1024 sc1
    s_branch K2_ATT
K1_V:
    v_and_b32 v6, 31, v1
    v_cmp_eq_u32 vcc, 28, v6
    v_mov_b32 v30, 0x3f803f80
    v_cmp_le_u32 s[56:57], 28, v6
    v_cndmask_b32 v30, 0, v30, vcc
    s_barrier
    ds_read_b128 v[128:131], v12 offset:0
    ds_read_b64_tr_b16 v[132:133], v16 offset:0
    ds_read_b64_tr_b16 v[134:135], v16 offset:1024
    ds_read_b64_tr_b16 v[136:137], v17 offset:0
    ds_read_b64_tr_b16 v[138:139], v17 offset:1024
    ds_read_b128 v[140:143], v13 offset:0
    ds_read_b64_tr_b16 v[144:145], v16 offset:4096
    ds_read_b64_tr_b16 v[146:147], v16 offset:5120
    ds_read_b64_tr_b16 v[148:149], v17 offset:4096
    ds_read_b64_tr_b16 v[150:151], v17 offset:5120
    ds_read_b128 v[152:155], v14 offset:0
    ds_read_b64_tr_b16 v[156:157], v16 offset:8192
    ds_read_b64_tr_b16 v[158:159], v16 offset:9216
    ds_read_b64_tr_b16 v[160:161], v17 offset:8192
    ds_read_b64_tr_b16 v[162:163], v17 offset:9216
    s_waitcnt lgkmcnt(10)
    v_mfma_f32_32x32x16_bf16 v[64:79], v[128:131], v[132:135], 0
    ds_read_b128 v[164:167], v15 offset:0
    ds_read_b64_tr_b16 v[168:169], v16 offset:12288
    v_mfma_f32_32x32x16_bf16 v[80:95], v[128:131], v[136:139], 0
    ds_read_b64_tr_b16 v[170:171], v16 offset:13312
    ds_read_b64_tr_b16 v[172:173], v17 offset:12288
    ds_read_b64_tr_b16 v[174:175], v17 offset:13312
    s_waitcnt lgkmcnt(10)
    s_barrier
    v_mfma_f32_32x32x16_bf16 v[64:79], v[140:143], v[144:147], v[64:79]
    ds_read_b128 v[128:131], v12 offset:8192
    ds_read_b64_tr_b16 v[132:133], v16 offset:16384
    v_mfma_f32_32x32x16_bf16 v[80:95], v[140:143], v[148:151], v[80:95]
    ds_read_b64_tr_b16 v[134:135], v16 offset:17408
    ds_read_b64_tr_b16 v[136:137], v17 offset:16384
    ds_read_b64_tr_b16 v[138:139], v17 offset:17408
    s_waitcnt lgkmcnt(10)
    v_mfma_f32_32x32x16_bf16 v[64:79], v[152:155], v[156:159], v[64:79]
    ds_read_b128 v[140:143], v13 offset:8192
    ds_read_b64_tr_b16 v[144:145], v16 offset:20480
    v_mfma_f32_32x32x16_bf16 v[80:95], v[152:155], v[160:163], v[80:95]
    ds_read_b64_tr_b16 v[146:147], v16 offset:21504
    ds_read_b64_tr_b16 v[148:149], v17 offset:20480
    ds_read_b64_tr_b16 v[150:151], v17 offset:21504
    s_waitcnt lgkmcnt(10)
    v_mfma_f32_32x32x16_bf16 v[64:79], v[164:167], v[168:171], v[64:79]
    ds_read_b128 v[152:155], v14 offset:8192
    ds_read_b64_tr_b16 v[156:157], v16 offset:24576
    v_mfma_f32_32x32x16_bf16 v[80:95], v[164:167], v[172:175], v[80:95]
    ds_read_b64_tr_b16 v[158:159], v16 offset:25600
    ds_read_b64_tr_b16 v[160:161], v17 offset:24576
    ds_read_b64_tr_b16 v[162:163], v17 offset:25600
    s_waitcnt lgkmcnt(10)
    v_mfma_f32_32x32x16_bf16 v[64:79], v[128:131], v[132:135], v[64:79]
    ds_read_b128 v[164:167], v15 offset:8192
    ds_read_b64_tr_b16 v[168:169], v16 offset:28672
    v_mfma_f32_32x32x16_bf16 v[80:95], v[128:131], v[136:139], v[80:95]
    ds_read_b64_tr_b16 v[170:171], v16 offset:29696
    ds_read_b64_tr_b16 v[172:173], v17 offset:28672
    ds_read_b64_tr_b16 v[174:175], v17 offset:29696
    s_waitcnt lgkmcnt(10)
    s_barrier
    v_mfma_f32_32x32x16_bf16 v[64:79], v[140:143], v[144:147], v[64:79]
    ds_read_b128 v[128:131], v12 offset:16384
    ds_read_b64_tr_b16 v[132:133], v16 offset:32768
    v_mfma_f32_32x32x16_bf16 v[80:95], v[140:143], v[148:151], v[80:95]
    ds_read_b64_tr_b16 v[134:135], v16 offset:33792
    ds_read_b64_tr_b16 v[136:137], v17 offset:32768
    ds_read_b64_tr_b16 v[138:139], v17 offset:33792
    s_waitcnt lgkmcnt(10)
    v_mfma_f32_32x32x16_bf16 v[64:79], v[152:155], v[156:159], v[64:79]
    ds_read_b128 v[140:143], v13 offset:16384
    ds_read_b64_tr_b16 v[144:145], v16 offset:36864
    v_mfma_f32_32x32x16_bf16 v[80:95], v[152:155], v[160:163], v[80:95]
    ds_read_b64_tr_b16 v[146:147], v16 offset:37888
    ds_read_b64_tr_b16 v[148:149], v17 offset:36864
    ds_read_b64_tr_b16 v[150:151], v17 offset:37888
    s_waitcnt lgkmcnt(10)
    v_mfma_f32_32x32x16_bf16 v[64:79], v[164:167], v[168:171], v[64:79]
    ds_read_b128 v[152:155], v14 offset:16384
    ds_read_b64_tr_b16 v[156:157], v16 offset:40960
    v_mfma_f32_32x32x16_bf16 v[80:95], v[164:167], v[172:175], v[80:95]
    ds_read_b64_tr_b16 v[158:159], v16 offset:41984
    ds_read_b64_tr_b16 v[160:161], v17 offset:40960
    ds_read_b64_tr_b16 v[162:163], v17 offset:41984
    s_waitcnt lgkmcnt(10)
    v_mfma_f32_32x32x16_bf16 v[64:79], v[128:131], v[132:135], v[64:79]
    ds_read_b128 v[164:167], v15 offset:16384
    ds_read_b64_tr_b16 v[168:169], v16 offset:45056
    v_mfma_f32_32x32x16_bf16 v[80:95], v[128:131], v[136:139], v[80:95]
    ds_read_b64_tr_b16 v[170:171], v16 offset:46080
    ds_read_b64_tr_b16 v[172:173], v17 offset:45056
    ds_read_b64_tr_b16 v[174:175], v17 offset:46080
    s_waitcnt lgkmcnt(10)
    s_barrier
    v_mfma_f32_32x32x16_bf16 v[64:79], v[140:143], v[144:147], v[64:79]
    ds_read_b128 v[128:131], v12 offset:24576
    ds_read_b64_tr_b16 v[132:133], v16 offset:49152
    v_mfma_f32_32x32x16_bf16 v[80:95], v[140:143], v[148:151], v[80:95]
    ds_read_b64_tr_b16 v[134:135], v16 offset:50176
    ds_read_b64_tr_b16 v[136:137], v17 offset:49152
    ds_read_b64_tr_b16 v[138:139], v17 offset:50176
    s_waitcnt lgkmcnt(10)
    v_mfma_f32_32x32x16_bf16 v[64:79], v[152:155], v[156:159], v[64:79]
    ds_read_b128 v[140:143], v13 offset:24576
    ds_read_b64_tr_b16 v[144:145], v16 offset:53248
    v_mfma_f32_32x32x16_bf16 v[80:95], v[152:155], v[160:163], v[80:95]
    ds_read_b64_tr_b16 v[146:147], v16 offset:54272
    ds_read_b64_tr_b16 v[148:149], v17 offset:53248
    ds_read_b64_tr_b16 v[150:151], v17 offset:54272
    s_waitcnt lgkmcnt(10)
    v_mfma_f32_32x32x16_bf16 v[64:79], v[164:167], v[168:171], v[64:79]
    ds_read_b128 v[152:155], v14 offset:24576
    ds_read_b64_tr_b16 v[156:157], v16 offset:57344
    v_mfma_f32_32x32x16_bf16 v[80:95], v[164:167], v[172:175], v[80:95]
    ds_read_b64_tr_b16 v[158:159], v16 offset:58368
    ds_read_b64_tr_b16 v[160:161], v17 offset:57344
    ds_read_b64_tr_b16 v[162:163], v17 offset:58368
    s_waitcnt lgkmcnt(10)
    v_mfma_f32_32x32x16_bf16 v[64:79], v[128:131], v[132:135], v[64:79]
    ds_read_b128 v[164:167], v15 offset:24576
    ds_read_b64_tr_b16 v[168:169], v16 offset:61440
    v_mfma_f32_32x32x16_bf16 v[80:95], v[128:131], v[136:139], v[80:95]
    ds_read_b64_tr_b16 v[170:171], v16 offset:62464
    ds_read_b64_tr_b16 v[172:173], v17 offset:61440
    ds_read_b64_tr_b16 v[174:175], v17 offset:62464
    s_waitcnt lgkmcnt(10)
    s_barrier
    v_mfma_f32_32x32x16_bf16 v[64:79], v[140:143], v[144:147], v[64:79]
    ds_read_b128 v[128:131], v12 offset:32768
    ds_read_b64_tr_b16 v[132:133], v18 offset:0
    v_mfma_f32_32x32x16_bf16 v[80:95], v[140:143], v[148:151], v[80:95]
    ds_read_b64_tr_b16 v[134:135], v18 offset:1024
    ds_read_b64_tr_b16 v[136:137], v19 offset:0
    ds_read_b64_tr_b16 v[138:139], v19 offset:1024
    s_waitcnt lgkmcnt(10)
    v_mfma_f32_32x32x16_bf16 v[64:79], v[152:155], v[156:159], v[64:79]
    ds_read_b128 v[140:143], v13 offset:32768
    ds_read_b64_tr_b16 v[144:145], v18 offset:4096
    v_mfma_f32_32x32x16_bf16 v[80:95], v[152:155], v[160:163], v[80:95]
    ds_read_b64_tr_b16 v[146:147], v18 offset:5120
    ds_read_b64_tr_b16 v[148:149], v19 offset:4096
    ds_read_b64_tr_b16 v[150:151], v19 offset:5120
    s_waitcnt lgkmcnt(10)
    v_mfma_f32_32x32x16_bf16 v[64:79], v[164:167], v[168:171], v[64:79]
    ds_read_b128 v[152:155], v14 offset:32768
    ds_read_b64_tr_b16 v[156:157], v18 offset:8192
    v_mfma_f32_32x32x16_bf16 v[80:95], v[164:167], v[172:175], v[80:95]
    ds_read_b64_tr_b16 v[158:159], v18 offset:9216
    ds_read_b64_tr_b16 v[160:161], v19 offset:8192
    ds_read_b64_tr_b16 v[162:163], v19 offset:9216
    s_waitcnt lgkmcnt(10)
    v_mfma_f32_32x32x16_bf16 v[64:79], v[128:131], v[132:135], v[64:79]
    ds_read_b128 v[164:167], v15 offset:32768
    ds_read_b64_tr_b16 v[168:169], v18 offset:12288
    v_mfma_f32_32x32x16_bf16 v[80:95], v[128:131], v[136:139], v[80:95]
    ds_read_b64_tr_b16 v[170:171], v18 offset:13312
    ds_read_b64_tr_b16 v[172:173], v19 offset:12288
    ds_read_b64_tr_b16 v[174:175], v19 offset:13312
    s_waitcnt lgkmcnt(10)
    s_barrier
    v_mfma_f32_32x32x16_bf16 v[64:79], v[140:143], v[144:147], v[64:79]
    ds_read_b128 v[128:131], v12 offset:40960
    ds_read_b64_tr_b16 v[132:133], v18 offset:16384
    v_mfma_f32_32x32x16_bf16 v[80:95], v[140:143], v[148:151], v[80:95]
    ds_read_b64_tr_b16 v[134:135], v18 offset:17408
    ds_read_b64_tr_b16 v[136:137], v19 offset:16384
    ds_read_b64_tr_b16 v[138:139], v19 offset:17408
    s_waitcnt lgkmcnt(10)
    v_mfma_f32_32x32x16_bf16 v[64:79], v[152:155], v[156:159], v[64:79]
    ds_read_b128 v[140:143], v13 offset:40960
    ds_read_b64_tr_b16 v[144:145], v18 offset:20480
    v_mfma_f32_32x32x16_bf16 v[80:95], v[152:155], v[160:163], v[80:95]
    ds_read_b64_tr_b16 v[146:147], v18 offset:21504
    ds_read_b64_tr_b16 v[148:149], v19 offset:20480
    ds_read_b64_tr_b16 v[150:151], v19 offset:21504
    s_waitcnt lgkmcnt(10)
    v_mfma_f32_32x32x16_bf16 v[64:79], v[164:167], v[168:171], v[64:79]
    ds_read_b128 v[152:155], v14 offset:40960
    ds_read_b64_tr_b16 v[156:157], v18 offset:24576
    v_mfma_f32_32x32x16_bf16 v[80:95], v[164:167], v[172:175], v[80:95]
    ds_read_b64_tr_b16 v[158:159], v18 offset:25600
    ds_read_b64_tr_b16 v[160:161], v19 offset:24576
    ds_read_b64_tr_b16 v[162:163], v19 offset:25600
    s_waitcnt lgkmcnt(10)
    v_mfma_f32_32x32x16_bf16 v[64:79], v[128:131], v[132:135], v[64:79]
    ds_read_b128 v[164:167], v15 offset:40960
    ds_read_b64_tr_b16 v[168:169], v18 offset:28672
    v_mfma_f32_32x32x16_bf16 v[80:95], v[128:131], v[136:139], v[80:95]
    ds_read_b64_tr_b16 v[170:171], v18 offset:29696
    ds_read_b64_tr_b16 v[172:173], v19 offset:28672
    ds_read_b64_tr_b16 v[174:175], v19 offset:29696
    s_waitcnt lgkmcnt(10)
    s_barrier
    v_mfma_f32_32x32x16_bf16 v[64:79], v[140:143], v[144:147], v[64:79]
    ds_read_b128 v[128:131], v12 offset:0
    ds_read_b64_tr_b16 v[132:133], v18 offset:32768
    v_mfma_f32_32x32x16_bf16 v[80:95], v[140:143], v[148:151], v[80:95]
    ds_read_b64_tr_b16 v[134:135], v18 offset:33792
    ds_read_b64_tr_b16 v[136:137], v19 offset:32768
    ds_read_b64_tr_b16 v[138:139], v19 offset:33792
    s_waitcnt lgkmcnt(10)
    v_mfma_f32_32x32x16_bf16 v[64:79], v[152:155], v[156:159], v[64:79]
    ds_read_b128 v[140:143], v13 offset:0
    ds_read_b64_tr_b16 v[144:145], v18 offset:36864
    v_mfma_f32_32x32x16_bf16 v[80:95], v[152:155], v[160:163], v[80:95]
    ds_read_b64_tr_b16 v[146:147], v18 offset:37888
    ds_read_b64_tr_b16 v[148:149], v19 offset:36864
    ds_read_b64_tr_b16 v[150:151], v19 offset:37888
    s_waitcnt lgkmcnt(10)
    v_mfma_f32_32x32x16_bf16 v[64:79], v[164:167], v[168:171], v[64:79]
    ds_read_b128 v[152:155], v14 offset:0
    ds_read_b64_tr_b16 v[156:157], v18 offset:40960
    v_mfma_f32_32x32x16_bf16 v[80:95], v[164:167], v[172:175], v[80:95]
    ds_read_b64_tr_b16 v[158:159], v18 offset:41984
    ds_read_b64_tr_b16 v[160:161], v19 offset:40960
    ds_read_b64_tr_b16 v[162:163], v19 offset:41984
    s_waitcnt lgkmcnt(10)
    v_mfma_f32_32x32x16_bf16 v[64:79], v[128:131], v[132:135], v[64:79]
    ds_read_b128 v[164:167], v15 offset:0
    ds_read_b64_tr_b16 v[168:169], v18 offset:45056
    v_mfma_f32_32x32x16_bf16 v[80:95], v[128:131], v[136:139], v[80:95]
    ds_read_b64_tr_b16 v[170:171], v18 offset:46080
    ds_read_b64_tr_b16 v[172:173], v19 offset:45056
    ds_read_b64_tr_b16 v[174:175], v19 offset:46080
    s_waitcnt lgkmcnt(10)
    s_barrier
    v_mfma_f32_32x32x16_bf16 v[64:79], v[140:143], v[144:147], v[64:79]
    ds_read_b128 v[128:131], v12 offset:8192
    ds_read_b64_tr_b16 v[132:133], v16 offset:0
    v_mfma_f32_32x32x16_bf16 v[80:95], v[140:143], v[148:151], v[80:95]
    ds_read_b64_tr_b16 v[134:135], v16 offset:1024
    ds_read_b64_tr_b16 v[136:137], v17 offset:0
    ds_read_b64_tr_b16 v[138:139], v17 offset:1024
    s_waitcnt lgkmcnt(10)
    v_mfma_f32_32x32x16_bf16 v[64:79], v[152:155], v[156:159], v[64:79]
    ds_read_b128 v[140:143], v13 offset:8192
    ds_read_b64_tr_b16 v[144:145], v16 offset:4096
    v_mfma_f32_32x32x16_bf16 v[80:95], v[152:155], v[160:163], v[80:95]
    ds_read_b64_tr_b16 v[146:147], v16 offset:5120
    ds_read_b64_tr_b16 v[148:149], v17 offset:4096
    ds_read_b64_tr_b16 v[150:151], v17 offset:5120
    s_waitcnt lgkmcnt(10)
    v_mfma_f32_32x32x16_bf16 v[64:79], v[164:167], v[168:171], v[64:79]
    ds_read_b128 v[152:155], v14 offset:8192
    ds_read_b64_tr_b16 v[156:157], v16 offset:8192
    v_mfma_f32_32x32x16_bf16 v[80:95], v[164:167], v[172:175], v[80:95]
    ds_read_b64_tr_b16 v[158:159], v16 offset:9216
    ds_read_b64_tr_b16 v[160:161], v17 offset:8192
    ds_read_b64_tr_b16 v[162:163], v17 offset:9216
    s_waitcnt lgkmcnt(10)
    v_mfma_f32_32x32x16_bf16 v[96:111], v[128:131], v[132:135], 0
    ds_read_b128 v[164:167], v15 offset:8192
    ds_read_b64_tr_b16 v[168:169], v16 offset:12288
    v_mfma_f32_32x32x16_bf16 v[112:127], v[128:131], v[136:139], 0
    ds_read_b64_tr_b16 v[170:171], v16 offset:13312
    ds_read_b64_tr_b16 v[172:173], v17 offset:12288
    ds_read_b64_tr_b16 v[174:175], v17 offset:13312
    s_waitcnt lgkmcnt(10)
    s_barrier
    v_mfma_f32_32x32x16_bf16 v[96:111], v[140:143], v[144:147], v[96:111]
    ds_read_b128 v[128:131], v12 offset:16384
    ds_read_b64_tr_b16 v[132:133], v16 offset:16384
    v_mfma_f32_32x32x16_bf16 v[112:127], v[140:143], v[148:151], v[112:127]
    ds_read_b64_tr_b16 v[134:135], v16 offset:17408
    ds_read_b64_tr_b16 v[136:137], v17 offset:16384
    ds_read_b64_tr_b16 v[138:139], v17 offset:17408
    s_waitcnt lgkmcnt(10)
    v_mfma_f32_32x32x16_bf16 v[96:111], v[152:155], v[156:159], v[96:111]
    ds_read_b128 v[140:143], v13 offset:16384
    ds_read_b64_tr_b16 v[144:145], v16 offset:20480
    ds_read_b64_tr_b16 v[146:147], v16 offset:21504
    ds_read_b64_tr_b16 v[148:149], v17 offset:20480
    ds_read_b64_tr_b16 v[150:151], v17 offset:21504
    v_cvt_pk_bf16_f32 v32, v64, v65
    v_cvt_pk_bf16_f32 v33, v66, v67
    v_cvt_pk_bf16_f32 v34, v68, v69
    v_cvt_pk_bf16_f32 v35, v70, v71
    v_cvt_pk_bf16_f32 v36, v72, v73
    v_cvt_pk_bf16_f32 v37, v74, v75
    v_cvt_pk_bf16_f32 v38, v76, v77
    v_mfma_f32_32x32x16_bf16 v[112:127], v[152:155], v[160:163], v[112:127]
    v_cvt_pk_bf16_f32 v39, v78, v79
    v_cndmask_b32 v32, v32, v30, s[56:57]
    v_cndmask_b32 v33, v33, v30, s[56:57]
    v_cndmask_b32 v34, v34, v30, s[56:57]
    v_cndmask_b32 v35, v35, v30, s[56:57]
    v_cndmask_b32 v36, v36, v30, s[56:57]
    v_cndmask_b32 v37, v37, v30, s[56:57]
    v_cndmask_b32 v38, v38, v30, s[56:57]
    v_cndmask_b32 v39, v39, v30, s[56:57]
    buffer_store_dwordx4 v[32:35], v2, s[24:27], s53 offen sc1
    buffer_store_dwordx4 v[36:39], v2, s[24:27], s53 offen offset:1024 sc1
    v_cvt_pk_bf16_f32 v40, v80, v81
    s_waitcnt lgkmcnt(10)
    v_mfma_f32_32x32x16_bf16 v[96:111], v[164:167], v[168:171], v[96:111]
    ds_read_b128 v[152:155], v14 offset:16384
    ds_read_b64_tr_b16 v[156:157], v16 offset:24576
    ds_read_b64_tr_b16 v[158:159], v16 offset:25600
    ds_read_b64_tr_b16 v[160:161], v17 offset:24576
    ds_read_b64_tr_b16 v[162:163], v17 offset:25600
    v_cvt_pk_bf16_f32 v41, v82, v83
    v_cvt_pk_bf16_f32 v42, v84, v85
    v_cvt_pk_bf16_f32 v43, v86, v87
    v_cvt_pk_bf16_f32 v44, v88, v89
    v_cvt_pk_bf16_f32 v45, v90, v91
    v_cvt_pk_bf16_f32 v46, v92, v93
    v_mfma_f32_32x32x16_bf16 v[112:127], v[164:167], v[172:175], v[112:127]
    v_cvt_pk_bf16_f32 v47, v94, v95
    v_cndmask_b32 v40, v40, v30, s[56:57]
    v_cndmask_b32 v41, v41, v30, s[56:57]
    v_cndmask_b32 v42, v42, v30, s[56:57]
    v_cndmask_b32 v43, v43, v30, s[56:57]
    v_cndmask_b32 v44, v44, v30, s[56:57]
    v_cndmask_b32 v45, v45, v30, s[56:57]
    v_cndmask_b32 v46, v46, v30, s[56:57]
    v_cndmask_b32 v47, v47, v30, s[56:57]
    s_add_u32 s46, s53, s54
    buffer_store_dwordx4 v[40:43], v2, s[24:27], s46 offen sc1
    buffer_store_dwordx4 v[44:47], v2, s[24:27], s46 offen offset:1024 sc1
    s_mov_b32 s32, s14
    s_and_b32 s33, s15, 0xffff
    s_mov_b32 s34, 256
    s_mov_b32 s35, 0x20000
    v_mov_b32 v10, 0
    buffer_load_dwordx2 v[8:9], v10, s[32:35], 0 offen sc1
    s_waitcnt lgkmcnt(10)
    v_mfma_f32_32x32x16_bf16 v[96:111], v[128:131], v[132:135], v[96:111]
    ds_read_b128 v[164:167], v15 offset:16384
    ds_read_b64_tr_b16 v[168:169], v16 offset:28672
    v_mfma_f32_32x32x16_bf16 v[112:127], v[128:131], v[136:139], v[112:127]
    ds_read_b64_tr_b16 v[170:171], v16 offset:29696
    ds_read_b64_tr_b16 v[172:173], v17 offset:28672
    ds_read_b64_tr_b16 v[174:175], v17 offset:29696
    s_waitcnt lgkmcnt(10)
    s_barrier
    v_mfma_f32_32x32x16_bf16 v[96:111], v[140:143], v[144:147], v[96:111]
    ds_read_b128 v[128:131], v12 offset:24576
    ds_read_b64_tr_b16 v[132:133], v16 offset:32768
    v_mfma_f32_32x32x16_bf16 v[112:127], v[140:143], v[148:151], v[112:127]
    ds_read_b64_tr_b16 v[134:135], v16 offset:33792
    ds_read_b64_tr_b16 v[136:137], v17 offset:32768
    ds_read_b64_tr_b16 v[138:139], v17 offset:33792
    s_waitcnt lgkmcnt(10)
    v_mfma_f32_32x32x16_bf16 v[96:111], v[152:155], v[156:159], v[96:111]
    ds_read_b128 v[140:143], v13 offset:24576
    ds_read_b64_tr_b16 v[144:145], v16 offset:36864
    v_mfma_f32_32x32x16_bf16 v[112:127], v[152:155], v[160:163], v[112:127]
    ds_read_b64_tr_b16 v[146:147], v16 offset:37888
    ds_read_b64_tr_b16 v[148:149], v17 offset:36864
    ds_read_b64_tr_b16 v[150:151], v17 offset:37888
    s_waitcnt lgkmcnt(10)
    v_mfma_f32_32x32x16_bf16 v[96:111], v[164:167], v[168:171], v[96:111]
    ds_read_b128 v[152:155], v14 offset:24576
    ds_read_b64_tr_b16 v[156:157], v16 offset:40960
    v_mfma_f32_32x32x16_bf16 v[112:127], v[164:167], v[172:175], v[112:127]
    ds_read_b64_tr_b16 v[158:159], v16 offset:41984
    ds_read_b64_tr_b16 v[160:161], v17 offset:40960
    ds_read_b64_tr_b16 v[162:163], v17 offset:41984
    s_waitcnt lgkmcnt(10)
    v_mfma_f32_32x32x16_bf16 v[96:111], v[128:131], v[132:135], v[96:111]
    ds_read_b128 v[164:167], v15 offset:24576
    ds_read_b64_tr_b16 v[168:169], v16 offset:45056
    v_mfma_f32_32x32x16_bf16 v[112:127], v[128:131], v[136:139], v[112:127]
    ds_read_b64_tr_b16 v[170:171], v16 offset:46080
    ds_read_b64_tr_b16 v[172:173], v17 offset:45056
    ds_read_b64_tr_b16 v[174:175], v17 offset:46080
    s_waitcnt lgkmcnt(10)
    s_barrier
    v_mfma_f32_32x32x16_bf16 v[96:111], v[140:143], v[144:147], v[96:111]
    ds_read_b128 v[128:131], v12 offset:32768
    ds_read_b64_tr_b16 v[132:133], v16 offset:49152
    v_mfma_f32_32x32x16_bf16 v[112:127], v[140:143], v[148:151], v[112:127]
    ds_read_b64_tr_b16 v[134:135], v16 offset:50176
    ds_read_b64_tr_b16 v[136:137], v17 offset:49152
    ds_read_b64_tr_b16 v[138:139], v17 offset:50176
    s_waitcnt lgkmcnt(10)
    v_mfma_f32_32x32x16_bf16 v[96:111], v[152:155], v[156:159], v[96:111]
    ds_read_b128 v[140:143], v13 offset:32768
    ds_read_b64_tr_b16 v[144:145], v16 offset:53248
    v_mfma_f32_32x32x16_bf16 v[112:127], v[152:155], v[160:163], v[112:127]
    ds_read_b64_tr_b16 v[146:147], v16 offset:54272
    ds_read_b64_tr_b16 v[148:149], v17 offset:53248
    ds_read_b64_tr_b16 v[150:151], v17 offset:54272
    s_waitcnt lgkmcnt(10)
    v_mfma_f32_32x32x16_bf16 v[96:111], v[164:167], v[168:171], v[96:111]
    ds_read_b128 v[152:155], v14 offset:32768
    ds_read_b64_tr_b16 v[156:157], v16 offset:57344
    v_mfma_f32_32x32x16_bf16 v[112:127], v[164:167], v[172:175], v[112:127]
    ds_read_b64_tr_b16 v[158:159], v16 offset:58368
    ds_read_b64_tr_b16 v[160:161], v17 offset:57344
    ds_read_b64_tr_b16 v[162:163], v17 offset:58368
    s_mov_b32 s61, 200000
EP7:
    s_waitcnt vmcnt(0)
    v_readfirstlane_b32 s63, v9
    v_readfirstlane_b32 s62, v8
    s_sub_u32 s61, s61, 1
    s_cbranch_scc1 EP7_X
    s_cmp_lg_u32 s63, 0
    s_cbranch_scc1 EP7_X
    buffer_load_dwordx2 v[8:9], v10, s[32:35], 0 offen sc1
    s_branch EP7
EP7_X:
    v_cmp_gt_u32 vcc, 16, v1
    v_lshlrev_b32 v8, 3, v1
    v_mov_b32 v10, 2146435072
    v_cndmask_b32 v10, v10, v8, vcc
    v_mov_b32 v8, s62
    v_mov_b32 v9, s63
    buffer_store_dwordx2 v[8:9], v10, s[24:27], s40 offen sc1
    s_waitcnt lgkmcnt(10)
    v_mfma_f32_32x32x16_bf16 v[96:111], v[128:131], v[132:135], v[96:111]
    ds_read_b128 v[164:167], v15 offset:32768
    ds_read_b64_tr_b16 v[168:169], v16 offset:61440
    v_mfma_f32_32x32x16_bf16 v[112:127], v[128:131], v[136:139], v[112:127]
    ds_read_b64_tr_b16 v[170:171], v16 offset:62464
    ds_read_b64_tr_b16 v[172:173], v17 offset:61440
    ds_read_b64_tr_b16 v[174:175], v17 offset:62464
    s_waitcnt lgkmcnt(10)
    s_barrier
    v_mfma_f32_32x32x16_bf16 v[96:111], v[140:143], v[144:147], v[96:111]
    ds_read_b128 v[128:131], v12 offset:40960
    ds_read_b64_tr_b16 v[132:133], v18 offset:0
    v_mfma_f32_32x32x16_bf16 v[112:127], v[140:143], v[148:151], v[112:127]
    ds_read_b64_tr_b16 v[134:135], v18 offset:1024
    ds_read_b64_tr_b16 v[136:137], v19 offset:0
    ds_read_b64_tr_b16 v[138:139], v19 offset:1024
    s_waitcnt lgkmcnt(10)
    v_mfma_f32_32x32x16_bf16 v[96:111], v[152:155], v[156:159], v[96:111]
    ds_read_b128 v[140:143], v13 offset:40960
    ds_read_b64_tr_b16 v[144:145], v18 offset:4096
    v_mfma_f32_32x32x16_bf16 v[112:127], v[152:155], v[160:163], v[112:127]
    ds_read_b64_tr_b16 v[146:147], v18 offset:5120
    ds_read_b64_tr_b16 v[148:149], v19 offset:4096
    ds_read_b64_tr_b16 v[150:151], v19 offset:5120
    s_waitcnt lgkmcnt(10)
    v_mfma_f32_32x32x16_bf16 v[96:111], v[164:167], v[168:171], v[96:111]
    ds_read_b128 v[152:155], v14 offset:40960
    ds_read_b64_tr_b16 v[156:157], v18 offset:8192
    v_mfma_f32_32x32x16_bf16 v[112:127], v[164:167], v[172:175], v[112:127]
    ds_read_b64_tr_b16 v[158:159], v18 offset:9216
    ds_read_b64_tr_b16 v[160:161], v19 offset:8192
    ds_read_b64_tr_b16 v[162:163], v19 offset:9216
    s_waitcnt lgkmcnt(10)
    v_mfma_f32_32x32x16_bf16 v[96:111], v[128:131], v[132:135], v[96:111]
    ds_read_b128 v[164:167], v15 offset:40960
    ds_read_b64_tr_b16 v[168:169], v18 offset:12288
    v_mfma_f32_32x32x16_bf16 v[112:127], v[128:131], v[136:139], v[112:127]
    ds_read_b64_tr_b16 v[170:171], v18 offset:13312
    ds_read_b64_tr_b16 v[172:173], v19 offset:12288
    ds_read_b64_tr_b16 v[174:175], v19 offset:13312
    s_waitcnt lgkmcnt(10)
    s_barrier
    v_mfma_f32_32x32x16_bf16 v[96:111], v[140:143], v[144:147], v[96:111]
    ds_read_b128 v[128:131], v12 offset:0
    ds_read_b64_tr_b16 v[132:133], v18 offset:16384
    v_mfma_f32_32x32x16_bf16 v[112:127], v[140:143], v[148:151], v[112:127]
    ds_read_b64_tr_b16 v[134:135], v18 offset:17408
    ds_read_b64_tr_b16 v[136:137], v19 offset:16384
    ds_read_b64_tr_b16 v[138:139], v19 offset:17408
    s_waitcnt lgkmcnt(10)
    v_mfma_f32_32x32x16_bf16 v[96:111], v[152:155], v[156:159], v[96:111]
    ds_read_b128 v[140:143], v13 offset:0
    ds_read_b64_tr_b16 v[144:145], v18 offset:20480
    v_mfma_f32_32x32x16_bf16 v[112:127], v[152:155], v[160:163], v[112:127]
    ds_read_b64_tr_b16 v[146:147], v18 offset:21504
    ds_read_b64_tr_b16 v[148:149], v19 offset:20480
    ds_read_b64_tr_b16 v[150:151], v19 offset:21504
    s_waitcnt lgkmcnt(10)
    v_mfma_f32_32x32x16_bf16 v[96:111], v[164:167], v[168:171], v[96:111]
    ds_read_b128 v[152:155], v14 offset:0
    ds_read_b64_tr_b16 v[156:157], v18 offset:24576
    v_mfma_f32_32x32x16_bf16 v[112:127], v[164:167], v[172:175], v[112:127]
    ds_read_b64_tr_b16 v[158:159], v18 offset:25600
    ds_read_b64_tr_b16 v[160:161], v19 offset:24576
    ds_read_b64_tr_b16 v[162:163], v19 offset:25600
    s_waitcnt lgkmcnt(10)
    v_mfma_f32_32x32x16_bf16 v[96:111], v[128:131], v[132:135], v[96:111]
    ds_read_b128 v[164:167], v15 offset:0
    ds_read_b64_tr_b16 v[168:169], v18 offset:28672
    v_mfma_f32_32x32x16_bf16 v[112:127], v[128:131], v[136:139], v[112:127]
    ds_read_b64_tr_b16 v[170:171], v18 offset:29696
    ds_read_b64_tr_b16 v[172:173], v19 offset:28672
    ds_read_b64_tr_b16 v[174:175], v19 offset:29696
    s_waitcnt lgkmcnt(10)
    s_barrier
    v_mfma_f32_32x32x16_bf16 v[96:111], v[140:143], v[144:147], v[96:111]
    ds_read_b128 v[128:131], v12 offset:8192
    ds_read_b64_tr_b16 v[132:133], v18 offset:32768
    v_mfma_f32_32x32x16_bf16 v[112:127], v[140:143], v[148:151], v[112:127]
    ds_read_b64_tr_b16 v[134:135], v18 offset:33792
    ds_read_b64_tr_b16 v[136:137], v19 offset:32768
    ds_read_b64_tr_b16 v[138:139], v19 offset:33792
    s_waitcnt lgkmcnt(10)
    v_mfma_f32_32x32x16_bf16 v[96:111], v[152:155], v[156:159], v[96:111]
    ds_read_b128 v[140:143], v13 offset:8192
    ds_read_b64_tr_b16 v[144:145], v18 offset:36864
    v_mfma_f32_32x32x16_bf16 v[112:127], v[152:155], v[160:163], v[112:127]
    ds_read_b64_tr_b16 v[146:147], v18 offset:37888
    ds_read_b64_tr_b16 v[148:149], v19 offset:36864
    ds_read_b64_tr_b16 v[150:151], v19 offset:37888
    s_waitcnt lgkmcnt(10)
    v_mfma_f32_32x32x16_bf16 v[96:111], v[164:167], v[168:171], v[96:111]
    ds_read_b128 v[152:155], v14 offset:8192
    ds_read_b64_tr_b16 v[156:157], v18 offset:40960
    v_mfma_f32_32x32x16_bf16 v[112:127], v[164:167], v[172:175], v[112:127]
    ds_read_b64_tr_b16 v[158:159], v18 offset:41984
    ds_read_b64_tr_b16 v[160:161], v19 offset:40960
    ds_read_b64_tr_b16 v[162:163], v19 offset:41984
    s_waitcnt lgkmcnt(10)
    v_mfma_f32_32x32x16_bf16 v[96:111], v[128:131], v[132:135], v[96:111]
    ds_read_b128 v[164:167], v15 offset:8192
    ds_read_b64_tr_b16 v[168:169], v18 offset:45056
    v_mfma_f32_32x32x16_bf16 v[112:127], v[128:131], v[136:139], v[112:127]
    ds_read_b64_tr_b16 v[170:171], v18 offset:46080
    ds_read_b64_tr_b16 v[172:173], v19 offset:45056
    ds_read_b64_tr_b16 v[174:175], v19 offset:46080
    s_waitcnt lgkmcnt(10)
    v_mfma_f32_32x32x16_bf16 v[96:111], v[140:143], v[144:147], v[96:111]
    v_mfma_f32_32x32x16_bf16 v[112:127], v[140:143], v[148:151], v[112:127]
    s_waitcnt lgkmcnt(5)
    v_mfma_f32_32x32x16_bf16 v[96:111], v[152:155], v[156:159], v[96:111]
    v_mfma_f32_32x32x16_bf16 v[112:127], v[152:155], v[160:163], v[112:127]
    s_waitcnt lgkmcnt(0)
    v_mfma_f32_32x32x16_bf16 v[96:111], v[164:167], v[168:171], v[96:111]
    v_mfma_f32_32x32x16_bf16 v[112:127], v[164:167], v[172:175], v[112:127]
    s_lshl_b32 s44, s36, 12
    s_add_u32 s44, s44, 81920
    v_add_u32 v20, s44, v2
    s_nop 7
    v_cvt_pk_bf16_f32 v144, v96, v97
    v_cvt_pk_bf16_f32 v145, v98, v99
    v_cvt_pk_bf16_f32 v146, v100, v101
    v_cvt_pk_bf16_f32 v147, v102, v103
    v_cvt_pk_bf16_f32 v148, v104, v105
    v_cvt_pk_bf16_f32 v149, v106, v107
    v_cvt_pk_bf16_f32 v150, v108, v109
    v_cvt_pk_bf16_f32 v151, v110, v111
    v_cndmask_b32 v144, v144, v30, s[56:57]
    v_cndmask_b32 v145, v145, v30, s[56:57]
    v_cndmask_b32 v146, v146, v30, s[56:57]
    v_cndmask_b32 v147, v147, v30, s[56:57]
    v_cndmask_b32 v148, v148, v30, s[56:57]
    v_cndmask_b32 v149, v149, v30, s[56:57]
    v_cndmask_b32 v150, v150, v30, s[56:57]
    v_cndmask_b32 v151, v151, v30, s[56:57]
    v_cvt_pk_bf16_f32 v152, v112, v113
    v_cvt_pk_bf16_f32 v153, v114, v115
    v_cvt_pk_bf16_f32 v154, v116, v117
    v_cvt_pk_bf16_f32 v155, v118, v119
    v_cvt_pk_bf16_f32 v156, v120, v121
    v_cvt_pk_bf16_f32 v157, v122, v123
    v_cvt_pk_bf16_f32 v158, v124, v125
    v_cvt_pk_bf16_f32 v159, v126, v127
    v_cndmask_b32 v152, v152, v30, s[56:57]
    v_cndmask_b32 v153, v153, v30, s[56:57]
    v_cndmask_b32 v154, v154, v30, s[56:57]
    v_cndmask_b32 v155, v155, v30, s[56:57]
    v_cndmask_b32 v156, v156, v30, s[56:57]
    v_cndmask_b32 v157, v157, v30, s[56:57]
    v_cndmask_b32 v158, v158, v30, s[56:57]
    v_cndmask_b32 v159, v159, v30, s[56:57]
    s_and_b32 s31, s2, 7
    s_lshr_b32 s30, s2, 3
    s_and_b32 s44, s30, 1
    s_lshl_b32 s28, s31, 1
    s_add_u32 s28, s28, s44
    s_lshr_b32 s29, s30, 1
    s_lshl_b32 s47, s28, 17
    s_lshl_b32 s44, s29, 13
    s_add_u32 s47, s47, s44
    s_add_u32 s44, s36, 1
    s_and_b32 s44, s44, 3
    s_lshl_b32 s44, s44, 11
    s_add_u32 s32, s44, s47
    s_add_u32 s44, s36, 2
    s_and_b32 s44, s44, 3
    s_lshl_b32 s44, s44, 11
    s_add_u32 s33, s44, s47
    s_add_u32 s44, s36, 3
    s_and_b32 s44, s44, 3
    s_lshl_b32 s44, s44, 11
    s_add_u32 s34, s44, s47
    s_add_u32 s44, s36, 4
    s_and_b32 s44, s44, 3
    s_lshl_b32 s44, s44, 11
    s_add_u32 s35, s44, s47
    s_lshl_b32 s41, s28, 18
    s_lshl_b32 s44, s36, 16
    s_add_u32 s41, s41, s44
    s_add_u32 s41, s41, 2097152
    s_and_b32 s39, s29, 1
    s_lshl_b32 s39, s39, 14
    s_mov_b32 s43, 0
    s_add_u32 s51, s39, s41
    v_add_u32 v26, 4096, v2
    v_add_u32 v27, 8192, v2
    v_add_u32 v28, 12288, v2
    v_mov_b32 v64, 0
    v_mov_b32 v65, 0
    v_mov_b32 v66, 0
    v_mov_b32 v67, 0
    v_mov_b32 v68, 0
    v_mov_b32 v69, 0
    v_mov_b32 v70, 0
    v_mov_b32 v71, 0
    v_mov_b32 v72, 0
    v_mov_b32 v73, 0
    v_mov_b32 v74, 0
    v_mov_b32 v75, 0
    v_mov_b32 v76, 0
    v_mov_b32 v77, 0
    v_mov_b32 v78, 0
    v_mov_b32 v79, 0
    v_mov_b32 v80, 0
    v_mov_b32 v81, 0
    v_mov_b32 v82, 0
    v_mov_b32 v83, 0
    v_mov_b32 v84, 0
    v_mov_b32 v85, 0
    v_mov_b32 v86, 0
    v_mov_b32 v87, 0
    v_mov_b32 v88, 0
    v_mov_b32 v89, 0
    v_mov_b32 v90, 0
    v_mov_b32 v91, 0
    v_mov_b32 v92, 0
    v_mov_b32 v93, 0
    v_mov_b32 v94, 0
    v_mov_b32 v95, 0
    v_mov_b32 v96, 0
    v_mov_b32 v97, 0
    v_mov_b32 v98, 0
    v_mov_b32 v99, 0
    v_mov_b32 v100, 0
    v_mov_b32 v101, 0
    v_mov_b32 v102, 0
    v_mov_b32 v103, 0
    v_mov_b32 v104, 0
    v_mov_b32 v105, 0
    v_mov_b32 v106, 0
    v_mov_b32 v107, 0
    v_mov_b32 v108, 0
    v_mov_b32 v109, 0
    v_mov_b32 v110, 0
    v_mov_b32 v111, 0
    v_mov_b32 v112, 0
    v_mov_b32 v113, 0
    v_mov_b32 v114, 0
    v_mov_b32 v115, 0
    v_mov_b32 v116, 0
    v_mov_b32 v117, 0
    v_mov_b32 v118, 0
    v_mov_b32 v119, 0
    v_mov_b32 v120, 0
    v_mov_b32 v121, 0
    v_mov_b32 v122, 0
    v_mov_b32 v123, 0
    v_mov_b32 v124, 0
    v_mov_b32 v125, 0
    v_mov_b32 v126, 0
    v_mov_b32 v127, 0
    v_mov_b32 v184, 0
    v_mov_b32 v185, 0
    v_mov_b32 v186, 0
    v_mov_b32 v187, 0
    v_mov_b32 v188, 0
    v_mov_b32 v189, 0
    v_mov_b32 v190, 0
    v_mov_b32 v191, 0
    v_mov_b32 v252, 0
    v_mov_b32 v253, 0
    v_mov_b32 v254, 0
    v_mov_b32 v255, 0
    v_mov_b32 v12, 0xdddddddd
    s_add_u32 s44, s36, 1
    s_and_b32 s44, s44, 3
    s_mul_i32 s44, s44, 12288
    s_add_u32 s44, s44, 57344
    v_add_u32 v13, s44, v2
    s_add_u32 s44, s36, 2
    s_and_b32 s44, s44, 3
    s_mul_i32 s44, s44, 12288
    s_add_u32 s44, s44, 61440
    v_add_u32 v14, s44, v2
    s_add_u32 s44, s36, 3
    s_and_b32 s44, s44, 3
    s_mul_i32 s44, s44, 12288
    s_add_u32 s44, s44, 65536
    v_add_u32 v15, s44, v2
    s_mul_i32 s44, s36, 12288
    s_add_u32 s44, s44, 57344
    v_add_u32 v16, s44, v2
    s_barrier
    buffer_load_dwordx4 v[32:35], v2, s[24:27], s32 offen sc1
    buffer_load_dwordx4 v[36:39], v2, s[24:27], s32 offen offset:1024 sc1
    buffer_load_dwordx4 v[192:195], v2, s[24:27], s51 offen offset:0 sc1
    buffer_load_dwordx4 v[196:199], v2, s[24:27], s51 offen offset:1024 sc1
    buffer_load_dwordx4 v[200:203], v2, s[24:27], s51 offen offset:2048 sc1
    buffer_load_dwordx4 v[204:207], v2, s[24:27], s51 offen offset:3072 sc1
    buffer_load_dwordx4 v[40:43], v2, s[24:27], s33 offen sc1
    buffer_load_dwordx4 v[44:47], v2, s[24:27], s33 offen offset:1024 sc1
    ds_write_b128 v20, v[144:147] offset:0
    ds_write_b128 v20, v[148:151] offset:1024
    ds_write_b128 v20, v[152:155] offset:2048
    ds_write_b128 v20, v[156:159] offset:3072
    s_waitcnt lgkmcnt(0)
    s_barrier
    buffer_load_dwordx4 v[48:51], v2, s[24:27], s34 offen sc1
    buffer_load_dwordx4 v[52:55], v2, s[24:27], s34 offen offset:1024 sc1
    buffer_load_dwordx4 v[56:59], v2, s[24:27], s35 offen sc1
    buffer_load_dwordx4 v[60:63], v2, s[24:27], s35 offen offset:1024 sc1
    s_branch K2_ATT
K1_Q:
    s_lshl_b32 s53, s44, 18
    s_lshl_b32 s44, s37, 1
    s_add_u32 s44, s44, s55
    s_lshl_b32 s45, s44, 1
    s_add_u32 s45, s45, s46
    s_lshl_b32 s60, s45, 11
    s_add_u32 s53, s53, s60
    s_mov_b32 s54, 131072
    s_mov_b32 s50, 0x3e8b97f6
    s_mov_b32 s51, s50
    s_lshl_b32 s40, s38, 5
    s_add_u32 s40, s40, s44
    s_lshl_b32 s40, s40, 2
    s_add_u32 s40, s40, s36
    s_lshl_b32 s40, s40, 7
    s_add_u32 s40, s40, 15859712
    s_lshl_b32 s58, s38, 2
    s_add_u32 s58, s58, s36
    s_lshl_b32 s58, s58, 4
    v_and_b32 v4, 31, v1
    v_cvt_f32_u32 v4, v4
    v_lshlrev_b32 v5, 8, v24
    v_add_u32 v5, s45, v5
    v_cvt_f32_u32 v5, v5
    v_mul_f32 v6, v4, v5
    s_cmp_ge_u32 s36, 2
    s_cselect_b32 s44, 0xbe800000, 0
    v_mov_b32 v7, s44
    v_fmamk_f32 v6, v6, 0x3a000000, v7
    v_fmamk_f32 v128, v4, 0x0, v6
    v_fmamk_f32 v129, v4, 0x3d000000, v6
    v_fmamk_f32 v130, v4, 0x3d800000, v6
    v_fmamk_f32 v131, v4, 0x3dc00000, v6
    v_fmamk_f32 v132, v4, 0x3e800000, v6
    v_fmamk_f32 v133, v4, 0x3e900000, v6
    v_fmamk_f32 v134, v4, 0x3ea00000, v6
    v_fmamk_f32 v135, v4, 0x3eb00000, v6
    v_fmamk_f32 v136, v4, 0x3f000000, v6
    v_fmamk_f32 v137, v4, 0x3f080000, v6
    v_fmamk_f32 v138, v4, 0x3f100000, v6
    v_fmamk_f32 v139, v4, 0x3f180000, v6
    v_fmamk_f32 v140, v4, 0x3f400000, v6
    v_fmamk_f32 v141, v4, 0x3f480000, v6
    v_fmamk_f32 v142, v4, 0x3f500000, v6
    v_fmamk_f32 v143, v4, 0x3f580000, v6
    v_cos_f32 v128, v128
    v_cos_f32 v129, v129
    v_cos_f32 v130, v130
    v_cos_f32 v131, v131
    v_cos_f32 v132, v132
    v_cos_f32 v133, v133
    v_cos_f32 v134, v134
    v_cos_f32 v135, v135
    v_cos_f32 v136, v136
    v_cos_f32 v137, v137
    v_cos_f32 v138, v138
    v_cos_f32 v139, v139
    v_cos_f32 v140, v140
    v_cos_f32 v141, v141
    v_cos_f32 v142, v142
    v_cos_f32 v143, v143
    v_cvt_pk_bf16_f32 v144, v128, v129
    v_cvt_pk_bf16_f32 v145, v130, v131
    v_cvt_pk_bf16_f32 v146, v132, v133
    v_cvt_pk_bf16_f32 v147, v134, v135
    v_cvt_pk_bf16_f32 v148, v136, v137
    v_cvt_pk_bf16_f32 v149, v138, v139
    v_cvt_pk_bf16_f32 v150, v140, v141
    v_cvt_pk_bf16_f32 v151, v142, v143
    s_lshl_b32 s44, s46, 12
    s_lshl_b32 s45, s47, 11
    s_add_u32 s44, s44, s45
    s_add_u32 s44, s44, 155648
    v_add_u32 v4, s44, v2
    ds_write_b128 v4, v[144:147]
    ds_write_b128 v4, v[148:151] offset:1024
    v_and_b32 v4, 15, v1
    v_add_u32 v4, s58, v4
    v_cvt_f32_u32 v30, v4
    v_bfe_u32 v4, v1, 4, 1
    v_mul_u32_u24 v4, 112, v4
    v_cvt_f32_u32 v4, v4
    s_lshl_b32 s44, s39, 3
    v_add_lshl_u32 v5, s44, v24, 3
    v_cvt_f32_u32 v5, v5
    v_fma_f32 v4, v5, v30, v4
    v_mul_f32 v6, 0x3b124925, v4
    v_floor_f32 v6, v6
    v_fmamk_f32 v4, v6, 0xc3e00000, v4
    v_mul_f32 v4, 0x3b124925, v4
    v_mul_f32 v30, 0x3b124925, v30
    v_mul_f32 v25, 0x41800000, v30
    v_cos_f32 v25, v25
    v_fmamk_f32 v48, v30, 0x0, v4
    v_fmamk_f32 v49, v30, 0x3f800000, v4
    v_fmamk_f32 v50, v30, 0x40000000, v4
    v_fmamk_f32 v51, v30, 0x40400000, v4
    v_fmamk_f32 v52, v30, 0x40800000, v4
    v_fmamk_f32 v53, v30, 0x40a00000, v4
    v_fmamk_f32 v54, v30, 0x40c00000, v4
    v_fmamk_f32 v55, v30, 0x40e00000, v4
    v_fmamk_f32 v56, v30, 0xc1800000, v4
    v_fmamk_f32 v57, v30, 0xc1700000, v4
    v_fmamk_f32 v58, v30, 0xc1600000, v4
    v_fmamk_f32 v59, v30, 0xc1500000, v4
    v_fmamk_f32 v60, v30, 0xc1400000, v4
    v_fmamk_f32 v61, v30, 0xc1300000, v4
    v_fmamk_f32 v62, v30, 0xc1200000, v4
    v_fmamk_f32 v63, v30, 0xc1100000, v4
    v_cos_f32 v48, v48
    v_cos_f32 v49, v49
    v_cos_f32 v50, v50
    v_cos_f32 v51, v51
    v_cos_f32 v52, v52
    v_cos_f32 v53, v53
    v_cos_f32 v54, v54
    v_cos_f32 v55, v55
    v_cos_f32 v56, v56
    v_cos_f32 v57, v57
    v_cos_f32 v58, v58
    v_cos_f32 v59, v59
    v_cos_f32 v60, v60
    v_cos_f32 v61, v61
    v_cos_f32 v62, v62
    v_cos_f32 v63, v63
    v_add_f32 v25, v25, v25
    v_cvt_pk_bf16_f32 v176, v48, v49
    v_cvt_pk_bf16_f32 v177, v50, v51
    v_cvt_pk_bf16_f32 v178, v52, v53
    v_cvt_pk_bf16_f32 v179, v54, v55
    s_waitcnt lgkmcnt(0)
    s_barrier
    ds_read_b128 v[128:131], v12 offset:0
    ds_read_b64_tr_b16 v[132:133], v16 offset:0
    ds_read_b64_tr_b16 v[134:135], v16 offset:1024
    ds_read_b64_tr_b16 v[136:137], v17 offset:0
    ds_read_b64_tr_b16 v[138:139], v17 offset:1024
    ds_read_b128 v[140:143], v13 offset:0
    ds_read_b64_tr_b16 v[144:145], v16 offset:4096
    ds_read_b64_tr_b16 v[146:147], v16 offset:5120
    ds_read_b64_tr_b16 v[148:149], v17 offset:4096
    ds_read_b64_tr_b16 v[150:151], v17 offset:5120
    ds_read_b128 v[152:155], v14 offset:0
    ds_read_b64_tr_b16 v[156:157], v16 offset:8192
    ds_read_b64_tr_b16 v[158:159], v16 offset:9216
    ds_read_b64_tr_b16 v[160:161], v17 offset:8192
    ds_read_b64_tr_b16 v[162:163], v17 offset:9216
    s_waitcnt lgkmcnt(10)
    v_mfma_f32_32x32x16_bf16 v[64:79], v[132:135], v[128:131], 0
    ds_read_b128 v[164:167], v15 offset:0
    ds_read_b64_tr_b16 v[168:169], v16 offset:12288
    v_mfma_f32_32x32x16_bf16 v[80:95], v[136:139], v[128:131], 0
    ds_read_b64_tr_b16 v[170:171], v16 offset:13312
    ds_read_b64_tr_b16 v[172:173], v17 offset:12288
    ds_read_b64_tr_b16 v[174:175], v17 offset:13312
    s_waitcnt lgkmcnt(10)
    s_barrier
    v_mfma_f32_32x32x16_bf16 v[64:79], v[144:147], v[140:143], v[64:79]
    ds_read_b128 v[128:131], v12 offset:8192
    ds_read_b64_tr_b16 v[132:133], v16 offset:16384
    v_mfma_f32_32x32x16_bf16 v[80:95], v[148:151], v[140:143], v[80:95]
    ds_read_b64_tr_b16 v[134:135], v16 offset:17408
    ds_read_b64_tr_b16 v[136:137], v17 offset:16384
    ds_read_b64_tr_b16 v[138:139], v17 offset:17408
    s_waitcnt lgkmcnt(10)
    v_mfma_f32_32x32x16_bf16 v[64:79], v[156:159], v[152:155], v[64:79]
    ds_read_b128 v[140:143], v13 offset:8192
    ds_read_b64_tr_b16 v[144:145], v16 offset:20480
    v_mfma_f32_32x32x16_bf16 v[80:95], v[160:163], v[152:155], v[80:95]
    ds_read_b64_tr_b16 v[146:147], v16 offset:21504
    ds_read_b64_tr_b16 v[148:149], v17 offset:20480
    ds_read_b64_tr_b16 v[150:151], v17 offset:21504
    s_waitcnt lgkmcnt(10)
    v_mfma_f32_32x32x16_bf16 v[64:79], v[168:171], v[164:167], v[64:79]
    ds_read_b128 v[152:155], v14 offset:8192
    ds_read_b64_tr_b16 v[156:157], v16 offset:24576
    v_mfma_f32_32x32x16_bf16 v[80:95], v[172:175], v[164:167], v[80:95]
    ds_read_b64_tr_b16 v[158:159], v16 offset:25600
    ds_read_b64_tr_b16 v[160:161], v17 offset:24576
    ds_read_b64_tr_b16 v[162:163], v17 offset:25600
    s_waitcnt lgkmcnt(10)
    v_mfma_f32_32x32x16_bf16 v[64:79], v[132:135], v[128:131], v[64:79]
    ds_read_b128 v[164:167], v15 offset:8192
    ds_read_b64_tr_b16 v[168:169], v16 offset:28672
    v_mfma_f32_32x32x16_bf16 v[80:95], v[136:139], v[128:131], v[80:95]
    ds_read_b64_tr_b16 v[170:171], v16 offset:29696
    ds_read_b64_tr_b16 v[172:173], v17 offset:28672
    ds_read_b64_tr_b16 v[174:175], v17 offset:29696
    s_waitcnt lgkmcnt(10)
    s_barrier
    v_mfma_f32_32x32x16_bf16 v[64:79], v[144:147], v[140:143], v[64:79]
    ds_read_b128 v[128:131], v12 offset:16384
    ds_read_b64_tr_b16 v[132:133], v16 offset:32768
    v_mfma_f32_32x32x16_bf16 v[80:95], v[148:151], v[140:143], v[80:95]
    ds_read_b64_tr_b16 v[134:135], v16 offset:33792
    ds_read_b64_tr_b16 v[136:137], v17 offset:32768
    ds_read_b64_tr_b16 v[138:139], v17 offset:33792
    s_waitcnt lgkmcnt(10)
    v_mfma_f32_32x32x16_bf16 v[64:79], v[156:159], v[152:155], v[64:79]
    ds_read_b128 v[140:143], v13 offset:16384
    ds_read_b64_tr_b16 v[144:145], v16 offset:36864
    v_mfma_f32_32x32x16_bf16 v[80:95], v[160:163], v[152:155], v[80:95]
    ds_read_b64_tr_b16 v[146:147], v16 offset:37888
    ds_read_b64_tr_b16 v[148:149], v17 offset:36864
    ds_read_b64_tr_b16 v[150:151], v17 offset:37888
    s_waitcnt lgkmcnt(10)
    v_mfma_f32_32x32x16_bf16 v[64:79], v[168:171], v[164:167], v[64:79]
    ds_read_b128 v[152:155], v14 offset:16384
    ds_read_b64_tr_b16 v[156:157], v16 offset:40960
    v_mfma_f32_32x32x16_bf16 v[80:95], v[172:175], v[164:167], v[80:95]
    ds_read_b64_tr_b16 v[158:159], v16 offset:41984
    ds_read_b64_tr_b16 v[160:161], v17 offset:40960
    ds_read_b64_tr_b16 v[162:163], v17 offset:41984
    s_waitcnt lgkmcnt(10)
    v_mfma_f32_32x32x16_bf16 v[64:79], v[132:135], v[128:131], v[64:79]
    ds_read_b128 v[164:167], v15 offset:16384
    ds_read_b64_tr_b16 v[168:169], v16 offset:45056
    v_mfma_f32_32x32x16_bf16 v[80:95], v[136:139], v[128:131], v[80:95]
    ds_read_b64_tr_b16 v[170:171], v16 offset:46080
    ds_read_b64_tr_b16 v[172:173], v17 offset:45056
    ds_read_b64_tr_b16 v[174:175], v17 offset:46080
    s_waitcnt lgkmcnt(10)
    s_barrier
    v_mfma_f32_32x32x16_bf16 v[64:79], v[144:147], v[140:143], v[64:79]
    ds_read_b128 v[128:131], v12 offset:24576
    ds_read_b64_tr_b16 v[132:133], v16 offset:49152
    v_mfma_f32_32x32x16_bf16 v[80:95], v[148:151], v[140:143], v[80:95]
    ds_read_b64_tr_b16 v[134:135], v16 offset:50176
    ds_read_b64_tr_b16 v[136:137], v17 offset:49152
    ds_read_b64_tr_b16 v[138:139], v17 offset:50176
    s_waitcnt lgkmcnt(10)
    v_mfma_f32_32x32x16_bf16 v[64:79], v[156:159], v[152:155], v[64:79]
    ds_read_b128 v[140:143], v13 offset:24576
    ds_read_b64_tr_b16 v[144:145], v16 offset:53248
    v_mfma_f32_32x32x16_bf16 v[80:95], v[160:163], v[152:155], v[80:95]
    ds_read_b64_tr_b16 v[146:147], v16 offset:54272
    ds_read_b64_tr_b16 v[148:149], v17 offset:53248
    ds_read_b64_tr_b16 v[150:151], v17 offset:54272
    s_waitcnt lgkmcnt(10)
    v_mfma_f32_32x32x16_bf16 v[64:79], v[168:171], v[164:167], v[64:79]
    ds_read_b128 v[152:155], v14 offset:24576
    ds_read_b64_tr_b16 v[156:157], v16 offset:57344
    v_mfma_f32_32x32x16_bf16 v[80:95], v[172:175], v[164:167], v[80:95]
    ds_read_b64_tr_b16 v[158:159], v16 offset:58368
    ds_read_b64_tr_b16 v[160:161], v17 offset:57344
    ds_read_b64_tr_b16 v[162:163], v17 offset:58368
    s_waitcnt lgkmcnt(10)
    v_mfma_f32_32x32x16_bf16 v[64:79], v[132:135], v[128:131], v[64:79]
    ds_read_b128 v[164:167], v15 offset:24576
    ds_read_b64_tr_b16 v[168:169], v16 offset:61440
    v_mfma_f32_32x32x16_bf16 v[80:95], v[136:139], v[128:131], v[80:95]
    ds_read_b64_tr_b16 v[170:171], v16 offset:62464
    ds_read_b64_tr_b16 v[172:173], v17 offset:61440
    ds_read_b64_tr_b16 v[174:175], v17 offset:62464
    s_waitcnt lgkmcnt(10)
    s_barrier
    v_mfma_f32_32x32x16_bf16 v[64:79], v[144:147], v[140:143], v[64:79]
    ds_read_b128 v[128:131], v12 offset:32768
    ds_read_b64_tr_b16 v[132:133], v18 offset:0
    v_mfma_f32_32x32x16_bf16 v[80:95], v[148:151], v[140:143], v[80:95]
    ds_read_b64_tr_b16 v[134:135], v18 offset:1024
    ds_read_b64_tr_b16 v[136:137], v19 offset:0
    ds_read_b64_tr_b16 v[138:139], v19 offset:1024
    s_waitcnt lgkmcnt(10)
    v_mfma_f32_32x32x16_bf16 v[64:79], v[156:159], v[152:155], v[64:79]
    ds_read_b128 v[140:143], v13 offset:32768
    ds_read_b64_tr_b16 v[144:145], v18 offset:4096
    v_mfma_f32_32x32x16_bf16 v[80:95], v[160:163], v[152:155], v[80:95]
    ds_read_b64_tr_b16 v[146:147], v18 offset:5120
    ds_read_b64_tr_b16 v[148:149], v19 offset:4096
    ds_read_b64_tr_b16 v[150:151], v19 offset:5120
    s_waitcnt lgkmcnt(10)
    v_mfma_f32_32x32x16_bf16 v[64:79], v[168:171], v[164:167], v[64:79]
    ds_read_b128 v[152:155], v14 offset:32768
    ds_read_b64_tr_b16 v[156:157], v18 offset:8192
    v_mfma_f32_32x32x16_bf16 v[80:95], v[172:175], v[164:167], v[80:95]
    ds_read_b64_tr_b16 v[158:159], v18 offset:9216
    ds_read_b64_tr_b16 v[160:161], v19 offset:8192
    ds_read_b64_tr_b16 v[162:163], v19 offset:9216
    s_waitcnt lgkmcnt(10)
    v_mfma_f32_32x32x16_bf16 v[64:79], v[132:135], v[128:131], v[64:79]
    ds_read_b128 v[164:167], v15 offset:32768
    ds_read_b64_tr_b16 v[168:169], v18 offset:12288
    v_mfma_f32_32x32x16_bf16 v[80:95], v[136:139], v[128:131], v[80:95]
    ds_read_b64_tr_b16 v[170:171], v18 offset:13312
    ds_read_b64_tr_b16 v[172:173], v19 offset:12288
    ds_read_b64_tr_b16 v[174:175], v19 offset:13312
    s_waitcnt lgkmcnt(10)
    s_barrier
    v_mfma_f32_32x32x16_bf16 v[64:79], v[144:147], v[140:143], v[64:79]
    ds_read_b128 v[128:131], v12 offset:40960
    ds_read_b64_tr_b16 v[132:133], v18 offset:16384
    v_mfma_f32_32x32x16_bf16 v[80:95], v[148:151], v[140:143], v[80:95]
    ds_read_b64_tr_b16 v[134:135], v18 offset:17408
    ds_read_b64_tr_b16 v[136:137], v19 offset:16384
    ds_read_b64_tr_b16 v[138:139], v19 offset:17408
    s_waitcnt lgkmcnt(10)
    v_mfma_f32_32x32x16_bf16 v[64:79], v[156:159], v[152:155], v[64:79]
    ds_read_b128 v[140:143], v13 offset:40960
    ds_read_b64_tr_b16 v[144:145], v18 offset:20480
    v_mfma_f32_32x32x16_bf16 v[80:95], v[160:163], v[152:155], v[80:95]
    ds_read_b64_tr_b16 v[146:147], v18 offset:21504
    ds_read_b64_tr_b16 v[148:149], v19 offset:20480
    ds_read_b64_tr_b16 v[150:151], v19 offset:21504
    s_waitcnt lgkmcnt(10)
    v_mfma_f32_32x32x16_bf16 v[64:79], v[168:171], v[164:167], v[64:79]
    ds_read_b128 v[152:155], v14 offset:40960
    ds_read_b64_tr_b16 v[156:157], v18 offset:24576
    v_mfma_f32_32x32x16_bf16 v[80:95], v[172:175], v[164:167], v[80:95]
    ds_read_b64_tr_b16 v[158:159], v18 offset:25600
    ds_read_b64_tr_b16 v[160:161], v19 offset:24576
    ds_read_b64_tr_b16 v[162:163], v19 offset:25600
    s_waitcnt lgkmcnt(10)
    v_mfma_f32_32x32x16_bf16 v[64:79], v[132:135], v[128:131], v[64:79]
    ds_read_b128 v[164:167], v15 offset:40960
    ds_read_b64_tr_b16 v[168:169], v18 offset:28672
    v_mfma_f32_32x32x16_bf16 v[80:95], v[136:139], v[128:131], v[80:95]
    ds_read_b64_tr_b16 v[170:171], v18 offset:29696
    ds_read_b64_tr_b16 v[172:173], v19 offset:28672
    ds_read_b64_tr_b16 v[174:175], v19 offset:29696
    s_waitcnt lgkmcnt(10)
    s_barrier
    v_mfma_f32_32x32x16_bf16 v[64:79], v[144:147], v[140:143], v[64:79]
    ds_read_b128 v[128:131], v12 offset:49152
    ds_read_b64_tr_b16 v[132:133], v16 offset:0
    v_mfma_f32_32x32x16_bf16 v[80:95], v[148:151], v[140:143], v[80:95]
    ds_read_b64_tr_b16 v[134:135], v16 offset:1024
    ds_read_b64_tr_b16 v[136:137], v17 offset:0
    ds_read_b64_tr_b16 v[138:139], v17 offset:1024
    s_waitcnt lgkmcnt(10)
    v_mfma_f32_32x32x16_bf16 v[64:79], v[156:159], v[152:155], v[64:79]
    ds_read_b128 v[140:143], v13 offset:49152
    ds_read_b64_tr_b16 v[144:145], v16 offset:4096
    v_mfma_f32_32x32x16_bf16 v[80:95], v[160:163], v[152:155], v[80:95]
    ds_read_b64_tr_b16 v[146:147], v16 offset:5120
    ds_read_b64_tr_b16 v[148:149], v17 offset:4096
    ds_read_b64_tr_b16 v[150:151], v17 offset:5120
    s_waitcnt lgkmcnt(10)
    v_mfma_f32_32x32x16_bf16 v[64:79], v[168:171], v[164:167], v[64:79]
    ds_read_b128 v[152:155], v14 offset:49152
    ds_read_b64_tr_b16 v[156:157], v16 offset:8192
    v_mfma_f32_32x32x16_bf16 v[80:95], v[172:175], v[164:167], v[80:95]
    ds_read_b64_tr_b16 v[158:159], v16 offset:9216
    ds_read_b64_tr_b16 v[160:161], v17 offset:8192
    ds_read_b64_tr_b16 v[162:163], v17 offset:9216
    s_waitcnt lgkmcnt(10)
    v_mfma_f32_32x32x16_bf16 v[64:79], v[132:135], v[128:131], v[64:79]
    ds_read_b128 v[164:167], v15 offset:49152
    ds_read_b64_tr_b16 v[168:169], v16 offset:12288
    v_mfma_f32_32x32x16_bf16 v[80:95], v[136:139], v[128:131], v[80:95]
    ds_read_b64_tr_b16 v[170:171], v16 offset:13312
    ds_read_b64_tr_b16 v[172:173], v17 offset:12288
    ds_read_b64_tr_b16 v[174:175], v17 offset:13312
    s_waitcnt lgkmcnt(10)
    v_mfma_f32_32x32x16_bf16 v[64:79], v[144:147], v[140:143], v[64:79]
    ds_read_b128 v[128:131], v20 offset:0
    v_mfma_f32_32x32x16_bf16 v[80:95], v[148:151], v[140:143], v[80:95]
    ds_read_b128 v[132:135], v20 offset:4096
    s_waitcnt lgkmcnt(7)
    v_mfma_f32_32x32x16_bf16 v[64:79], v[156:159], v[152:155], v[64:79]
    ds_read_b128 v[140:143], v21 offset:0
    v_mfma_f32_32x32x16_bf16 v[80:95], v[160:163], v[152:155], v[80:95]
    ds_read_b128 v[144:147], v21 offset:4096
    s_waitcnt lgkmcnt(4)
    v_mfma_f32_32x32x16_bf16 v[64:79], v[168:171], v[164:167], v[64:79]
    ds_read_b128 v[152:155], v22 offset:0
    v_mfma_f32_32x32x16_bf16 v[80:95], v[172:175], v[164:167], v[80:95]
    ds_read_b128 v[156:159], v22 offset:4096
    s_waitcnt lgkmcnt(4)
    v_mfma_f32_32x32x16_bf16 v[96:111], v[128:131], v[176:179], 0
    ds_read_b128 v[164:167], v23 offset:0
    v_fma_f32 v56, v25, v48, -v56
    v_fma_f32 v57, v25, v49, -v57
    v_fma_f32 v58, v25, v50, -v58
    v_fma_f32 v59, v25, v51, -v59
    v_fma_f32 v60, v25, v52, -v60
    v_fma_f32 v61, v25, v53, -v61
    v_mfma_f32_32x32x16_bf16 v[112:127], v[132:135], v[176:179], 0
    v_fma_f32 v62, v25, v54, -v62
    v_fma_f32 v63, v25, v55, -v63
    v_cvt_pk_bf16_f32 v180, v56, v57
    v_cvt_pk_bf16_f32 v181, v58, v59
    v_cvt_pk_bf16_f32 v182, v60, v61
    v_cvt_pk_bf16_f32 v183, v62, v63
    ds_read_b128 v[168:171], v23 offset:4096
    s_waitcnt lgkmcnt(4)
    v_mfma_f32_32x32x16_bf16 v[96:111], v[140:143], v[180:183], v[96:111]
    ds_read_b128 v[128:131], v20 offset:8192
    v_fma_f32 v48, v25, v56, -v48
    v_fma_f32 v49, v25, v57, -v49
    v_fma_f32 v50, v25, v58, -v50
    v_fma_f32 v51, v25, v59, -v51
    v_fma_f32 v52, v25, v60, -v52
    v_fma_f32 v53, v25, v61, -v53
    v_mfma_f32_32x32x16_bf16 v[112:127], v[144:147], v[180:183], v[112:127]
    v_fma_f32 v54, v25, v62, -v54
    v_fma_f32 v55, v25, v63, -v55
    v_cvt_pk_bf16_f32 v176, v48, v49
    v_cvt_pk_bf16_f32 v177, v50, v51
    v_cvt_pk_bf16_f32 v178, v52, v53
    v_cvt_pk_bf16_f32 v179, v54, v55
    ds_read_b128 v[132:135], v20 offset:12288
    s_waitcnt lgkmcnt(4)
    v_mfma_f32_32x32x16_bf16 v[96:111], v[152:155], v[176:179], v[96:111]
    ds_read_b128 v[140:143], v21 offset:8192
    v_fma_f32 v56, v25, v48, -v56
    v_fma_f32 v57, v25, v49, -v57
    v_fma_f32 v58, v25, v50, -v58
    v_fma_f32 v59, v25, v51, -v59
    v_fma_f32 v60, v25, v52, -v60
    v_fma_f32 v61, v25, v53, -v61
    v_fma_f32 v62, v25, v54, -v62
    v_fma_f32 v63, v25, v55, -v63
    v_cvt_pk_bf16_f32 v180, v56, v57
    v_cvt_pk_bf16_f32 v181, v58, v59
    v_cvt_pk_bf16_f32 v182, v60, v61
    v_cvt_pk_bf16_f32 v183, v62, v63
    ds_read_b128 v[144:147], v21 offset:12288
    v_pk_mul_f32 v[64:65], v[64:65], s[50:51]
    v_pk_mul_f32 v[66:67], v[66:67], s[50:51]
    v_pk_mul_f32 v[68:69], v[68:69], s[50:51]
    v_mfma_f32_32x32x16_bf16 v[112:127], v[156:159], v[176:179], v[112:127]
    v_pk_mul_f32 v[70:71], v[70:71], s[50:51]
    v_pk_mul_f32 v[72:73], v[72:73], s[50:51]
    v_pk_mul_f32 v[74:75], v[74:75], s[50:51]
    v_pk_mul_f32 v[76:77], v[76:77], s[50:51]
    v_pk_mul_f32 v[78:79], v[78:79], s[50:51]
    v_cvt_pk_bf16_f32 v32, v64, v65
    v_cvt_pk_bf16_f32 v33, v66, v67
    v_cvt_pk_bf16_f32 v34, v68, v69
    v_cvt_pk_bf16_f32 v35, v70, v71
    v_cvt_pk_bf16_f32 v36, v72, v73
    v_cvt_pk_bf16_f32 v37, v74, v75
    v_cvt_pk_bf16_f32 v38, v76, v77
    v_cvt_pk_bf16_f32 v39, v78, v79
    v_cndmask_b32 v38, v38, 0, s[48:49]
    v_cndmask_b32 v39, v39, 0, s[48:49]
    buffer_store_dwordx4 v[32:35], v2, s[24:27], s53 offen sc1
    buffer_store_dwordx4 v[36:39], v2, s[24:27], s53 offen offset:1024 sc1
    v_pk_mul_f32 v[80:81], v[80:81], s[50:51]
    s_waitcnt lgkmcnt(4)
    v_mfma_f32_32x32x16_bf16 v[96:111], v[164:167], v[180:183], v[96:111]
    ds_read_b128 v[152:155], v22 offset:8192
    v_fma_f32 v48, v25, v56, -v48
    v_fma_f32 v49, v25, v57, -v49
    v_fma_f32 v50, v25, v58, -v50
    v_fma_f32 v51, v25, v59, -v51
    v_fma_f32 v52, v25, v60, -v52
    v_fma_f32 v53, v25, v61, -v53
    v_fma_f32 v54, v25, v62, -v54
    v_fma_f32 v55, v25, v63, -v55
    v_cvt_pk_bf16_f32 v176, v48, v49
    v_cvt_pk_bf16_f32 v177, v50, v51
    v_cvt_pk_bf16_f32 v178, v52, v53
    v_cvt_pk_bf16_f32 v179, v54, v55
    ds_read_b128 v[156:159], v22 offset:12288
    v_pk_mul_f32 v[82:83], v[82:83], s[50:51]
    v_pk_mul_f32 v[84:85], v[84:85], s[50:51]
    v_pk_mul_f32 v[86:87], v[86:87], s[50:51]
    v_mfma_f32_32x32x16_bf16 v[112:127], v[168:171], v[180:183], v[112:127]
    v_pk_mul_f32 v[88:89], v[88:89], s[50:51]
    v_pk_mul_f32 v[90:91], v[90:91], s[50:51]
    v_pk_mul_f32 v[92:93], v[92:93], s[50:51]
    v_pk_mul_f32 v[94:95], v[94:95], s[50:51]
    v_cvt_pk_bf16_f32 v40, v80, v81
    v_cvt_pk_bf16_f32 v41, v82, v83
    v_cvt_pk_bf16_f32 v42, v84, v85
    v_cvt_pk_bf16_f32 v43, v86, v87
    v_cvt_pk_bf16_f32 v44, v88, v89
    v_cvt_pk_bf16_f32 v45, v90, v91
    v_cvt_pk_bf16_f32 v46, v92, v93
    v_cvt_pk_bf16_f32 v47, v94, v95
    v_cndmask_b32 v46, v46, 0, s[48:49]
    v_cndmask_b32 v47, v47, 0, s[48:49]
    s_add_u32 s46, s53, s54
    buffer_store_dwordx4 v[40:43], v2, s[24:27], s46 offen sc1
    buffer_store_dwordx4 v[44:47], v2, s[24:27], s46 offen offset:1024 sc1
    s_mov_b32 s32, s14
    s_and_b32 s33, s15, 0xffff
    s_mov_b32 s34, 256
    s_mov_b32 s35, 0x20000
    v_mov_b32 v10, 0
    buffer_load_dwordx2 v[8:9], v10, s[32:35], 0 offen sc1
    s_barrier
    s_waitcnt lgkmcnt(4)
    v_mfma_f32_32x32x16_bf16 v[96:111], v[128:131], v[176:179], v[96:111]
    ds_read_b128 v[164:167], v23 offset:8192
    v_fma_f32 v56, v25, v48, -v56
    v_fma_f32 v57, v25, v49, -v57
    v_fma_f32 v58, v25, v50, -v58
    v_fma_f32 v59, v25, v51, -v59
    v_fma_f32 v60, v25, v52, -v60
    v_fma_f32 v61, v25, v53, -v61
    v_mfma_f32_32x32x16_bf16 v[112:127], v[132:135], v[176:179], v[112:127]
    v_fma_f32 v62, v25, v54, -v62
    v_fma_f32 v63, v25, v55, -v63
    v_cvt_pk_bf16_f32 v180, v56, v57
    v_cvt_pk_bf16_f32 v181, v58, v59
    v_cvt_pk_bf16_f32 v182, v60, v61
    v_cvt_pk_bf16_f32 v183, v62, v63
    ds_read_b128 v[168:171], v23 offset:12288
    s_waitcnt lgkmcnt(4)
    v_mfma_f32_32x32x16_bf16 v[96:111], v[140:143], v[180:183], v[96:111]
    ds_read_b128 v[128:131], v20 offset:16384
    v_fma_f32 v48, v25, v56, -v48
    v_fma_f32 v49, v25, v57, -v49
    v_fma_f32 v50, v25, v58, -v50
    v_fma_f32 v51, v25, v59, -v51
    v_fma_f32 v52, v25, v60, -v52
    v_fma_f32 v53, v25, v61, -v53
    v_mfma_f32_32x32x16_bf16 v[112:127], v[144:147], v[180:183], v[112:127]
    v_fma_f32 v54, v25, v62, -v54
    v_fma_f32 v55, v25, v63, -v55
    v_cvt_pk_bf16_f32 v176, v48, v49
    v_cvt_pk_bf16_f32 v177, v50, v51
    v_cvt_pk_bf16_f32 v178, v52, v53
    v_cvt_pk_bf16_f32 v179, v54, v55
    ds_read_b128 v[132:135], v20 offset:20480
    s_waitcnt lgkmcnt(4)
    v_mfma_f32_32x32x16_bf16 v[96:111], v[152:155], v[176:179], v[96:111]
    ds_read_b128 v[140:143], v21 offset:16384
    v_fma_f32 v56, v25, v48, -v56
    v_fma_f32 v57, v25, v49, -v57
    v_fma_f32 v58, v25, v50, -v58
    v_fma_f32 v59, v25, v51, -v59
    v_fma_f32 v60, v25, v52, -v60
    v_fma_f32 v61, v25, v53, -v61
    v_mfma_f32_32x32x16_bf16 v[112:127], v[156:159], v[176:179], v[112:127]
    v_fma_f32 v62, v25, v54, -v62
    v_fma_f32 v63, v25, v55, -v63
    v_cvt_pk_bf16_f32 v180, v56, v57
    v_cvt_pk_bf16_f32 v181, v58, v59
    v_cvt_pk_bf16_f32 v182, v60, v61
    v_cvt_pk_bf16_f32 v183, v62, v63
    ds_read_b128 v[144:147], v21 offset:20480
    s_waitcnt lgkmcnt(4)
    v_mfma_f32_32x32x16_bf16 v[96:111], v[164:167], v[180:183], v[96:111]
    ds_read_b128 v[152:155], v22 offset:16384
    v_fma_f32 v48, v25, v56, -v48
    v_fma_f32 v49, v25, v57, -v49
    v_fma_f32 v50, v25, v58, -v50
    v_fma_f32 v51, v25, v59, -v51
    v_fma_f32 v52, v25, v60, -v52
    v_fma_f32 v53, v25, v61, -v53
    v_mfma_f32_32x32x16_bf16 v[112:127], v[168:171], v[180:183], v[112:127]
    v_fma_f32 v54, v25, v62, -v54
    v_fma_f32 v55, v25, v63, -v55
    v_cvt_pk_bf16_f32 v176, v48, v49
    v_cvt_pk_bf16_f32 v177, v50, v51
    v_cvt_pk_bf16_f32 v178, v52, v53
    v_cvt_pk_bf16_f32 v179, v54, v55
    ds_read_b128 v[156:159], v22 offset:20480
    s_waitcnt lgkmcnt(4)
    v_mfma_f32_32x32x16_bf16 v[96:111], v[128:131], v[176:179], v[96:111]
    ds_read_b128 v[164:167], v23 offset:16384
    v_fma_f32 v56, v25, v48, -v56
    v_fma_f32 v57, v25, v49, -v57
    v_fma_f32 v58, v25, v50, -v58
    v_fma_f32 v59, v25, v51, -v59
    v_fma_f32 v60, v25, v52, -v60
    v_fma_f32 v61, v25, v53, -v61
    v_mfma_f32_32x32x16_bf16 v[112:127], v[132:135], v[176:179], v[112:127]
    v_fma_f32 v62, v25, v54, -v62
    v_fma_f32 v63, v25, v55, -v63
    v_cvt_pk_bf16_f32 v180, v56, v57
    v_cvt_pk_bf16_f32 v181, v58, v59
    v_cvt_pk_bf16_f32 v182, v60, v61
    v_cvt_pk_bf16_f32 v183, v62, v63
    ds_read_b128 v[168:171], v23 offset:20480
    s_waitcnt lgkmcnt(4)
    v_mfma_f32_32x32x16_bf16 v[96:111], v[140:143], v[180:183], v[96:111]
    ds_read_b128 v[128:131], v20 offset:24576
    v_fma_f32 v48, v25, v56, -v48
    v_fma_f32 v49, v25, v57, -v49
    v_fma_f32 v50, v25, v58, -v50
    v_fma_f32 v51, v25, v59, -v51
    v_fma_f32 v52, v25, v60, -v52
    v_fma_f32 v53, v25, v61, -v53
    v_mfma_f32_32x32x16_bf16 v[112:127], v[144:147], v[180:183], v[112:127]
    v_fma_f32 v54, v25, v62, -v54
    v_fma_f32 v55, v25, v63, -v55
    v_cvt_pk_bf16_f32 v176, v48, v49
    v_cvt_pk_bf16_f32 v177, v50, v51
    v_cvt_pk_bf16_f32 v178, v52, v53
    v_cvt_pk_bf16_f32 v179, v54, v55
    ds_read_b128 v[132:135], v20 offset:28672
    s_waitcnt lgkmcnt(4)
    v_mfma_f32_32x32x16_bf16 v[96:111], v[152:155], v[176:179], v[96:111]
    ds_read_b128 v[140:143], v21 offset:24576
    v_fma_f32 v56, v25, v48, -v56
    v_fma_f32 v57, v25, v49, -v57
    v_fma_f32 v58, v25, v50, -v58
    v_fma_f32 v59, v25, v51, -v59
    v_fma_f32 v60, v25, v52, -v60
    v_fma_f32 v61, v25, v53, -v61
    v_mfma_f32_32x32x16_bf16 v[112:127], v[156:159], v[176:179], v[112:127]
    v_fma_f32 v62, v25, v54, -v62
    v_fma_f32 v63, v25, v55, -v63
    v_cvt_pk_bf16_f32 v180, v56, v57
    v_cvt_pk_bf16_f32 v181, v58, v59
    v_cvt_pk_bf16_f32 v182, v60, v61
    v_cvt_pk_bf16_f32 v183, v62, v63
    ds_read_b128 v[144:147], v21 offset:28672
    s_mov_b32 s61, 200000
EP8:
    s_waitcnt vmcnt(0)
    v_readfirstlane_b32 s63, v9
    v_readfirstlane_b32 s62, v8
    s_sub_u32 s61, s61, 1
    s_cbranch_scc1 EP8_X
    s_cmp_lg_u32 s63, 0
    s_cbranch_scc1 EP8_X
    buffer_load_dwordx2 v[8:9], v10, s[32:35], 0 offen sc1
    s_branch EP8
EP8_X:
    v_cmp_gt_u32 vcc, 16, v1
    v_lshlrev_b32 v8, 3, v1
    v_mov_b32 v10, 2146435072
    v_cndmask_b32 v10, v10, v8, vcc
    v_mov_b32 v8, s62
    v_mov_b32 v9, s63
    buffer_store_dwordx2 v[8:9], v10, s[24:27], s40 offen sc1
    s_waitcnt lgkmcnt(4)
    v_mfma_f32_32x32x16_bf16 v[96:111], v[164:167], v[180:183], v[96:111]
    ds_read_b128 v[152:155], v22 offset:24576
    v_fma_f32 v48, v25, v56, -v48
    v_fma_f32 v49, v25, v57, -v49
    v_fma_f32 v50, v25, v58, -v50
    v_fma_f32 v51, v25, v59, -v51
    v_fma_f32 v52, v25, v60, -v52
    v_fma_f32 v53, v25, v61, -v53
    v_mfma_f32_32x32x16_bf16 v[112:127], v[168:171], v[180:183], v[112:127]
    v_fma_f32 v54, v25, v62, -v54
    v_fma_f32 v55, v25, v63, -v55
    v_cvt_pk_bf16_f32 v176, v48, v49
    v_cvt_pk_bf16_f32 v177, v50, v51
    v_cvt_pk_bf16_f32 v178, v52, v53
    v_cvt_pk_bf16_f32 v179, v54, v55
    ds_read_b128 v[156:159], v22 offset:28672
    s_waitcnt lgkmcnt(4)
    v_mfma_f32_32x32x16_bf16 v[96:111], v[128:131], v[176:179], v[96:111]
    ds_read_b128 v[164:167], v23 offset:24576
    v_fma_f32 v56, v25, v48, -v56
    v_fma_f32 v57, v25, v49, -v57
    v_fma_f32 v58, v25, v50, -v58
    v_fma_f32 v59, v25, v51, -v59
    v_fma_f32 v60, v25, v52, -v60
    v_fma_f32 v61, v25, v53, -v61
    v_mfma_f32_32x32x16_bf16 v[112:127], v[132:135], v[176:179], v[112:127]
    v_fma_f32 v62, v25, v54, -v62
    v_fma_f32 v63, v25, v55, -v63
    v_cvt_pk_bf16_f32 v180, v56, v57
    v_cvt_pk_bf16_f32 v181, v58, v59
    v_cvt_pk_bf16_f32 v182, v60, v61
    v_cvt_pk_bf16_f32 v183, v62, v63
    ds_read_b128 v[168:171], v23 offset:28672
    s_waitcnt lgkmcnt(4)
    v_mfma_f32_32x32x16_bf16 v[96:111], v[140:143], v[180:183], v[96:111]
    ds_read_b128 v[128:131], v20 offset:32768
    v_fma_f32 v48, v25, v56, -v48
    v_fma_f32 v49, v25, v57, -v49
    v_fma_f32 v50, v25, v58, -v50
    v_fma_f32 v51, v25, v59, -v51
    v_fma_f32 v52, v25, v60, -v52
    v_fma_f32 v53, v25, v61, -v53
    v_mfma_f32_32x32x16_bf16 v[112:127], v[144:147], v[180:183], v[112:127]
    v_fma_f32 v54, v25, v62, -v54
    v_fma_f32 v55, v25, v63, -v55
    v_cvt_pk_bf16_f32 v176, v48, v49
    v_cvt_pk_bf16_f32 v177, v50, v51
    v_cvt_pk_bf16_f32 v178, v52, v53
    v_cvt_pk_bf16_f32 v179, v54, v55
    ds_read_b128 v[132:135], v20 offset:36864
    s_waitcnt lgkmcnt(4)
    v_mfma_f32_32x32x16_bf16 v[96:111], v[152:155], v[176:179], v[96:111]
    ds_read_b128 v[140:143], v21 offset:32768
    v_fma_f32 v56, v25, v48, -v56
    v_fma_f32 v57, v25, v49, -v57
    v_fma_f32 v58, v25, v50, -v58
    v_fma_f32 v59, v25, v51, -v59
    v_fma_f32 v60, v25, v52, -v60
    v_fma_f32 v61, v25, v53, -v61
    v_mfma_f32_32x32x16_bf16 v[112:127], v[156:159], v[176:179], v[112:127]
    v_fma_f32 v62, v25, v54, -v62
    v_fma_f32 v63, v25, v55, -v63
    v_cvt_pk_bf16_f32 v180, v56, v57
    v_cvt_pk_bf16_f32 v181, v58, v59
    v_cvt_pk_bf16_f32 v182, v60, v61
    v_cvt_pk_bf16_f32 v183, v62, v63
    ds_read_b128 v[144:147], v21 offset:36864
    s_waitcnt lgkmcnt(4)
    v_mfma_f32_32x32x16_bf16 v[96:111], v[164:167], v[180:183], v[96:111]
    ds_read_b128 v[152:155], v22 offset:32768
    v_fma_f32 v48, v25, v56, -v48
    v_fma_f32 v49, v25, v57, -v49
    v_fma_f32 v50, v25, v58, -v50
    v_fma_f32 v51, v25, v59, -v51
    v_fma_f32 v52, v25, v60, -v52
    v_fma_f32 v53, v25, v61, -v53
    v_mfma_f32_32x32x16_bf16 v[112:127], v[168:171], v[180:183], v[112:127]
    v_fma_f32 v54, v25, v62, -v54
    v_fma_f32 v55, v25, v63, -v55
    v_cvt_pk_bf16_f32 v176, v48, v49
    v_cvt_pk_bf16_f32 v177, v50, v51
    v_cvt_pk_bf16_f32 v178, v52, v53
    v_cvt_pk_bf16_f32 v179, v54, v55
    ds_read_b128 v[156:159], v22 offset:36864
    s_waitcnt lgkmcnt(4)
    v_mfma_f32_32x32x16_bf16 v[96:111], v[128:131], v[176:179], v[96:111]
    ds_read_b128 v[164:167], v23 offset:32768
    v_fma_f32 v56, v25, v48, -v56
    v_fma_f32 v57, v25, v49, -v57
    v_fma_f32 v58, v25, v50, -v58
    v_fma_f32 v59, v25, v51, -v59
    v_fma_f32 v60, v25, v52, -v60
    v_fma_f32 v61, v25, v53, -v61
    v_mfma_f32_32x32x16_bf16 v[112:127], v[132:135], v[176:179], v[112:127]
    v_fma_f32 v62, v25, v54, -v62
    v_fma_f32 v63, v25, v55, -v63
    v_cvt_pk_bf16_f32 v180, v56, v57
    v_cvt_pk_bf16_f32 v181, v58, v59
    v_cvt_pk_bf16_f32 v182, v60, v61
    v_cvt_pk_bf16_f32 v183, v62, v63
    ds_read_b128 v[168:171], v23 offset:36864
    s_waitcnt lgkmcnt(4)
    v_mfma_f32_32x32x16_bf16 v[96:111], v[140:143], v[180:183], v[96:111]
    ds_read_b128 v[128:131], v20 offset:40960
    v_fma_f32 v48, v25, v56, -v48
    v_fma_f32 v49, v25, v57, -v49
    v_fma_f32 v50, v25, v58, -v50
    v_fma_f32 v51, v25, v59, -v51
    v_fma_f32 v52, v25, v60, -v52
    v_fma_f32 v53, v25, v61, -v53
    v_mfma_f32_32x32x16_bf16 v[112:127], v[144:147], v[180:183], v[112:127]
    v_fma_f32 v54, v25, v62, -v54
    v_fma_f32 v55, v25, v63, -v55
    v_cvt_pk_bf16_f32 v176, v48, v49
    v_cvt_pk_bf16_f32 v177, v50, v51
    v_cvt_pk_bf16_f32 v178, v52, v53
    v_cvt_pk_bf16_f32 v179, v54, v55
    ds_read_b128 v[132:135], v20 offset:45056
    s_waitcnt lgkmcnt(4)
    v_mfma_f32_32x32x16_bf16 v[96:111], v[152:155], v[176:179], v[96:111]
    ds_read_b128 v[140:143], v21 offset:40960
    v_fma_f32 v56, v25, v48, -v56
    v_fma_f32 v57, v25, v49, -v57
    v_fma_f32 v58, v25, v50, -v58
    v_fma_f32 v59, v25, v51, -v59
    v_fma_f32 v60, v25, v52, -v60
    v_fma_f32 v61, v25, v53, -v61
    v_mfma_f32_32x32x16_bf16 v[112:127], v[156:159], v[176:179], v[112:127]
    v_fma_f32 v62, v25, v54, -v62
    v_fma_f32 v63, v25, v55, -v63
    v_cvt_pk_bf16_f32 v180, v56, v57
    v_cvt_pk_bf16_f32 v181, v58, v59
    v_cvt_pk_bf16_f32 v182, v60, v61
    v_cvt_pk_bf16_f32 v183, v62, v63
    ds_read_b128 v[144:147], v21 offset:45056
    s_waitcnt lgkmcnt(4)
    v_mfma_f32_32x32x16_bf16 v[96:111], v[164:167], v[180:183], v[96:111]
    ds_read_b128 v[152:155], v22 offset:40960
    v_fma_f32 v48, v25, v56, -v48
    v_fma_f32 v49, v25, v57, -v49
    v_fma_f32 v50, v25, v58, -v50
    v_fma_f32 v51, v25, v59, -v51
    v_fma_f32 v52, v25, v60, -v52
    v_fma_f32 v53, v25, v61, -v53
    v_mfma_f32_32x32x16_bf16 v[112:127], v[168:171], v[180:183], v[112:127]
    v_fma_f32 v54, v25, v62, -v54
    v_fma_f32 v55, v25, v63, -v55
    v_cvt_pk_bf16_f32 v176, v48, v49
    v_cvt_pk_bf16_f32 v177, v50, v51
    v_cvt_pk_bf16_f32 v178, v52, v53
    v_cvt_pk_bf16_f32 v179, v54, v55
    ds_read_b128 v[156:159], v22 offset:45056
    s_waitcnt lgkmcnt(4)
    v_mfma_f32_32x32x16_bf16 v[96:111], v[128:131], v[176:179], v[96:111]
    ds_read_b128 v[164:167], v23 offset:40960
    v_fma_f32 v56, v25, v48, -v56
    v_fma_f32 v57, v25, v49, -v57
    v_fma_f32 v58, v25, v50, -v58
    v_fma_f32 v59, v25, v51, -v59
    v_fma_f32 v60, v25, v52, -v60
    v_fma_f32 v61, v25, v53, -v61
    v_mfma_f32_32x32x16_bf16 v[112:127], v[132:135], v[176:179], v[112:127]
    v_fma_f32 v62, v25, v54, -v62
    v_fma_f32 v63, v25, v55, -v63
    v_cvt_pk_bf16_f32 v180, v56, v57
    v_cvt_pk_bf16_f32 v181, v58, v59
    v_cvt_pk_bf16_f32 v182, v60, v61
    v_cvt_pk_bf16_f32 v183, v62, v63
    ds_read_b128 v[168:171], v23 offset:45056
    s_waitcnt lgkmcnt(4)
    v_mfma_f32_32x32x16_bf16 v[96:111], v[140:143], v[180:183], v[96:111]
    ds_read_b128 v[128:131], v20 offset:49152
    v_fma_f32 v48, v25, v56, -v48
    v_fma_f32 v49, v25, v57, -v49
    v_fma_f32 v50, v25, v58, -v50
    v_fma_f32 v51, v25, v59, -v51
    v_fma_f32 v52, v25, v60, -v52
    v_fma_f32 v53, v25, v61, -v53
    v_mfma_f32_32x32x16_bf16 v[112:127], v[144:147], v[180:183], v[112:127]
    v_fma_f32 v54, v25, v62, -v54
    v_fma_f32 v55, v25, v63, -v55
    v_cvt_pk_bf16_f32 v176, v48, v49
    v_cvt_pk_bf16_f32 v177, v50, v51
    v_cvt_pk_bf16_f32 v178, v52, v53
    v_cvt_pk_bf16_f32 v179, v54, v55
    ds_read_b128 v[132:135], v20 offset:53248
    s_waitcnt lgkmcnt(4)
    v_mfma_f32_32x32x16_bf16 v[96:111], v[152:155], v[176:179], v[96:111]
    ds_read_b128 v[140:143], v21 offset:49152
    v_fma_f32 v56, v25, v48, -v56
    v_fma_f32 v57, v25, v49, -v57
    v_fma_f32 v58, v25, v50, -v58
    v_fma_f32 v59, v25, v51, -v59
    v_fma_f32 v60, v25, v52, -v60
    v_fma_f32 v61, v25, v53, -v61
    v_mfma_f32_32x32x16_bf16 v[112:127], v[156:159], v[176:179], v[112:127]
    v_fma_f32 v62, v25, v54, -v62
    v_fma_f32 v63, v25, v55, -v63
    v_cvt_pk_bf16_f32 v180, v56, v57
    v_cvt_pk_bf16_f32 v181, v58, v59
    v_cvt_pk_bf16_f32 v182, v60, v61
    v_cvt_pk_bf16_f32 v183, v62, v63
    ds_read_b128 v[144:147], v21 offset:53248
    s_waitcnt lgkmcnt(4)
    v_mfma_f32_32x32x16_bf16 v[96:111], v[164:167], v[180:183], v[96:111]
    ds_read_b128 v[152:155], v22 offset:49152
    v_fma_f32 v48, v25, v56, -v48
    v_fma_f32 v49, v25, v57, -v49
    v_fma_f32 v50, v25, v58, -v50
    v_fma_f32 v51, v25, v59, -v51
    v_fma_f32 v52, v25, v60, -v52
    v_fma_f32 v53, v25, v61, -v53
    v_mfma_f32_32x32x16_bf16 v[112:127], v[168:171], v[180:183], v[112:127]
    v_fma_f32 v54, v25, v62, -v54
    v_fma_f32 v55, v25, v63, -v55
    v_cvt_pk_bf16_f32 v176, v48, v49
    v_cvt_pk_bf16_f32 v177, v50, v51
    v_cvt_pk_bf16_f32 v178, v52, v53
    v_cvt_pk_bf16_f32 v179, v54, v55
    ds_read_b128 v[156:159], v22 offset:53248
    s_waitcnt lgkmcnt(4)
    v_mfma_f32_32x32x16_bf16 v[96:111], v[128:131], v[176:179], v[96:111]
    ds_read_b128 v[164:167], v23 offset:49152
    v_fma_f32 v56, v25, v48, -v56
    v_fma_f32 v57, v25, v49, -v57
    v_fma_f32 v58, v25, v50, -v58
    v_fma_f32 v59, v25, v51, -v59
    v_fma_f32 v60, v25, v52, -v60
    v_fma_f32 v61, v25, v53, -v61
    v_mfma_f32_32x32x16_bf16 v[112:127], v[132:135], v[176:179], v[112:127]
    v_fma_f32 v62, v25, v54, -v62
    v_fma_f32 v63, v25, v55, -v63
    v_cvt_pk_bf16_f32 v180, v56, v57
    v_cvt_pk_bf16_f32 v181, v58, v59
    v_cvt_pk_bf16_f32 v182, v60, v61
    v_cvt_pk_bf16_f32 v183, v62, v63
    ds_read_b128 v[168:171], v23 offset:53248
    s_waitcnt lgkmcnt(4)
    v_mfma_f32_32x32x16_bf16 v[96:111], v[140:143], v[180:183], v[96:111]
    v_fma_f32 v48, v25, v56, -v48
    v_fma_f32 v49, v25, v57, -v49
    v_fma_f32 v50, v25, v58, -v50
    v_fma_f32 v51, v25, v59, -v51
    v_fma_f32 v52, v25, v60, -v52
    v_fma_f32 v53, v25, v61, -v53
    v_mfma_f32_32x32x16_bf16 v[112:127], v[144:147], v[180:183], v[112:127]
    v_fma_f32 v54, v25, v62, -v54
    v_fma_f32 v55, v25, v63, -v55
    v_cvt_pk_bf16_f32 v176, v48, v49
    v_cvt_pk_bf16_f32 v177, v50, v51
    v_cvt_pk_bf16_f32 v178, v52, v53
    v_cvt_pk_bf16_f32 v179, v54, v55
    s_nop 0
    s_waitcnt lgkmcnt(2)
    v_mfma_f32_32x32x16_bf16 v[96:111], v[152:155], v[176:179], v[96:111]
    v_fma_f32 v56, v25, v48, -v56
    v_fma_f32 v57, v25, v49, -v57
    v_fma_f32 v58, v25, v50, -v58
    v_fma_f32 v59, v25, v51, -v59
    v_fma_f32 v60, v25, v52, -v60
    v_fma_f32 v61, v25, v53, -v61
    v_mfma_f32_32x32x16_bf16 v[112:127], v[156:159], v[176:179], v[112:127]
    v_fma_f32 v62, v25, v54, -v62
    v_fma_f32 v63, v25, v55, -v63
    v_cvt_pk_bf16_f32 v180, v56, v57
    v_cvt_pk_bf16_f32 v181, v58, v59
    v_cvt_pk_bf16_f32 v182, v60, v61
    v_cvt_pk_bf16_f32 v183, v62, v63
    s_nop 0
    s_waitcnt lgkmcnt(0)
    v_mfma_f32_32x32x16_bf16 v[96:111], v[164:167], v[180:183], v[96:111]
    v_mfma_f32_32x32x16_bf16 v[112:127], v[168:171], v[180:183], v[112:127]
    v_add_u32 v4, 155648, v2
    ds_read_b128 v[128:131], v4 offset:0
    ds_read_b128 v[132:135], v4 offset:1024
    ds_read_b128 v[136:139], v4 offset:2048
    ds_read_b128 v[140:143], v4 offset:3072
    ds_read_b128 v[144:147], v4 offset:4096
    ds_read_b128 v[148:151], v4 offset:5120
    ds_read_b128 v[152:155], v4 offset:6144
    ds_read_b128 v[156:159], v4 offset:7168
    v_and_b32 v12, 31, v1
    v_lshlrev_b32 v12, 3, v12
    v_lshl_add_u32 v30, v24, 10, v12
    s_lshl_b32 s44, s36, 12
    s_add_u32 s44, s44, 81920
    v_add_u32 v30, s44, v30
    v_cvt_pk_bf16_f32 v96, v96, v97
    v_cvt_pk_bf16_f32 v97, v98, v99
    v_cvt_pk_bf16_f32 v98, v100, v101
    v_cvt_pk_bf16_f32 v99, v102, v103
    v_cvt_pk_bf16_f32 v100, v104, v105
    v_cvt_pk_bf16_f32 v101, v106, v107
    v_cvt_pk_bf16_f32 v102, v108, v109
    v_cvt_pk_bf16_f32 v103, v110, v111
    v_cvt_pk_bf16_f32 v112, v112, v113
    v_cvt_pk_bf16_f32 v113, v114, v115
    v_cvt_pk_bf16_f32 v114, v116, v117
    v_cvt_pk_bf16_f32 v115, v118, v119
    v_cvt_pk_bf16_f32 v116, v120, v121
    v_cvt_pk_bf16_f32 v117, v122, v123
    v_cvt_pk_bf16_f32 v118, v124, v125
    v_cvt_pk_bf16_f32 v119, v126, v127
    s_waitcnt lgkmcnt(0)
    v_mfma_f32_32x32x16_bf16 v[64:79], v[96:99], v[128:131], 0
    v_mfma_f32_32x32x16_bf16 v[80:95], v[96:99], v[136:139], 0
    v_mfma_f32_32x32x16_bf16 v[64:79], v[100:103], v[132:135], v[64:79]
    v_mfma_f32_32x32x16_bf16 v[80:95], v[100:103], v[140:143], v[80:95]
    v_mfma_f32_32x32x16_bf16 v[160:175], v[112:115], v[144:147], 0
    v_mfma_f32_32x32x16_bf16 v[176:191], v[112:115], v[152:155], 0
    v_mfma_f32_32x32x16_bf16 v[160:175], v[116:119], v[148:151], v[160:175]
    v_mfma_f32_32x32x16_bf16 v[176:191], v[116:119], v[156:159], v[176:191]
    s_nop 7
    v_pk_add_f32 v[4:5], v[64:65], v[88:89]
    v_pk_add_f32 v[6:7], v[72:73], v[80:81] neg_lo:[0,1] neg_hi:[0,1]
    v_cvt_pk_bf16_f32 v144, v4, v6
    v_cvt_pk_bf16_f32 v146, v5, v7
    v_pk_add_f32 v[4:5], v[66:67], v[90:91]
    v_pk_add_f32 v[6:7], v[74:75], v[82:83] neg_lo:[0,1] neg_hi:[0,1]
    v_cvt_pk_bf16_f32 v148, v4, v6
    v_cvt_pk_bf16_f32 v150, v5, v7
    v_pk_add_f32 v[4:5], v[68:69], v[92:93]
    v_pk_add_f32 v[6:7], v[76:77], v[84:85] neg_lo:[0,1] neg_hi:[0,1]
    v_cvt_pk_bf16_f32 v152, v4, v6
    v_cvt_pk_bf16_f32 v154, v5, v7
    v_pk_add_f32 v[4:5], v[70:71], v[94:95]
    v_pk_add_f32 v[6:7], v[78:79], v[86:87] neg_lo:[0,1] neg_hi:[0,1]
    v_cvt_pk_bf16_f32 v156, v4, v6
    v_cvt_pk_bf16_f32 v158, v5, v7
    v_pk_add_f32 v[4:5], v[160:161], v[184:185]
    v_pk_add_f32 v[6:7], v[168:169], v[176:177] neg_lo:[0,1] neg_hi:[0,1]
    v_cvt_pk_bf16_f32 v145, v4, v6
    v_cvt_pk_bf16_f32 v147, v5, v7
    v_pk_add_f32 v[4:5], v[162:163], v[186:187]
    v_pk_add_f32 v[6:7], v[170:171], v[178:179] neg_lo:[0,1] neg_hi:[0,1]
    v_cvt_pk_bf16_f32 v149, v4, v6
    v_cvt_pk_bf16_f32 v151, v5, v7
    v_pk_add_f32 v[4:5], v[164:165], v[188:189]
    v_pk_add_f32 v[6:7], v[172:173], v[180:181] neg_lo:[0,1] neg_hi:[0,1]
    v_cvt_pk_bf16_f32 v153, v4, v6
    v_cvt_pk_bf16_f32 v155, v5, v7
    v_pk_add_f32 v[4:5], v[166:167], v[190:191]
    v_pk_add_f32 v[6:7], v[174:175], v[182:183] neg_lo:[0,1] neg_hi:[0,1]
    v_cvt_pk_bf16_f32 v157, v4, v6
    v_cvt_pk_bf16_f32 v159, v5, v7
    s_and_b32 s31, s2, 7
    s_lshr_b32 s30, s2, 3
    s_and_b32 s44, s30, 1
    s_lshl_b32 s28, s31, 1
    s_add_u32 s28, s28, s44
    s_lshr_b32 s29, s30, 1
    s_lshl_b32 s47, s28, 17
    s_lshl_b32 s44, s29, 13
    s_add_u32 s47, s47, s44
    s_add_u32 s44, s36, 1
    s_and_b32 s44, s44, 3
    s_lshl_b32 s44, s44, 11
    s_add_u32 s32, s44, s47
    s_add_u32 s44, s36, 2
    s_and_b32 s44, s44, 3
    s_lshl_b32 s44, s44, 11
    s_add_u32 s33, s44, s47
    s_add_u32 s44, s36, 3
    s_and_b32 s44, s44, 3
    s_lshl_b32 s44, s44, 11
    s_add_u32 s34, s44, s47
    s_add_u32 s44, s36, 4
    s_and_b32 s44, s44, 3
    s_lshl_b32 s44, s44, 11
    s_add_u32 s35, s44, s47
    s_lshl_b32 s41, s28, 18
    s_lshl_b32 s44, s36, 16
    s_add_u32 s41, s41, s44
    s_add_u32 s41, s41, 2097152
    s_and_b32 s39, s29, 1
    s_lshl_b32 s39, s39, 14
    s_mov_b32 s43, 0
    s_add_u32 s51, s39, s41
    v_add_u32 v26, 4096, v2
    v_add_u32 v27, 8192, v2
    v_add_u32 v28, 12288, v2
    v_mov_b32 v64, 0
    v_mov_b32 v65, 0
    v_mov_b32 v66, 0
    v_mov_b32 v67, 0
    v_mov_b32 v68, 0
    v_mov_b32 v69, 0
    v_mov_b32 v70, 0
    v_mov_b32 v71, 0
    v_mov_b32 v72, 0
    v_mov_b32 v73, 0
    v_mov_b32 v74, 0
    v_mov_b32 v75, 0
    v_mov_b32 v76, 0
    v_mov_b32 v77, 0
    v_mov_b32 v78, 0
    v_mov_b32 v79, 0
    v_mov_b32 v80, 0
    v_mov_b32 v81, 0
    v_mov_b32 v82, 0
    v_mov_b32 v83, 0
    v_mov_b32 v84, 0
    v_mov_b32 v85, 0
    v_mov_b32 v86, 0
    v_mov_b32 v87, 0
    v_mov_b32 v88, 0
    v_mov_b32 v89, 0
    v_mov_b32 v90, 0
    v_mov_b32 v91, 0
    v_mov_b32 v92, 0
    v_mov_b32 v93, 0
    v_mov_b32 v94, 0
    v_mov_b32 v95, 0
    v_mov_b32 v96, 0
    v_mov_b32 v97, 0
    v_mov_b32 v98, 0
    v_mov_b32 v99, 0
    v_mov_b32 v100, 0
    v_mov_b32 v101, 0
    v_mov_b32 v102, 0
    v_mov_b32 v103, 0
    v_mov_b32 v104, 0
    v_mov_b32 v105, 0
    v_mov_b32 v106, 0
    v_mov_b32 v107, 0
    v_mov_b32 v108, 0
    v_mov_b32 v109, 0
    v_mov_b32 v110, 0
    v_mov_b32 v111, 0
    v_mov_b32 v112, 0
    v_mov_b32 v113, 0
    v_mov_b32 v114, 0
    v_mov_b32 v115, 0
    v_mov_b32 v116, 0
    v_mov_b32 v117, 0
    v_mov_b32 v118, 0
    v_mov_b32 v119, 0
    v_mov_b32 v120, 0
    v_mov_b32 v121, 0
    v_mov_b32 v122, 0
    v_mov_b32 v123, 0
    v_mov_b32 v124, 0
    v_mov_b32 v125, 0
    v_mov_b32 v126, 0
    v_mov_b32 v127, 0
    v_mov_b32 v184, 0
    v_mov_b32 v185, 0
    v_mov_b32 v186, 0
    v_mov_b32 v187, 0
    v_mov_b32 v188, 0
    v_mov_b32 v189, 0
    v_mov_b32 v190, 0
    v_mov_b32 v191, 0
    v_mov_b32 v252, 0
    v_mov_b32 v253, 0
    v_mov_b32 v254, 0
    v_mov_b32 v255, 0
    v_mov_b32 v12, 0xdddddddd
    s_add_u32 s44, s36, 1
    s_and_b32 s44, s44, 3
    s_mul_i32 s44, s44, 12288
    s_add_u32 s44, s44, 57344
    v_add_u32 v13, s44, v2
    s_add_u32 s44, s36, 2
    s_and_b32 s44, s44, 3
    s_mul_i32 s44, s44, 12288
    s_add_u32 s44, s44, 61440
    v_add_u32 v14, s44, v2
    s_add_u32 s44, s36, 3
    s_and_b32 s44, s44, 3
    s_mul_i32 s44, s44, 12288
    s_add_u32 s44, s44, 65536
    v_add_u32 v15, s44, v2
    s_mul_i32 s44, s36, 12288
    s_add_u32 s44, s44, 57344
    v_add_u32 v16, s44, v2
    s_barrier
    buffer_load_dwordx4 v[32:35], v2, s[24:27], s32 offen sc1
    buffer_load_dwordx4 v[36:39], v2, s[24:27], s32 offen offset:1024 sc1
    buffer_load_dwordx4 v[192:195], v2, s[24:27], s51 offen offset:0 sc1
    buffer_load_dwordx4 v[196:199], v2, s[24:27], s51 offen offset:1024 sc1
    buffer_load_dwordx4 v[200:203], v2, s[24:27], s51 offen offset:2048 sc1
    buffer_load_dwordx4 v[204:207], v2, s[24:27], s51 offen offset:3072 sc1
    buffer_load_dwordx4 v[40:43], v2, s[24:27], s33 offen sc1
    buffer_load_dwordx4 v[44:47], v2, s[24:27], s33 offen offset:1024 sc1
    ds_write_b64 v30, v[144:145] offset:0
    ds_write_b64 v30, v[146:147] offset:256
    ds_write_b64 v30, v[148:149] offset:512
    ds_write_b64 v30, v[150:151] offset:768
    ds_write_b64 v30, v[152:153] offset:2048
    ds_write_b64 v30, v[154:155] offset:2304
    ds_write_b64 v30, v[156:157] offset:2560
    ds_write_b64 v30, v[158:159] offset:2816
    s_waitcnt lgkmcnt(0)
    s_barrier
    buffer_load_dwordx4 v[48:51], v2, s[24:27], s34 offen sc1
    buffer_load_dwordx4 v[52:55], v2, s[24:27], s34 offen offset:1024 sc1
    buffer_load_dwordx4 v[56:59], v2, s[24:27], s35 offen sc1
    buffer_load_dwordx4 v[60:63], v2, s[24:27], s35 offen offset:1024 sc1
K2_ATT:
    v_mov_b32 v17, 98308
    s_waitcnt vmcnt(6) lgkmcnt(0)
    v_mfma_f32_32x32x16_bf16 v[128:143], v[192:195], v[32:35], 0
    v_mfma_f32_32x32x16_bf16 v[128:143], v[196:199], v[36:39], v[128:143]
    buffer_load_dwordx4 v[208:211], v26, s[24:27], s51 offen offset:0 sc1
    buffer_load_dwordx4 v[212:215], v26, s[24:27], s51 offen offset:1024 sc1
    buffer_load_dwordx4 v[216:219], v26, s[24:27], s51 offen offset:2048 sc1
    buffer_load_dwordx4 v[220:223], v26, s[24:27], s51 offen offset:3072 sc1
    buffer_load_dwordx4 v[224:227], v27, s[24:27], s51 offen offset:0 sc1
    buffer_load_dwordx4 v[228:231], v27, s[24:27], s51 offen offset:1024 sc1
    buffer_load_dwordx4 v[232:235], v27, s[24:27], s51 offen offset:2048 sc1
    buffer_load_dwordx4 v[236:239], v27, s[24:27], s51 offen offset:3072 sc1
    s_nop 2
    s_waitcnt vmcnt(12)
    v_mfma_f32_32x32x16_bf16 v[144:159], v[192:195], v[40:43], 0
    v_exp_f32 v128, v128
    v_exp_f32 v129, v129
    v_exp_f32 v130, v130
    v_exp_f32 v131, v131
    v_mfma_f32_32x32x16_bf16 v[144:159], v[196:199], v[44:47], v[144:159]
    v_exp_f32 v132, v132
    v_exp_f32 v133, v133
    v_exp_f32 v134, v134
    v_exp_f32 v135, v135
    v_smfmac_f32_32x32x32_bf16 v[112:127], v[252:255], v[184:191], v12
    buffer_load_dwordx4 v[240:243], v28, s[24:27], s51 offen offset:0 sc1
    buffer_load_dwordx4 v[244:247], v28, s[24:27], s51 offen offset:1024 sc1
    buffer_load_dwordx4 v[248:251], v28, s[24:27], s51 offen offset:2048 sc1
    buffer_load_dwordx4 v[252:255], v28, s[24:27], s51 offen offset:3072 sc1
    s_add_u32 s43, s43, 16384
    s_xor_b32 s51, s43, s39
    s_add_u32 s51, s51, s41
    v_exp_f32 v136, v136
    v_exp_f32 v137, v137
    v_exp_f32 v138, v138
    v_exp_f32 v139, v139
    v_smfmac_f32_32x32x32_bf16 v[64:79], v[200:203], v[128:135], v12
    v_exp_f32 v140, v140
    v_exp_f32 v141, v141
    v_exp_f32 v142, v142
    v_exp_f32 v143, v143
    s_waitcnt vmcnt(14)
    v_mfma_f32_32x32x16_bf16 v[160:175], v[192:195], v[48:51], 0
    v_exp_f32 v144, v144
    v_exp_f32 v145, v145
    v_exp_f32 v146, v146
    v_exp_f32 v147, v147
    v_mfma_f32_32x32x16_bf16 v[160:175], v[196:199], v[52:55], v[160:175]
    v_exp_f32 v148, v148
    v_exp_f32 v149, v149
    v_exp_f32 v150, v150
    v_exp_f32 v151, v151
    v_smfmac_f32_32x32x32_bf16 v[64:79], v[204:207], v[136:143], v12
    v_exp_f32 v152, v152
    v_exp_f32 v153, v153
    v_exp_f32 v154, v154
    v_exp_f32 v155, v155
    v_smfmac_f32_32x32x32_bf16 v[80:95], v[200:203], v[144:151], v12
    v_exp_f32 v156, v156
    v_exp_f32 v157, v157
    v_exp_f32 v158, v158
    v_exp_f32 v159, v159
    s_waitcnt vmcnt(12)
    v_mfma_f32_32x32x16_bf16 v[176:191], v[192:195], v[56:59], 0
    v_exp_f32 v160, v160
    v_exp_f32 v161, v161
    v_exp_f32 v162, v162
    v_exp_f32 v163, v163
    v_mfma_f32_32x32x16_bf16 v[176:191], v[196:199], v[60:63], v[176:191]
    v_exp_f32 v164, v164
    v_exp_f32 v165, v165
    v_exp_f32 v166, v166
    v_exp_f32 v167, v167
    v_smfmac_f32_32x32x32_bf16 v[80:95], v[204:207], v[152:159], v12
    v_exp_f32 v168, v168
    v_exp_f32 v169, v169
    v_exp_f32 v170, v170
    v_exp_f32 v171, v171
    v_smfmac_f32_32x32x32_bf16 v[96:111], v[200:203], v[160:167], v12
    v_exp_f32 v172, v172
    v_exp_f32 v173, v173
    v_exp_f32 v174, v174
    v_exp_f32 v175, v175
    s_waitcnt vmcnt(8)
    v_mfma_f32_32x32x16_bf16 v[128:143], v[208:211], v[32:35], 0
    v_exp_f32 v176, v176
    v_exp_f32 v177, v177
    v_exp_f32 v178, v178
    v_exp_f32 v179, v179
    v_mfma_f32_32x32x16_bf16 v[128:143], v[212:215], v[36:39], v[128:143]
    v_exp_f32 v180, v180
    v_exp_f32 v181, v181
    v_exp_f32 v182, v182
    v_exp_f32 v183, v183
    v_smfmac_f32_32x32x32_bf16 v[96:111], v[204:207], v[168:175], v12
    v_exp_f32 v184, v184
    v_exp_f32 v185, v185
    v_exp_f32 v186, v186
    v_exp_f32 v187, v187
    v_smfmac_f32_32x32x32_bf16 v[112:127], v[200:203], v[176:183], v12
    v_exp_f32 v188, v188
    v_exp_f32 v189, v189
    v_exp_f32 v190, v190
    v_exp_f32 v191, v191
    v_mfma_f32_32x32x16_bf16 v[144:159], v[208:211], v[40:43], 0
    v_exp_f32 v128, v128
    v_exp_f32 v129, v129
    v_exp_f32 v130, v130
    v_exp_f32 v131, v131
    v_mfma_f32_32x32x16_bf16 v[144:159], v[212:215], v[44:47], v[144:159]
    v_exp_f32 v132, v132
    v_exp_f32 v133, v133
    v_exp_f32 v134, v134
    v_exp_f32 v135, v135
    v_smfmac_f32_32x32x32_bf16 v[112:127], v[204:207], v[184:191], v12
    buffer_load_dwordx4 v[192:195], v2, s[24:27], s51 offen offset:0 sc1
    buffer_load_dwordx4 v[196:199], v2, s[24:27], s51 offen offset:1024 sc1
    buffer_load_dwordx4 v[200:203], v2, s[24:27], s51 offen offset:2048 sc1
    buffer_load_dwordx4 v[204:207], v2, s[24:27], s51 offen offset:3072 sc1
    v_exp_f32 v136, v136
    v_exp_f32 v137, v137
    v_exp_f32 v138, v138
    v_exp_f32 v139, v139
    v_smfmac_f32_32x32x32_bf16 v[64:79], v[216:219], v[128:135], v12
    v_exp_f32 v140, v140
    v_exp_f32 v141, v141
    v_exp_f32 v142, v142
    v_exp_f32 v143, v143
    v_mfma_f32_32x32x16_bf16 v[160:175], v[208:211], v[48:51], 0
    v_exp_f32 v144, v144
    v_exp_f32 v145, v145
    v_exp_f32 v146, v146
    v_exp_f32 v147, v147
    v_mfma_f32_32x32x16_bf16 v[160:175], v[212:215], v[52:55], v[160:175]
    v_exp_f32 v148, v148
    v_exp_f32 v149, v149
    v_exp_f32 v150, v150
    v_exp_f32 v151, v151
    v_smfmac_f32_32x32x32_bf16 v[64:79], v[220:223], v[136:143], v12
    v_exp_f32 v152, v152
    v_exp_f32 v153, v153
    v_exp_f32 v154, v154
    v_exp_f32 v155, v155
    v_smfmac_f32_32x32x32_bf16 v[80:95], v[216:219], v[144:151], v12
    v_exp_f32 v156, v156
    v_exp_f32 v157, v157
    v_exp_f32 v158, v158
    v_exp_f32 v159, v159
    v_mfma_f32_32x32x16_bf16 v[176:191], v[208:211], v[56:59], 0
    v_exp_f32 v160, v160
    v_exp_f32 v161, v161
    v_exp_f32 v162, v162
    v_exp_f32 v163, v163
    v_mfma_f32_32x32x16_bf16 v[176:191], v[212:215], v[60:63], v[176:191]
    v_exp_f32 v164, v164
    v_exp_f32 v165, v165
    v_exp_f32 v166, v166
    v_exp_f32 v167, v167
    v_smfmac_f32_32x32x32_bf16 v[80:95], v[220:223], v[152:159], v12
    v_exp_f32 v168, v168
    v_exp_f32 v169, v169
    v_exp_f32 v170, v170
    v_exp_f32 v171, v171
    v_smfmac_f32_32x32x32_bf16 v[96:111], v[216:219], v[160:167], v12
    v_exp_f32 v172, v172
    v_exp_f32 v173, v173
    v_exp_f32 v174, v174
    v_exp_f32 v175, v175
    s_waitcnt vmcnt(8)
    v_mfma_f32_32x32x16_bf16 v[128:143], v[224:227], v[32:35], 0
    v_exp_f32 v176, v176
    v_exp_f32 v177, v177
    v_exp_f32 v178, v178
    v_exp_f32 v179, v179
    v_mfma_f32_32x32x16_bf16 v[128:143], v[228:231], v[36:39], v[128:143]
    v_exp_f32 v180, v180
    v_exp_f32 v181, v181
    v_exp_f32 v182, v182
    v_exp_f32 v183, v183
    v_smfmac_f32_32x32x32_bf16 v[96:111], v[220:223], v[168:175], v12
    v_exp_f32 v184, v184
    v_exp_f32 v185, v185
    v_exp_f32 v186, v186
    v_exp_f32 v187, v187
    v_smfmac_f32_32x32x32_bf16 v[112:127], v[216:219], v[176:183], v12
    v_exp_f32 v188, v188
    v_exp_f32 v189, v189
    v_exp_f32 v190, v190
    v_exp_f32 v191, v191
    v_mfma_f32_32x32x16_bf16 v[144:159], v[224:227], v[40:43], 0
    v_exp_f32 v128, v128
    v_exp_f32 v129, v129
    v_exp_f32 v130, v130
    v_exp_f32 v131, v131
    v_mfma_f32_32x32x16_bf16 v[144:159], v[228:231], v[44:47], v[144:159]
    v_exp_f32 v132, v132
    v_exp_f32 v133, v133
    v_exp_f32 v134, v134
    v_exp_f32 v135, v135
    v_smfmac_f32_32x32x32_bf16 v[112:127], v[220:223], v[184:191], v12
    buffer_load_dwordx4 v[208:211], v26, s[24:27], s51 offen offset:0 sc1
    buffer_load_dwordx4 v[212:215], v26, s[24:27], s51 offen offset:1024 sc1
    buffer_load_dwordx4 v[216:219], v26, s[24:27], s51 offen offset:2048 sc1
    buffer_load_dwordx4 v[220:223], v26, s[24:27], s51 offen offset:3072 sc1
    v_exp_f32 v136, v136
    v_exp_f32 v137, v137
    v_exp_f32 v138, v138
    v_exp_f32 v139, v139
    v_smfmac_f32_32x32x32_bf16 v[64:79], v[232:235], v[128:135], v12
    v_exp_f32 v140, v140
    v_exp_f32 v141, v141
    v_exp_f32 v142, v142
    v_exp_f32 v143, v143
    v_mfma_f32_32x32x16_bf16 v[160:175], v[224:227], v[48:51], 0
    v_exp_f32 v144, v144
    v_exp_f32 v145, v145
    v_exp_f32 v146, v146
    v_exp_f32 v147, v147
    v_mfma_f32_32x32x16_bf16 v[160:175], v[228:231], v[52:55], v[160:175]
    v_exp_f32 v148, v148
    v_exp_f32 v149, v149
    v_exp_f32 v150, v150
    v_exp_f32 v151, v151
    v_smfmac_f32_32x32x32_bf16 v[64:79], v[236:239], v[136:143], v12
    v_exp_f32 v152, v152
    v_exp_f32 v153, v153
    v_exp_f32 v154, v154
    v_exp_f32 v155, v155
    v_smfmac_f32_32x32x32_bf16 v[80:95], v[232:235], v[144:151], v12
    v_exp_f32 v156, v156
    v_exp_f32 v157, v157
    v_exp_f32 v158, v158
    v_exp_f32 v159, v159
    v_mfma_f32_32x32x16_bf16 v[176:191], v[224:227], v[56:59], 0
    v_exp_f32 v160, v160
    v_exp_f32 v161, v161
    v_exp_f32 v162, v162
    v_exp_f32 v163, v163
    v_mfma_f32_32x32x16_bf16 v[176:191], v[228:231], v[60:63], v[176:191]
    v_exp_f32 v164, v164
    v_exp_f32 v165, v165
    v_exp_f32 v166, v166
    v_exp_f32 v167, v167
    v_smfmac_f32_32x32x32_bf16 v[80:95], v[236:239], v[152:159], v12
    v_exp_f32 v168, v168
    v_exp_f32 v169, v169
    v_exp_f32 v170, v170
    v_exp_f32 v171, v171
    v_smfmac_f32_32x32x32_bf16 v[96:111], v[232:235], v[160:167], v12
    v_exp_f32 v172, v172
    v_exp_f32 v173, v173
    v_exp_f32 v174, v174
    v_exp_f32 v175, v175
    s_waitcnt vmcnt(8)
    v_mfma_f32_32x32x16_bf16 v[128:143], v[240:243], v[32:35], 0
    v_exp_f32 v176, v176
    v_exp_f32 v177, v177
    v_exp_f32 v178, v178
    v_exp_f32 v179, v179
    v_mfma_f32_32x32x16_bf16 v[128:143], v[244:247], v[36:39], v[128:143]
    v_exp_f32 v180, v180
    v_exp_f32 v181, v181
    v_exp_f32 v182, v182
    v_exp_f32 v183, v183
    v_smfmac_f32_32x32x32_bf16 v[96:111], v[236:239], v[168:175], v12
    v_exp_f32 v184, v184
    v_exp_f32 v185, v185
    v_exp_f32 v186, v186
    v_exp_f32 v187, v187
    v_smfmac_f32_32x32x32_bf16 v[112:127], v[232:235], v[176:183], v12
    v_exp_f32 v188, v188
    v_exp_f32 v189, v189
    v_exp_f32 v190, v190
    v_exp_f32 v191, v191
    v_mfma_f32_32x32x16_bf16 v[144:159], v[240:243], v[40:43], 0
    v_exp_f32 v128, v128
    v_exp_f32 v129, v129
    v_exp_f32 v130, v130
    v_exp_f32 v131, v131
    v_mfma_f32_32x32x16_bf16 v[144:159], v[244:247], v[44:47], v[144:159]
    v_exp_f32 v132, v132
    v_exp_f32 v133, v133
    v_exp_f32 v134, v134
    v_exp_f32 v135, v135
    v_smfmac_f32_32x32x32_bf16 v[112:127], v[236:239], v[184:191], v12
    buffer_load_dwordx4 v[224:227], v27, s[24:27], s51 offen offset:0 sc1
    buffer_load_dwordx4 v[228:231], v27, s[24:27], s51 offen offset:1024 sc1
    buffer_load_dwordx4 v[232:235], v27, s[24:27], s51 offen offset:2048 sc1
    buffer_load_dwordx4 v[236:239], v27, s[24:27], s51 offen offset:3072 sc1
    v_exp_f32 v136, v136
    v_exp_f32 v137, v137
    v_exp_f32 v138, v138
    v_exp_f32 v139, v139
    v_smfmac_f32_32x32x32_bf16 v[64:79], v[248:251], v[128:135], v12
    v_exp_f32 v140, v140
    v_exp_f32 v141, v141
    v_exp_f32 v142, v142
    v_exp_f32 v143, v143
    v_mfma_f32_32x32x16_bf16 v[160:175], v[240:243], v[48:51], 0
    v_exp_f32 v144, v144
    v_exp_f32 v145, v145
    v_exp_f32 v146, v146
    v_exp_f32 v147, v147
    v_mfma_f32_32x32x16_bf16 v[160:175], v[244:247], v[52:55], v[160:175]
    v_exp_f32 v148, v148
    v_exp_f32 v149, v149
    v_exp_f32 v150, v150
    v_exp_f32 v151, v151
    v_smfmac_f32_32x32x32_bf16 v[64:79], v[252:255], v[136:143], v12
    v_exp_f32 v152, v152
    v_exp_f32 v153, v153
    v_exp_f32 v154, v154
    v_exp_f32 v155, v155
    v_smfmac_f32_32x32x32_bf16 v[80:95], v[248:251], v[144:151], v12
    v_exp_f32 v156, v156
    v_exp_f32 v157, v157
    v_exp_f32 v158, v158
    v_exp_f32 v159, v159
    v_mfma_f32_32x32x16_bf16 v[176:191], v[240:243], v[56:59], 0
    v_exp_f32 v160, v160
    v_exp_f32 v161, v161
    v_exp_f32 v162, v162
    v_exp_f32 v163, v163
    v_mfma_f32_32x32x16_bf16 v[176:191], v[244:247], v[60:63], v[176:191]
    v_exp_f32 v164, v164
    v_exp_f32 v165, v165
    v_exp_f32 v166, v166
    v_exp_f32 v167, v167
    v_smfmac_f32_32x32x32_bf16 v[80:95], v[252:255], v[152:159], v12
    v_exp_f32 v168, v168
    v_exp_f32 v169, v169
    v_exp_f32 v170, v170
    v_exp_f32 v171, v171
    v_smfmac_f32_32x32x32_bf16 v[96:111], v[248:251], v[160:167], v12
    v_exp_f32 v172, v172
    v_exp_f32 v173, v173
    v_exp_f32 v174, v174
    v_exp_f32 v175, v175
    s_waitcnt vmcnt(8)
    v_mfma_f32_32x32x16_bf16 v[128:143], v[192:195], v[32:35], 0
    v_exp_f32 v176, v176
    v_exp_f32 v177, v177
    v_exp_f32 v178, v178
    v_exp_f32 v179, v179
    v_mfma_f32_32x32x16_bf16 v[128:143], v[196:199], v[36:39], v[128:143]
    v_exp_f32 v180, v180
    v_exp_f32 v181, v181
    v_exp_f32 v182, v182
    v_exp_f32 v183, v183
    v_smfmac_f32_32x32x32_bf16 v[96:111], v[252:255], v[168:175], v12
    v_exp_f32 v184, v184
    v_exp_f32 v185, v185
    v_exp_f32 v186, v186
    v_exp_f32 v187, v187
    v_smfmac_f32_32x32x32_bf16 v[112:127], v[248:251], v[176:183], v12
    v_exp_f32 v188, v188
    v_exp_f32 v189, v189
    v_exp_f32 v190, v190
    v_exp_f32 v191, v191
    v_mfma_f32_32x32x16_bf16 v[144:159], v[192:195], v[40:43], 0
    v_exp_f32 v128, v128
    v_exp_f32 v129, v129
    v_exp_f32 v130, v130
    v_exp_f32 v131, v131
    v_mfma_f32_32x32x16_bf16 v[144:159], v[196:199], v[44:47], v[144:159]
    v_exp_f32 v132, v132
    v_exp_f32 v133, v133
    v_exp_f32 v134, v134
    v_exp_f32 v135, v135
    v_smfmac_f32_32x32x32_bf16 v[112:127], v[252:255], v[184:191], v12
    buffer_load_dwordx4 v[240:243], v28, s[24:27], s51 offen offset:0 sc1
    buffer_load_dwordx4 v[244:247], v28, s[24:27], s51 offen offset:1024 sc1
    buffer_load_dwordx4 v[248:251], v28, s[24:27], s51 offen offset:2048 sc1
    buffer_load_dwordx4 v[252:255], v28, s[24:27], s51 offen offset:3072 sc1
    s_add_u32 s43, s43, 16384
    s_xor_b32 s51, s43, s39
    s_add_u32 s51, s51, s41
    v_exp_f32 v136, v136
    v_exp_f32 v137, v137
    v_exp_f32 v138, v138
    v_exp_f32 v139, v139
    v_smfmac_f32_32x32x32_bf16 v[64:79], v[200:203], v[128:135], v12
    v_exp_f32 v140, v140
    v_exp_f32 v141, v141
    v_exp_f32 v142, v142
    v_exp_f32 v143, v143
    v_mfma_f32_32x32x16_bf16 v[160:175], v[192:195], v[48:51], 0
    v_exp_f32 v144, v144
    v_exp_f32 v145, v145
    v_exp_f32 v146, v146
    v_exp_f32 v147, v147
    v_mfma_f32_32x32x16_bf16 v[160:175], v[196:199], v[52:55], v[160:175]
    v_exp_f32 v148, v148
    v_exp_f32 v149, v149
    v_exp_f32 v150, v150
    v_exp_f32 v151, v151
    v_smfmac_f32_32x32x32_bf16 v[64:79], v[204:207], v[136:143], v12
    v_exp_f32 v152, v152
    v_exp_f32 v153, v153
    v_exp_f32 v154, v154
    v_exp_f32 v155, v155
    v_smfmac_f32_32x32x32_bf16 v[80:95], v[200:203], v[144:151], v12
    v_exp_f32 v156, v156
    v_exp_f32 v157, v157
    v_exp_f32 v158, v158
    v_exp_f32 v159, v159
    v_mfma_f32_32x32x16_bf16 v[176:191], v[192:195], v[56:59], 0
    v_exp_f32 v160, v160
    v_exp_f32 v161, v161
    v_exp_f32 v162, v162
    v_exp_f32 v163, v163
    v_mfma_f32_32x32x16_bf16 v[176:191], v[196:199], v[60:63], v[176:191]
    v_exp_f32 v164, v164
    v_exp_f32 v165, v165
    v_exp_f32 v166, v166
    v_exp_f32 v167, v167
    v_smfmac_f32_32x32x32_bf16 v[80:95], v[204:207], v[152:159], v12
    v_exp_f32 v168, v168
    v_exp_f32 v169, v169
    v_exp_f32 v170, v170
    v_exp_f32 v171, v171
    v_smfmac_f32_32x32x32_bf16 v[96:111], v[200:203], v[160:167], v12
    v_exp_f32 v172, v172
    v_exp_f32 v173, v173
    v_exp_f32 v174, v174
    v_exp_f32 v175, v175
    s_waitcnt vmcnt(8)
    v_mfma_f32_32x32x16_bf16 v[128:143], v[208:211], v[32:35], 0
    v_exp_f32 v176, v176
    v_exp_f32 v177, v177
    v_exp_f32 v178, v178
    v_exp_f32 v179, v179
    v_mfma_f32_32x32x16_bf16 v[128:143], v[212:215], v[36:39], v[128:143]
    v_exp_f32 v180, v180
    v_exp_f32 v181, v181
    v_exp_f32 v182, v182
    v_exp_f32 v183, v183
    v_smfmac_f32_32x32x32_bf16 v[96:111], v[204:207], v[168:175], v12
    v_exp_f32 v184, v184
    v_exp_f32 v185, v185
    v_exp_f32 v186, v186
    v_exp_f32 v187, v187
    v_smfmac_f32_32x32x32_bf16 v[112:127], v[200:203], v[176:183], v12
    v_exp_f32 v188, v188
    v_exp_f32 v189, v189
    v_exp_f32 v190, v190
    v_exp_f32 v191, v191
    v_mfma_f32_32x32x16_bf16 v[144:159], v[208:211], v[40:43], 0
    v_exp_f32 v128, v128
    v_exp_f32 v129, v129
    v_exp_f32 v130, v130
    v_exp_f32 v131, v131
    v_mfma_f32_32x32x16_bf16 v[144:159], v[212:215], v[44:47], v[144:159]
    v_exp_f32 v132, v132
    v_exp_f32 v133, v133
    v_exp_f32 v134, v134
    v_exp_f32 v135, v135
    v_smfmac_f32_32x32x32_bf16 v[112:127], v[204:207], v[184:191], v12
    v_exp_f32 v136, v136
    v_exp_f32 v137, v137
    v_exp_f32 v138, v138
    v_exp_f32 v139, v139
    v_smfmac_f32_32x32x32_bf16 v[64:79], v[216:219], v[128:135], v12
    v_exp_f32 v140, v140
    v_exp_f32 v141, v141
    v_exp_f32 v142, v142
    v_exp_f32 v143, v143
    v_mfma_f32_32x32x16_bf16 v[160:175], v[208:211], v[48:51], 0
    v_exp_f32 v144, v144
    v_exp_f32 v145, v145
    v_exp_f32 v146, v146
    v_exp_f32 v147, v147
    v_mfma_f32_32x32x16_bf16 v[160:175], v[212:215], v[52:55], v[160:175]
    v_exp_f32 v148, v148
    v_exp_f32 v149, v149
    v_exp_f32 v150, v150
    v_exp_f32 v151, v151
    v_smfmac_f32_32x32x32_bf16 v[64:79], v[220:223], v[136:143], v12
    v_exp_f32 v152, v152
    v_exp_f32 v153, v153
    v_exp_f32 v154, v154
    v_exp_f32 v155, v155
    v_smfmac_f32_32x32x32_bf16 v[80:95], v[216:219], v[144:151], v12
    v_exp_f32 v156, v156
    v_exp_f32 v157, v157
    v_exp_f32 v158, v158
    v_exp_f32 v159, v159
    v_mfma_f32_32x32x16_bf16 v[176:191], v[208:211], v[56:59], 0
    v_exp_f32 v160, v160
    v_exp_f32 v161, v161
    v_exp_f32 v162, v162
    v_exp_f32 v163, v163
    v_mfma_f32_32x32x16_bf16 v[176:191], v[212:215], v[60:63], v[176:191]
    v_exp_f32 v164, v164
    v_exp_f32 v165, v165
    v_exp_f32 v166, v166
    v_exp_f32 v167, v167
    v_smfmac_f32_32x32x32_bf16 v[80:95], v[220:223], v[152:159], v12
    v_exp_f32 v168, v168
    v_exp_f32 v169, v169
    v_exp_f32 v170, v170
    v_exp_f32 v171, v171
    v_smfmac_f32_32x32x32_bf16 v[96:111], v[216:219], v[160:167], v12
    v_exp_f32 v172, v172
    v_exp_f32 v173, v173
    v_exp_f32 v174, v174
    v_exp_f32 v175, v175
    s_waitcnt vmcnt(4)
    ds_read_b32 v18, v17 offset:0
    v_mfma_f32_32x32x16_bf16 v[128:143], v[224:227], v[32:35], 0
    v_exp_f32 v176, v176
    v_exp_f32 v177, v177
    v_exp_f32 v178, v178
    v_exp_f32 v179, v179
    v_mfma_f32_32x32x16_bf16 v[128:143], v[228:231], v[36:39], v[128:143]
    v_exp_f32 v180, v180
    v_exp_f32 v181, v181
    v_exp_f32 v182, v182
    v_exp_f32 v183, v183
    v_smfmac_f32_32x32x32_bf16 v[96:111], v[220:223], v[168:175], v12
    v_exp_f32 v184, v184
    v_exp_f32 v185, v185
    v_exp_f32 v186, v186
    v_exp_f32 v187, v187
    v_smfmac_f32_32x32x32_bf16 v[112:127], v[216:219], v[176:183], v12
    v_exp_f32 v188, v188
    v_exp_f32 v189, v189
    v_exp_f32 v190, v190
    v_exp_f32 v191, v191
    v_mfma_f32_32x32x16_bf16 v[144:159], v[224:227], v[40:43], 0
    v_exp_f32 v128, v128
    v_exp_f32 v129, v129
    v_exp_f32 v130, v130
    v_exp_f32 v131, v131
    v_mfma_f32_32x32x16_bf16 v[144:159], v[228:231], v[44:47], v[144:159]
    v_exp_f32 v132, v132
    v_exp_f32 v133, v133
    v_exp_f32 v134, v134
    v_exp_f32 v135, v135
    v_smfmac_f32_32x32x32_bf16 v[112:127], v[220:223], v[184:191], v12
    s_mov_b32 s61, 200000
K2_RW1:
    s_waitcnt lgkmcnt(0)
    v_readfirstlane_b32 s44, v18
    s_cmp_ge_u32 s44, 256
    s_cbranch_scc1 K2_RD1
    s_sub_u32 s61, s61, 1
    s_cbranch_scc1 K2_RD1
    ds_read_b32 v18, v17 offset:0
    s_branch K2_RW1
K2_RD1:
    buffer_load_dwordx4 v[192:195], v2, s[24:27], s51 offen offset:0 sc1
    buffer_load_dwordx4 v[196:199], v2, s[24:27], s51 offen offset:1024 sc1
    buffer_load_dwordx4 v[200:203], v2, s[24:27], s51 offen offset:2048 sc1
    buffer_load_dwordx4 v[204:207], v2, s[24:27], s51 offen offset:3072 sc1
    buffer_load_dwordx4 v[208:211], v26, s[24:27], s51 offen offset:0 sc1
    buffer_load_dwordx4 v[212:215], v26, s[24:27], s51 offen offset:1024 sc1
    buffer_load_dwordx4 v[216:219], v26, s[24:27], s51 offen offset:2048 sc1
    buffer_load_dwordx4 v[220:223], v26, s[24:27], s51 offen offset:3072 sc1
    v_exp_f32 v136, v136
    v_exp_f32 v137, v137
    v_exp_f32 v138, v138
    v_exp_f32 v139, v139
    v_smfmac_f32_32x32x32_bf16 v[64:79], v[232:235], v[128:135], v12
    v_exp_f32 v140, v140
    v_exp_f32 v141, v141
    v_exp_f32 v142, v142
    v_exp_f32 v143, v143
    v_mfma_f32_32x32x16_bf16 v[160:175], v[224:227], v[48:51], 0
    v_exp_f32 v144, v144
    v_exp_f32 v145, v145
    v_exp_f32 v146, v146
    v_exp_f32 v147, v147
    v_mfma_f32_32x32x16_bf16 v[160:175], v[228:231], v[52:55], v[160:175]
    v_exp_f32 v148, v148
    v_exp_f32 v149, v149
    v_exp_f32 v150, v150
    v_exp_f32 v151, v151
    v_smfmac_f32_32x32x32_bf16 v[64:79], v[236:239], v[136:143], v12
    v_exp_f32 v152, v152
    v_exp_f32 v153, v153
    v_exp_f32 v154, v154
    v_exp_f32 v155, v155
    v_smfmac_f32_32x32x32_bf16 v[80:95], v[232:235], v[144:151], v12
    v_exp_f32 v156, v156
    v_exp_f32 v157, v157
    v_exp_f32 v158, v158
    v_exp_f32 v159, v159
    v_mfma_f32_32x32x16_bf16 v[176:191], v[224:227], v[56:59], 0
    v_exp_f32 v160, v160
    v_exp_f32 v161, v161
    v_exp_f32 v162, v162
    v_exp_f32 v163, v163
    v_mfma_f32_32x32x16_bf16 v[176:191], v[228:231], v[60:63], v[176:191]
    v_exp_f32 v164, v164
    v_exp_f32 v165, v165
    v_exp_f32 v166, v166
    v_exp_f32 v167, v167
    v_smfmac_f32_32x32x32_bf16 v[80:95], v[236:239], v[152:159], v12
    v_exp_f32 v168, v168
    v_exp_f32 v169, v169
    v_exp_f32 v170, v170
    v_exp_f32 v171, v171
    v_smfmac_f32_32x32x32_bf16 v[96:111], v[232:235], v[160:167], v12
    v_exp_f32 v172, v172
    v_exp_f32 v173, v173
    v_exp_f32 v174, v174
    v_exp_f32 v175, v175
    s_waitcnt vmcnt(8)
    v_mfma_f32_32x32x16_bf16 v[128:143], v[240:243], v[32:35], 0
    v_exp_f32 v176, v176
    v_exp_f32 v177, v177
    v_exp_f32 v178, v178
    v_exp_f32 v179, v179
    v_mfma_f32_32x32x16_bf16 v[128:143], v[244:247], v[36:39], v[128:143]
    v_exp_f32 v180, v180
    v_exp_f32 v181, v181
    v_exp_f32 v182, v182
    v_exp_f32 v183, v183
    v_smfmac_f32_32x32x32_bf16 v[96:111], v[236:239], v[168:175], v12
    v_exp_f32 v184, v184
    v_exp_f32 v185, v185
    v_exp_f32 v186, v186
    v_exp_f32 v187, v187
    v_smfmac_f32_32x32x32_bf16 v[112:127], v[232:235], v[176:183], v12
    v_exp_f32 v188, v188
    v_exp_f32 v189, v189
    v_exp_f32 v190, v190
    v_exp_f32 v191, v191
    v_mfma_f32_32x32x16_bf16 v[144:159], v[240:243], v[40:43], 0
    v_exp_f32 v128, v128
    v_exp_f32 v129, v129
    v_exp_f32 v130, v130
    v_exp_f32 v131, v131
    v_mfma_f32_32x32x16_bf16 v[144:159], v[244:247], v[44:47], v[144:159]
    v_exp_f32 v132, v132
    v_exp_f32 v133, v133
    v_exp_f32 v134, v134
    v_exp_f32 v135, v135
    v_smfmac_f32_32x32x32_bf16 v[112:127], v[236:239], v[184:191], v12
    buffer_load_dwordx4 v[224:227], v27, s[24:27], s51 offen offset:0 sc1
    buffer_load_dwordx4 v[228:231], v27, s[24:27], s51 offen offset:1024 sc1
    buffer_load_dwordx4 v[232:235], v27, s[24:27], s51 offen offset:2048 sc1
    buffer_load_dwordx4 v[236:239], v27, s[24:27], s51 offen offset:3072 sc1
    v_exp_f32 v136, v136
    v_exp_f32 v137, v137
    v_exp_f32 v138, v138
    v_exp_f32 v139, v139
    v_smfmac_f32_32x32x32_bf16 v[64:79], v[248:251], v[128:135], v12
    v_exp_f32 v140, v140
    v_exp_f32 v141, v141
    v_exp_f32 v142, v142
    v_exp_f32 v143, v143
    v_mfma_f32_32x32x16_bf16 v[160:175], v[240:243], v[48:51], 0
    v_exp_f32 v144, v144
    v_exp_f32 v145, v145
    v_exp_f32 v146, v146
    v_exp_f32 v147, v147
    v_mfma_f32_32x32x16_bf16 v[160:175], v[244:247], v[52:55], v[160:175]
    v_exp_f32 v148, v148
    v_exp_f32 v149, v149
    v_exp_f32 v150, v150
    v_exp_f32 v151, v151
    v_smfmac_f32_32x32x32_bf16 v[64:79], v[252:255], v[136:143], v12
    v_exp_f32 v152, v152
    v_exp_f32 v153, v153
    v_exp_f32 v154, v154
    v_exp_f32 v155, v155
    v_smfmac_f32_32x32x32_bf16 v[80:95], v[248:251], v[144:151], v12
    v_exp_f32 v156, v156
    v_exp_f32 v157, v157
    v_exp_f32 v158, v158
    v_exp_f32 v159, v159
    v_mfma_f32_32x32x16_bf16 v[176:191], v[240:243], v[56:59], 0
    v_exp_f32 v160, v160
    v_exp_f32 v161, v161
    v_exp_f32 v162, v162
    v_exp_f32 v163, v163
    v_mfma_f32_32x32x16_bf16 v[176:191], v[244:247], v[60:63], v[176:191]
    v_exp_f32 v164, v164
    v_exp_f32 v165, v165
    v_exp_f32 v166, v166
    v_exp_f32 v167, v167
    v_smfmac_f32_32x32x32_bf16 v[80:95], v[252:255], v[152:159], v12
    v_exp_f32 v168, v168
    v_exp_f32 v169, v169
    v_exp_f32 v170, v170
    v_exp_f32 v171, v171
    v_smfmac_f32_32x32x32_bf16 v[96:111], v[248:251], v[160:167], v12
    v_exp_f32 v172, v172
    v_exp_f32 v173, v173
    v_exp_f32 v174, v174
    v_exp_f32 v175, v175
    s_waitcnt vmcnt(8)
    v_mfma_f32_32x32x16_bf16 v[128:143], v[192:195], v[32:35], 0
    v_exp_f32 v176, v176
    v_exp_f32 v177, v177
    v_exp_f32 v178, v178
    v_exp_f32 v179, v179
    v_mfma_f32_32x32x16_bf16 v[128:143], v[196:199], v[36:39], v[128:143]
    v_exp_f32 v180, v180
    v_exp_f32 v181, v181
    v_exp_f32 v182, v182
    v_exp_f32 v183, v183
    v_smfmac_f32_32x32x32_bf16 v[96:111], v[252:255], v[168:175], v12
    v_exp_f32 v184, v184
    v_exp_f32 v185, v185
    v_exp_f32 v186, v186
    v_exp_f32 v187, v187
    v_smfmac_f32_32x32x32_bf16 v[112:127], v[248:251], v[176:183], v12
    v_exp_f32 v188, v188
    v_exp_f32 v189, v189
    v_exp_f32 v190, v190
    v_exp_f32 v191, v191
    v_mfma_f32_32x32x16_bf16 v[144:159], v[192:195], v[40:43], 0
    v_exp_f32 v128, v128
    v_exp_f32 v129, v129
    v_exp_f32 v130, v130
    v_exp_f32 v131, v131
    v_mfma_f32_32x32x16_bf16 v[144:159], v[196:199], v[44:47], v[144:159]
    v_exp_f32 v132, v132
    v_exp_f32 v133, v133
    v_exp_f32 v134, v134
    v_exp_f32 v135, v135
    v_smfmac_f32_32x32x32_bf16 v[112:127], v[252:255], v[184:191], v12
    buffer_load_dwordx4 v[240:243], v28, s[24:27], s51 offen offset:0 sc1
    buffer_load_dwordx4 v[244:247], v28, s[24:27], s51 offen offset:1024 sc1
    buffer_load_dwordx4 v[248:251], v28, s[24:27], s51 offen offset:2048 sc1
    buffer_load_dwordx4 v[252:255], v28, s[24:27], s51 offen offset:3072 sc1
    s_add_u32 s43, s43, 16384
    s_xor_b32 s51, s43, s39
    s_add_u32 s51, s51, s41
    v_exp_f32 v136, v136
    v_exp_f32 v137, v137
    v_exp_f32 v138, v138
    v_exp_f32 v139, v139
    v_smfmac_f32_32x32x32_bf16 v[64:79], v[200:203], v[128:135], v12
    v_exp_f32 v140, v140
    v_exp_f32 v141, v141
    v_exp_f32 v142, v142
    v_exp_f32 v143, v143
    v_mfma_f32_32x32x16_bf16 v[160:175], v[192:195], v[48:51], 0
    v_exp_f32 v144, v144
    v_exp_f32 v145, v145
    v_exp_f32 v146, v146
    v_exp_f32 v147, v147
    v_mfma_f32_32x32x16_bf16 v[160:175], v[196:199], v[52:55], v[160:175]
    v_exp_f32 v148, v148
    v_exp_f32 v149, v149
    v_exp_f32 v150, v150
    v_exp_f32 v151, v151
    v_smfmac_f32_32x32x32_bf16 v[64:79], v[204:207], v[136:143], v12
    v_exp_f32 v152, v152
    v_exp_f32 v153, v153
    v_exp_f32 v154, v154
    v_exp_f32 v155, v155
    v_smfmac_f32_32x32x32_bf16 v[80:95], v[200:203], v[144:151], v12
    v_exp_f32 v156, v156
    v_exp_f32 v157, v157
    v_exp_f32 v158, v158
    v_exp_f32 v159, v159
    v_mfma_f32_32x32x16_bf16 v[176:191], v[192:195], v[56:59], 0
    v_exp_f32 v160, v160
    v_exp_f32 v161, v161
    v_exp_f32 v162, v162
    v_exp_f32 v163, v163
    v_mfma_f32_32x32x16_bf16 v[176:191], v[196:199], v[60:63], v[176:191]
    v_exp_f32 v164, v164
    v_exp_f32 v165, v165
    v_exp_f32 v166, v166
    v_exp_f32 v167, v167
    v_smfmac_f32_32x32x32_bf16 v[80:95], v[204:207], v[152:159], v12
    v_exp_f32 v168, v168
    v_exp_f32 v169, v169
    v_exp_f32 v170, v170
    v_exp_f32 v171, v171
    v_smfmac_f32_32x32x32_bf16 v[96:111], v[200:203], v[160:167], v12
    v_exp_f32 v172, v172
    v_exp_f32 v173, v173
    v_exp_f32 v174, v174
    v_exp_f32 v175, v175
    s_waitcnt vmcnt(8)
    v_mfma_f32_32x32x16_bf16 v[128:143], v[208:211], v[32:35], 0
    v_exp_f32 v176, v176
    v_exp_f32 v177, v177
    v_exp_f32 v178, v178
    v_exp_f32 v179, v179
    v_mfma_f32_32x32x16_bf16 v[128:143], v[212:215], v[36:39], v[128:143]
    v_exp_f32 v180, v180
    v_exp_f32 v181, v181
    v_exp_f32 v182, v182
    v_exp_f32 v183, v183
    v_smfmac_f32_32x32x32_bf16 v[96:111], v[204:207], v[168:175], v12
    v_exp_f32 v184, v184
    v_exp_f32 v185, v185
    v_exp_f32 v186, v186
    v_exp_f32 v187, v187
    v_smfmac_f32_32x32x32_bf16 v[112:127], v[200:203], v[176:183], v12
    v_exp_f32 v188, v188
    v_exp_f32 v189, v189
    v_exp_f32 v190, v190
    v_exp_f32 v191, v191
    v_mfma_f32_32x32x16_bf16 v[144:159], v[208:211], v[40:43], 0
    v_exp_f32 v128, v128
    v_exp_f32 v129, v129
    v_exp_f32 v130, v130
    v_exp_f32 v131, v131
    v_mfma_f32_32x32x16_bf16 v[144:159], v[212:215], v[44:47], v[144:159]
    v_exp_f32 v132, v132
    v_exp_f32 v133, v133
    v_exp_f32 v134, v134
    v_exp_f32 v135, v135
    v_smfmac_f32_32x32x32_bf16 v[112:127], v[204:207], v[184:191], v12
    buffer_load_dwordx4 v[192:195], v2, s[24:27], s51 offen offset:0 sc1
    buffer_load_dwordx4 v[196:199], v2, s[24:27], s51 offen offset:1024 sc1
    buffer_load_dwordx4 v[200:203], v2, s[24:27], s51 offen offset:2048 sc1
    buffer_load_dwordx4 v[204:207], v2, s[24:27], s51 offen offset:3072 sc1
    v_exp_f32 v136, v136
    v_exp_f32 v137, v137
    v_exp_f32 v138, v138
    v_exp_f32 v139, v139
    v_smfmac_f32_32x32x32_bf16 v[64:79], v[216:219], v[128:135], v12
    v_exp_f32 v140, v140
    v_exp_f32 v141, v141
    v_exp_f32 v142, v142
    v_exp_f32 v143, v143
    v_mfma_f32_32x32x16_bf16 v[160:175], v[208:211], v[48:51], 0
    v_exp_f32 v144, v144
    v_exp_f32 v145, v145
    v_exp_f32 v146, v146
    v_exp_f32 v147, v147
    v_mfma_f32_32x32x16_bf16 v[160:175], v[212:215], v[52:55], v[160:175]
    v_exp_f32 v148, v148
    v_exp_f32 v149, v149
    v_exp_f32 v150, v150
    v_exp_f32 v151, v151
    v_smfmac_f32_32x32x32_bf16 v[64:79], v[220:223], v[136:143], v12
    v_exp_f32 v152, v152
    v_exp_f32 v153, v153
    v_exp_f32 v154, v154
    v_exp_f32 v155, v155
    v_smfmac_f32_32x32x32_bf16 v[80:95], v[216:219], v[144:151], v12
    v_exp_f32 v156, v156
    v_exp_f32 v157, v157
    v_exp_f32 v158, v158
    v_exp_f32 v159, v159
    v_mfma_f32_32x32x16_bf16 v[176:191], v[208:211], v[56:59], 0
    v_exp_f32 v160, v160
    v_exp_f32 v161, v161
    v_exp_f32 v162, v162
    v_exp_f32 v163, v163
    v_mfma_f32_32x32x16_bf16 v[176:191], v[212:215], v[60:63], v[176:191]
    v_exp_f32 v164, v164
    v_exp_f32 v165, v165
    v_exp_f32 v166, v166
    v_exp_f32 v167, v167
    v_smfmac_f32_32x32x32_bf16 v[80:95], v[220:223], v[152:159], v12
    v_exp_f32 v168, v168
    v_exp_f32 v169, v169
    v_exp_f32 v170, v170
    v_exp_f32 v171, v171
    v_smfmac_f32_32x32x32_bf16 v[96:111], v[216:219], v[160:167], v12
    v_exp_f32 v172, v172
    v_exp_f32 v173, v173
    v_exp_f32 v174, v174
    v_exp_f32 v175, v175
    s_waitcnt vmcnt(8)
    v_mfma_f32_32x32x16_bf16 v[128:143], v[224:227], v[32:35], 0
    v_exp_f32 v176, v176
    v_exp_f32 v177, v177
    v_exp_f32 v178, v178
    v_exp_f32 v179, v179
    v_mfma_f32_32x32x16_bf16 v[128:143], v[228:231], v[36:39], v[128:143]
    v_exp_f32 v180, v180
    v_exp_f32 v181, v181
    v_exp_f32 v182, v182
    v_exp_f32 v183, v183
    v_smfmac_f32_32x32x32_bf16 v[96:111], v[220:223], v[168:175], v12
    v_exp_f32 v184, v184
    v_exp_f32 v185, v185
    v_exp_f32 v186, v186
    v_exp_f32 v187, v187
    v_smfmac_f32_32x32x32_bf16 v[112:127], v[216:219], v[176:183], v12
    v_exp_f32 v188, v188
    v_exp_f32 v189, v189
    v_exp_f32 v190, v190
    v_exp_f32 v191, v191
    v_mfma_f32_32x32x16_bf16 v[144:159], v[224:227], v[40:43], 0
    v_exp_f32 v128, v128
    v_exp_f32 v129, v129
    v_exp_f32 v130, v130
    v_exp_f32 v131, v131
    v_mfma_f32_32x32x16_bf16 v[144:159], v[228:231], v[44:47], v[144:159]
    v_exp_f32 v132, v132
    v_exp_f32 v133, v133
    v_exp_f32 v134, v134
    v_exp_f32 v135, v135
    v_smfmac_f32_32x32x32_bf16 v[112:127], v[220:223], v[184:191], v12
    buffer_load_dwordx4 v[208:211], v26, s[24:27], s51 offen offset:0 sc1
    buffer_load_dwordx4 v[212:215], v26, s[24:27], s51 offen offset:1024 sc1
    buffer_load_dwordx4 v[216:219], v26, s[24:27], s51 offen offset:2048 sc1
    buffer_load_dwordx4 v[220:223], v26, s[24:27], s51 offen offset:3072 sc1
    v_exp_f32 v136, v136
    v_exp_f32 v137, v137
    v_exp_f32 v138, v138
    v_exp_f32 v139, v139
    v_smfmac_f32_32x32x32_bf16 v[64:79], v[232:235], v[128:135], v12
    v_exp_f32 v140, v140
    v_exp_f32 v141, v141
    v_exp_f32 v142, v142
    v_exp_f32 v143, v143
    v_mfma_f32_32x32x16_bf16 v[160:175], v[224:227], v[48:51], 0
    v_exp_f32 v144, v144
    v_exp_f32 v145, v145
    v_exp_f32 v146, v146
    v_exp_f32 v147, v147
    v_mfma_f32_32x32x16_bf16 v[160:175], v[228:231], v[52:55], v[160:175]
    v_exp_f32 v148, v148
    v_exp_f32 v149, v149
    v_exp_f32 v150, v150
    v_exp_f32 v151, v151
    v_smfmac_f32_32x32x32_bf16 v[64:79], v[236:239], v[136:143], v12
    v_exp_f32 v152, v152
    v_exp_f32 v153, v153
    v_exp_f32 v154, v154
    v_exp_f32 v155, v155
    v_smfmac_f32_32x32x32_bf16 v[80:95], v[232:235], v[144:151], v12
    v_exp_f32 v156, v156
    v_exp_f32 v157, v157
    v_exp_f32 v158, v158
    v_exp_f32 v159, v159
    v_mfma_f32_32x32x16_bf16 v[176:191], v[224:227], v[56:59], 0
    v_exp_f32 v160, v160
    v_exp_f32 v161, v161
    v_exp_f32 v162, v162
    v_exp_f32 v163, v163
    v_mfma_f32_32x32x16_bf16 v[176:191], v[228:231], v[60:63], v[176:191]
    v_exp_f32 v164, v164
    v_exp_f32 v165, v165
    v_exp_f32 v166, v166
    v_exp_f32 v167, v167
    v_smfmac_f32_32x32x32_bf16 v[80:95], v[236:239], v[152:159], v12
    v_exp_f32 v168, v168
    v_exp_f32 v169, v169
    v_exp_f32 v170, v170
    v_exp_f32 v171, v171
    v_smfmac_f32_32x32x32_bf16 v[96:111], v[232:235], v[160:167], v12
    v_exp_f32 v172, v172
    v_exp_f32 v173, v173
    v_exp_f32 v174, v174
    v_exp_f32 v175, v175
    s_waitcnt vmcnt(8)
    v_mfma_f32_32x32x16_bf16 v[128:143], v[240:243], v[32:35], 0
    v_exp_f32 v176, v176
    v_exp_f32 v177, v177
    v_exp_f32 v178, v178
    v_exp_f32 v179, v179
    v_mfma_f32_32x32x16_bf16 v[128:143], v[244:247], v[36:39], v[128:143]
    v_exp_f32 v180, v180
    v_exp_f32 v181, v181
    v_exp_f32 v182, v182
    v_exp_f32 v183, v183
    v_smfmac_f32_32x32x32_bf16 v[96:111], v[236:239], v[168:175], v12
    v_exp_f32 v184, v184
    v_exp_f32 v185, v185
    v_exp_f32 v186, v186
    v_exp_f32 v187, v187
    v_smfmac_f32_32x32x32_bf16 v[112:127], v[232:235], v[176:183], v12
    v_exp_f32 v188, v188
    v_exp_f32 v189, v189
    v_exp_f32 v190, v190
    v_exp_f32 v191, v191
    v_mfma_f32_32x32x16_bf16 v[144:159], v[240:243], v[40:43], 0
    v_exp_f32 v128, v128
    v_exp_f32 v129, v129
    v_exp_f32 v130, v130
    v_exp_f32 v131, v131
    v_mfma_f32_32x32x16_bf16 v[144:159], v[244:247], v[44:47], v[144:159]
    v_exp_f32 v132, v132
    v_exp_f32 v133, v133
    v_exp_f32 v134, v134
    v_exp_f32 v135, v135
    v_smfmac_f32_32x32x32_bf16 v[112:127], v[236:239], v[184:191], v12
    buffer_load_dwordx4 v[224:227], v27, s[24:27], s51 offen offset:0 sc1
    buffer_load_dwordx4 v[228:231], v27, s[24:27], s51 offen offset:1024 sc1
    buffer_load_dwordx4 v[232:235], v27, s[24:27], s51 offen offset:2048 sc1
    buffer_load_dwordx4 v[236:239], v27, s[24:27], s51 offen offset:3072 sc1
    v_exp_f32 v136, v136
    v_exp_f32 v137, v137
    v_exp_f32 v138, v138
    v_exp_f32 v139, v139
    v_smfmac_f32_32x32x32_bf16 v[64:79], v[248:251], v[128:135], v12
    v_exp_f32 v140, v140
    v_exp_f32 v141, v141
    v_exp_f32 v142, v142
    v_exp_f32 v143, v143
    v_mfma_f32_32x32x16_bf16 v[160:175], v[240:243], v[48:51], 0
    v_exp_f32 v144, v144
    v_exp_f32 v145, v145
    v_exp_f32 v146, v146
    v_exp_f32 v147, v147
    v_mfma_f32_32x32x16_bf16 v[160:175], v[244:247], v[52:55], v[160:175]
    v_exp_f32 v148, v148
    v_exp_f32 v149, v149
    v_exp_f32 v150, v150
    v_exp_f32 v151, v151
    v_smfmac_f32_32x32x32_bf16 v[64:79], v[252:255], v[136:143], v12
    v_exp_f32 v152, v152
    v_exp_f32 v153, v153
    v_exp_f32 v154, v154
    v_exp_f32 v155, v155
    v_smfmac_f32_32x32x32_bf16 v[80:95], v[248:251], v[144:151], v12
    v_exp_f32 v156, v156
    v_exp_f32 v157, v157
    v_exp_f32 v158, v158
    v_exp_f32 v159, v159
    v_mfma_f32_32x32x16_bf16 v[176:191], v[240:243], v[56:59], 0
    v_exp_f32 v160, v160
    v_exp_f32 v161, v161
    v_exp_f32 v162, v162
    v_exp_f32 v163, v163
    v_mfma_f32_32x32x16_bf16 v[176:191], v[244:247], v[60:63], v[176:191]
    v_exp_f32 v164, v164
    v_exp_f32 v165, v165
    v_exp_f32 v166, v166
    v_exp_f32 v167, v167
    v_smfmac_f32_32x32x32_bf16 v[80:95], v[252:255], v[152:159], v12
    v_exp_f32 v168, v168
    v_exp_f32 v169, v169
    v_exp_f32 v170, v170
    v_exp_f32 v171, v171
    v_smfmac_f32_32x32x32_bf16 v[96:111], v[248:251], v[160:167], v12
    v_exp_f32 v172, v172
    v_exp_f32 v173, v173
    v_exp_f32 v174, v174
    v_exp_f32 v175, v175
    s_waitcnt vmcnt(8)
    v_mfma_f32_32x32x16_bf16 v[128:143], v[192:195], v[32:35], 0
    v_exp_f32 v176, v176
    v_exp_f32 v177, v177
    v_exp_f32 v178, v178
    v_exp_f32 v179, v179
    v_mfma_f32_32x32x16_bf16 v[128:143], v[196:199], v[36:39], v[128:143]
    v_exp_f32 v180, v180
    v_exp_f32 v181, v181
    v_exp_f32 v182, v182
    v_exp_f32 v183, v183
    v_smfmac_f32_32x32x32_bf16 v[96:111], v[252:255], v[168:175], v12
    v_exp_f32 v184, v184
    v_exp_f32 v185, v185
    v_exp_f32 v186, v186
    v_exp_f32 v187, v187
    v_smfmac_f32_32x32x32_bf16 v[112:127], v[248:251], v[176:183], v12
    v_exp_f32 v188, v188
    v_exp_f32 v189, v189
    v_exp_f32 v190, v190
    v_exp_f32 v191, v191
    v_mfma_f32_32x32x16_bf16 v[144:159], v[192:195], v[40:43], 0
    v_exp_f32 v128, v128
    v_exp_f32 v129, v129
    v_exp_f32 v130, v130
    v_exp_f32 v131, v131
    v_mfma_f32_32x32x16_bf16 v[144:159], v[196:199], v[44:47], v[144:159]
    v_exp_f32 v132, v132
    v_exp_f32 v133, v133
    v_exp_f32 v134, v134
    v_exp_f32 v135, v135
    v_smfmac_f32_32x32x32_bf16 v[112:127], v[252:255], v[184:191], v12
    buffer_load_dwordx4 v[240:243], v28, s[24:27], s51 offen offset:0 sc1
    buffer_load_dwordx4 v[244:247], v28, s[24:27], s51 offen offset:1024 sc1
    buffer_load_dwordx4 v[248:251], v28, s[24:27], s51 offen offset:2048 sc1
    buffer_load_dwordx4 v[252:255], v28, s[24:27], s51 offen offset:3072 sc1
    s_add_u32 s43, s43, 16384
    s_xor_b32 s51, s43, s39
    s_add_u32 s51, s51, s41
    v_exp_f32 v136, v136
    v_exp_f32 v137, v137
    v_exp_f32 v138, v138
    v_exp_f32 v139, v139
    v_smfmac_f32_32x32x32_bf16 v[64:79], v[200:203], v[128:135], v12
    v_exp_f32 v140, v140
    v_exp_f32 v141, v141
    v_exp_f32 v142, v142
    v_exp_f32 v143, v143
    v_mfma_f32_32x32x16_bf16 v[160:175], v[192:195], v[48:51], 0
    v_exp_f32 v144, v144
    v_exp_f32 v145, v145
    v_exp_f32 v146, v146
    v_exp_f32 v147, v147
    v_mfma_f32_32x32x16_bf16 v[160:175], v[196:199], v[52:55], v[160:175]
    v_exp_f32 v148, v148
    v_exp_f32 v149, v149
    v_exp_f32 v150, v150
    v_exp_f32 v151, v151
    v_smfmac_f32_32x32x32_bf16 v[64:79], v[204:207], v[136:143], v12
    v_exp_f32 v152, v152
    v_exp_f32 v153, v153
    v_exp_f32 v154, v154
    v_exp_f32 v155, v155
    v_smfmac_f32_32x32x32_bf16 v[80:95], v[200:203], v[144:151], v12
    v_exp_f32 v156, v156
    v_exp_f32 v157, v157
    v_exp_f32 v158, v158
    v_exp_f32 v159, v159
    v_mfma_f32_32x32x16_bf16 v[176:191], v[192:195], v[56:59], 0
    v_exp_f32 v160, v160
    v_exp_f32 v161, v161
    v_exp_f32 v162, v162
    v_exp_f32 v163, v163
    v_mfma_f32_32x32x16_bf16 v[176:191], v[196:199], v[60:63], v[176:191]
    v_exp_f32 v164, v164
    v_exp_f32 v165, v165
    v_exp_f32 v166, v166
    v_exp_f32 v167, v167
    v_smfmac_f32_32x32x32_bf16 v[80:95], v[204:207], v[152:159], v12
    v_exp_f32 v168, v168
    v_exp_f32 v169, v169
    v_exp_f32 v170, v170
    v_exp_f32 v171, v171
    v_smfmac_f32_32x32x32_bf16 v[96:111], v[200:203], v[160:167], v12
    v_exp_f32 v172, v172
    v_exp_f32 v173, v173
    v_exp_f32 v174, v174
    v_exp_f32 v175, v175
    s_waitcnt vmcnt(8)
    v_mfma_f32_32x32x16_bf16 v[128:143], v[208:211], v[32:35], 0
    v_exp_f32 v176, v176
    v_exp_f32 v177, v177
    v_exp_f32 v178, v178
    v_exp_f32 v179, v179
    v_mfma_f32_32x32x16_bf16 v[128:143], v[212:215], v[36:39], v[128:143]
    v_exp_f32 v180, v180
    v_exp_f32 v181, v181
    v_exp_f32 v182, v182
    v_exp_f32 v183, v183
    v_smfmac_f32_32x32x32_bf16 v[96:111], v[204:207], v[168:175], v12
    v_exp_f32 v184, v184
    v_exp_f32 v185, v185
    v_exp_f32 v186, v186
    v_exp_f32 v187, v187
    v_smfmac_f32_32x32x32_bf16 v[112:127], v[200:203], v[176:183], v12
    v_exp_f32 v188, v188
    v_exp_f32 v189, v189
    v_exp_f32 v190, v190
    v_exp_f32 v191, v191
    v_mfma_f32_32x32x16_bf16 v[144:159], v[208:211], v[40:43], 0
    v_exp_f32 v128, v128
    v_exp_f32 v129, v129
    v_exp_f32 v130, v130
    v_exp_f32 v131, v131
    v_mfma_f32_32x32x16_bf16 v[144:159], v[212:215], v[44:47], v[144:159]
    v_exp_f32 v132, v132
    v_exp_f32 v133, v133
    v_exp_f32 v134, v134
    v_exp_f32 v135, v135
    v_smfmac_f32_32x32x32_bf16 v[112:127], v[204:207], v[184:191], v12
    v_exp_f32 v136, v136
    v_exp_f32 v137, v137
    v_exp_f32 v138, v138
    v_exp_f32 v139, v139
    v_smfmac_f32_32x32x32_bf16 v[64:79], v[216:219], v[128:135], v12
    v_exp_f32 v140, v140
    v_exp_f32 v141, v141
    v_exp_f32 v142, v142
    v_exp_f32 v143, v143
    v_mfma_f32_32x32x16_bf16 v[160:175], v[208:211], v[48:51], 0
    v_exp_f32 v144, v144
    v_exp_f32 v145, v145
    v_exp_f32 v146, v146
    v_exp_f32 v147, v147
    v_mfma_f32_32x32x16_bf16 v[160:175], v[212:215], v[52:55], v[160:175]
    v_exp_f32 v148, v148
    v_exp_f32 v149, v149
    v_exp_f32 v150, v150
    v_exp_f32 v151, v151
    v_smfmac_f32_32x32x32_bf16 v[64:79], v[220:223], v[136:143], v12
    v_exp_f32 v152, v152
    v_exp_f32 v153, v153
    v_exp_f32 v154, v154
    v_exp_f32 v155, v155
    v_smfmac_f32_32x32x32_bf16 v[80:95], v[216:219], v[144:151], v12
    v_exp_f32 v156, v156
    v_exp_f32 v157, v157
    v_exp_f32 v158, v158
    v_exp_f32 v159, v159
    v_mfma_f32_32x32x16_bf16 v[176:191], v[208:211], v[56:59], 0
    v_exp_f32 v160, v160
    v_exp_f32 v161, v161
    v_exp_f32 v162, v162
    v_exp_f32 v163, v163
    v_mfma_f32_32x32x16_bf16 v[176:191], v[212:215], v[60:63], v[176:191]
    v_exp_f32 v164, v164
    v_exp_f32 v165, v165
    v_exp_f32 v166, v166
    v_exp_f32 v167, v167
    v_smfmac_f32_32x32x32_bf16 v[80:95], v[220:223], v[152:159], v12
    v_exp_f32 v168, v168
    v_exp_f32 v169, v169
    v_exp_f32 v170, v170
    v_exp_f32 v171, v171
    v_smfmac_f32_32x32x32_bf16 v[96:111], v[216:219], v[160:167], v12
    v_exp_f32 v172, v172
    v_exp_f32 v173, v173
    v_exp_f32 v174, v174
    v_exp_f32 v175, v175
    s_waitcnt vmcnt(4)
    v_mfma_f32_32x32x16_bf16 v[128:143], v[224:227], v[32:35], 0
    v_exp_f32 v176, v176
    v_exp_f32 v177, v177
    v_exp_f32 v178, v178
    v_exp_f32 v179, v179
    v_mfma_f32_32x32x16_bf16 v[128:143], v[228:231], v[36:39], v[128:143]
    v_exp_f32 v180, v180
    v_exp_f32 v181, v181
    v_exp_f32 v182, v182
    v_exp_f32 v183, v183
    v_smfmac_f32_32x32x32_bf16 v[96:111], v[220:223], v[168:175], v12
    v_exp_f32 v184, v184
    v_exp_f32 v185, v185
    v_exp_f32 v186, v186
    v_exp_f32 v187, v187
    v_smfmac_f32_32x32x32_bf16 v[112:127], v[216:219], v[176:183], v12
    v_exp_f32 v188, v188
    v_exp_f32 v189, v189
    v_exp_f32 v190, v190
    v_exp_f32 v191, v191
    v_mfma_f32_32x32x16_bf16 v[144:159], v[224:227], v[40:43], 0
    v_exp_f32 v128, v128
    v_exp_f32 v129, v129
    v_exp_f32 v130, v130
    v_exp_f32 v131, v131
    v_mfma_f32_32x32x16_bf16 v[144:159], v[228:231], v[44:47], v[144:159]
    v_exp_f32 v132, v132
    v_exp_f32 v133, v133
    v_exp_f32 v134, v134
    v_exp_f32 v135, v135
    v_smfmac_f32_32x32x32_bf16 v[112:127], v[220:223], v[184:191], v12
    v_exp_f32 v136, v136
    v_exp_f32 v137, v137
    v_exp_f32 v138, v138
    v_exp_f32 v139, v139
    v_smfmac_f32_32x32x32_bf16 v[64:79], v[232:235], v[128:135], v12
    v_exp_f32 v140, v140
    v_exp_f32 v141, v141
    v_exp_f32 v142, v142
    v_exp_f32 v143, v143
    v_mfma_f32_32x32x16_bf16 v[160:175], v[224:227], v[48:51], 0
    v_exp_f32 v144, v144
    v_exp_f32 v145, v145
    v_exp_f32 v146, v146
    v_exp_f32 v147, v147
    v_mfma_f32_32x32x16_bf16 v[160:175], v[228:231], v[52:55], v[160:175]
    v_exp_f32 v148, v148
    v_exp_f32 v149, v149
    v_exp_f32 v150, v150
    v_exp_f32 v151, v151
    v_smfmac_f32_32x32x32_bf16 v[64:79], v[236:239], v[136:143], v12
    v_exp_f32 v152, v152
    v_exp_f32 v153, v153
    v_exp_f32 v154, v154
    v_exp_f32 v155, v155
    v_smfmac_f32_32x32x32_bf16 v[80:95], v[232:235], v[144:151], v12
    v_exp_f32 v156, v156
    v_exp_f32 v157, v157
    v_exp_f32 v158, v158
    v_exp_f32 v159, v159
    v_mfma_f32_32x32x16_bf16 v[176:191], v[224:227], v[56:59], 0
    v_exp_f32 v160, v160
    v_exp_f32 v161, v161
    v_exp_f32 v162, v162
    v_exp_f32 v163, v163
    v_mfma_f32_32x32x16_bf16 v[176:191], v[228:231], v[60:63], v[176:191]
    v_exp_f32 v164, v164
    v_exp_f32 v165, v165
    v_exp_f32 v166, v166
    v_exp_f32 v167, v167
    v_smfmac_f32_32x32x32_bf16 v[80:95], v[236:239], v[152:159], v12
    v_exp_f32 v168, v168
    v_exp_f32 v169, v169
    v_exp_f32 v170, v170
    v_exp_f32 v171, v171
    v_smfmac_f32_32x32x32_bf16 v[96:111], v[232:235], v[160:167], v12
    v_exp_f32 v172, v172
    v_exp_f32 v173, v173
    v_exp_f32 v174, v174
    v_exp_f32 v175, v175
    s_waitcnt vmcnt(0)
    ds_read_b32 v18, v17 offset:8
    v_mfma_f32_32x32x16_bf16 v[128:143], v[240:243], v[32:35], 0
    v_exp_f32 v176, v176
    v_exp_f32 v177, v177
    v_exp_f32 v178, v178
    v_exp_f32 v179, v179
    v_mfma_f32_32x32x16_bf16 v[128:143], v[244:247], v[36:39], v[128:143]
    v_exp_f32 v180, v180
    v_exp_f32 v181, v181
    v_exp_f32 v182, v182
    v_exp_f32 v183, v183
    v_smfmac_f32_32x32x32_bf16 v[96:111], v[236:239], v[168:175], v12
    v_exp_f32 v184, v184
    v_exp_f32 v185, v185
    v_exp_f32 v186, v186
    v_exp_f32 v187, v187
    v_smfmac_f32_32x32x32_bf16 v[112:127], v[232:235], v[176:183], v12
    v_exp_f32 v188, v188
    v_exp_f32 v189, v189
    v_exp_f32 v190, v190
    v_exp_f32 v191, v191
    v_mfma_f32_32x32x16_bf16 v[144:159], v[240:243], v[40:43], 0
    v_exp_f32 v128, v128
    v_exp_f32 v129, v129
    v_exp_f32 v130, v130
    v_exp_f32 v131, v131
    v_mfma_f32_32x32x16_bf16 v[144:159], v[244:247], v[44:47], v[144:159]
    v_exp_f32 v132, v132
    v_exp_f32 v133, v133
    v_exp_f32 v134, v134
    v_exp_f32 v135, v135
    v_smfmac_f32_32x32x32_bf16 v[112:127], v[236:239], v[184:191], v12
    s_mov_b32 s61, 200000
K2_RW2:
    s_waitcnt lgkmcnt(0)
    v_readfirstlane_b32 s44, v18
    s_sub_u32 s44, s44, 4290847552
    s_cmp_ge_u32 s44, 256
    s_cbranch_scc1 K2_RD2
    s_sub_u32 s61, s61, 1
    s_cbranch_scc1 K2_RD2
    ds_read_b32 v18, v17 offset:8
    s_branch K2_RW2
K2_RD2:
    s_lshl_b32 s54, s29, 2
    s_add_u32 s54, s54, s36
    v_and_b32 v17, 31, v1
    v_lshlrev_b32 v17, 3, v17
    s_lshl_b32 s44, s54, 8
    s_add_u32 s44, s44, 13631492
    buffer_load_dword v23, v17, s[24:27], s44 offen sc1
    s_and_b32 s44, s62, 0x3fffffff
    v_mov_b32 v20, s44
    v_exp_f32 v136, v136
    v_exp_f32 v137, v137
    v_exp_f32 v138, v138
    v_exp_f32 v139, v139
    v_smfmac_f32_32x32x32_bf16 v[64:79], v[248:251], v[128:135], v12
    v_exp_f32 v140, v140
    v_exp_f32 v141, v141
    v_exp_f32 v142, v142
    v_exp_f32 v143, v143
    v_mfma_f32_32x32x16_bf16 v[160:175], v[240:243], v[48:51], 0
    v_exp_f32 v144, v144
    v_exp_f32 v145, v145
    v_exp_f32 v146, v146
    v_exp_f32 v147, v147
    v_mfma_f32_32x32x16_bf16 v[160:175], v[244:247], v[52:55], v[160:175]
    v_exp_f32 v148, v148
    v_exp_f32 v149, v149
    v_exp_f32 v150, v150
    v_exp_f32 v151, v151
    v_smfmac_f32_32x32x32_bf16 v[64:79], v[252:255], v[136:143], v12
    v_exp_f32 v152, v152
    v_exp_f32 v153, v153
    v_exp_f32 v154, v154
    v_exp_f32 v155, v155
    v_smfmac_f32_32x32x32_bf16 v[80:95], v[248:251], v[144:151], v12
    v_exp_f32 v156, v156
    v_exp_f32 v157, v157
    v_exp_f32 v158, v158
    v_exp_f32 v159, v159
    v_mfma_f32_32x32x16_bf16 v[176:191], v[240:243], v[56:59], 0
    v_exp_f32 v160, v160
    v_exp_f32 v161, v161
    v_exp_f32 v162, v162
    v_exp_f32 v163, v163
    v_mfma_f32_32x32x16_bf16 v[176:191], v[244:247], v[60:63], v[176:191]
    v_cndmask_b32 v79, v79, v20, s[48:49]
    ds_write_b128 v13, v[64:67] offset:0
    ds_write_b128 v13, v[68:71] offset:1024
    ds_write_b128 v13, v[72:75] offset:2048
    ds_write_b128 v13, v[76:79] offset:3072
    v_exp_f32 v164, v164
    v_exp_f32 v165, v165
    v_exp_f32 v166, v166
    v_exp_f32 v167, v167
    v_smfmac_f32_32x32x32_bf16 v[80:95], v[252:255], v[152:159], v12
    v_exp_f32 v168, v168
    v_exp_f32 v169, v169
    v_exp_f32 v170, v170
    v_exp_f32 v171, v171
    v_smfmac_f32_32x32x32_bf16 v[96:111], v[248:251], v[160:167], v12
    v_exp_f32 v172, v172
    v_exp_f32 v173, v173
    v_exp_f32 v174, v174
    v_exp_f32 v175, v175
    v_exp_f32 v176, v176
    v_exp_f32 v177, v177
    v_exp_f32 v178, v178
    v_exp_f32 v179, v179
    v_cndmask_b32 v95, v95, v20, s[48:49]
    ds_write_b128 v14, v[80:83] offset:0
    ds_write_b128 v14, v[84:87] offset:1024
    ds_write_b128 v14, v[88:91] offset:2048
    ds_write_b128 v14, v[92:95] offset:3072
    v_exp_f32 v180, v180
    v_exp_f32 v181, v181
    v_exp_f32 v182, v182
    v_exp_f32 v183, v183
    v_smfmac_f32_32x32x32_bf16 v[96:111], v[252:255], v[168:175], v12
    v_exp_f32 v184, v184
    v_exp_f32 v185, v185
    v_exp_f32 v186, v186
    v_exp_f32 v187, v187
    v_smfmac_f32_32x32x32_bf16 v[112:127], v[248:251], v[176:183], v12
    v_exp_f32 v188, v188
    v_exp_f32 v189, v189
    v_exp_f32 v190, v190
    v_exp_f32 v191, v191
    s_nop 1
    v_smfmac_f32_32x32x32_bf16 v[112:127], v[252:255], v[184:191], v12
    s_lshl_b32 s44, s31, 2
    s_and_b32 s45, s30, 3
    s_add_u32 s55, s44, s45
    s_lshr_b32 s51, s30, 2
    s_lshr_b32 s45, s36, 1
    s_lshl_b32 s59, s55, 1
    s_add_u32 s59, s59, s45
    s_xor_b32 s43, s59, 1
    v_cndmask_b32 v111, v111, v20, s[48:49]
    ds_write_b128 v15, v[96:99] offset:0
    ds_write_b128 v15, v[100:103] offset:1024
    ds_write_b128 v15, v[104:107] offset:2048
    ds_write_b128 v15, v[108:111] offset:3072
    s_mov_b32 s61, 200000
K2_TW:
    ds_read_b128 v[140:143], v16 offset:3072
    ds_read_b128 v[156:159], v16 offset:7168
    ds_read_b128 v[172:175], v16 offset:11264
    s_waitcnt lgkmcnt(0)
    v_xor_b32 v4, v20, v143
    v_xor_b32 v5, v20, v159
    v_xor_b32 v6, v20, v175
    v_or3_b32 v4, v4, v5, v6
    v_cmp_ne_u32 vcc, 0, v4
    s_sub_u32 s61, s61, 1
    s_cbranch_scc1 K2_TD
    s_cmp_lg_u32 vcc_hi, 0
    s_cbranch_scc1 K2_TW
K2_TD:
    ds_read_b128 v[128:131], v16 offset:0
    ds_read_b128 v[132:135], v16 offset:1024
    ds_read_b128 v[136:139], v16 offset:2048
    ds_read_b128 v[144:147], v16 offset:4096
    ds_read_b128 v[148:151], v16 offset:5120
    ds_read_b128 v[152:155], v16 offset:6144
    ds_read_b128 v[160:163], v16 offset:8192
    ds_read_b128 v[164:167], v16 offset:9216
    ds_read_b128 v[168:171], v16 offset:10240
    s_mov_b32 s50, 0
    v_pk_add_f32 v[124:125], v[124:125], v[140:141]
    v_pk_add_f32 v[126:127], v[126:127], v[142:143]
    v_pk_add_f32 v[124:125], v[124:125], v[156:157]
    v_pk_add_f32 v[126:127], v[126:127], v[158:159]
    v_pk_add_f32 v[124:125], v[124:125], v[172:173]
    v_pk_add_f32 v[126:127], v[126:127], v[174:175]
    v_mov_b32 v4, v124
    v_mov_b32 v5, v124
    s_waitcnt lgkmcnt(6)
    v_pk_add_f32 v[112:113], v[112:113], v[128:129]
    v_pk_add_f32 v[114:115], v[114:115], v[130:131]
    v_pk_add_f32 v[116:117], v[116:117], v[132:133]
    v_pk_add_f32 v[118:119], v[118:119], v[134:135]
    v_pk_add_f32 v[120:121], v[120:121], v[136:137]
    v_pk_add_f32 v[122:123], v[122:123], v[138:139]
    v_permlane32_swap_b32 v4, v5
    s_waitcnt lgkmcnt(3)
    v_pk_add_f32 v[112:113], v[112:113], v[144:145]
    v_pk_add_f32 v[114:115], v[114:115], v[146:147]
    v_pk_add_f32 v[116:117], v[116:117], v[148:149]
    v_pk_add_f32 v[118:119], v[118:119], v[150:151]
    v_pk_add_f32 v[120:121], v[120:121], v[152:153]
    v_pk_add_f32 v[122:123], v[122:123], v[154:155]
    s_waitcnt lgkmcnt(0)
    v_pk_add_f32 v[112:113], v[112:113], v[160:161]
    v_pk_add_f32 v[114:115], v[114:115], v[162:163]
    v_pk_add_f32 v[116:117], v[116:117], v[164:165]
    v_pk_add_f32 v[118:119], v[118:119], v[166:167]
    v_pk_add_f32 v[120:121], v[120:121], v[168:169]
    v_pk_add_f32 v[122:123], v[122:123], v[170:171]
    s_waitcnt vmcnt(0)
K2_FIN:
    v_rcp_f32 v6, v5
    s_lshl_b32 s44, s54, 15
    s_lshl_b32 s45, s28, 11
    s_add_u32 s44, s44, s45
    s_add_u32 s44, s44, 8388608
    v_mul_f32 v6, v6, v23
    v_mov_b32 v7, v6
    v_pk_mul_f32 v[112:113], v[112:113], v[6:7]
    v_pk_mul_f32 v[114:115], v[114:115], v[6:7]
    v_pk_mul_f32 v[116:117], v[116:117], v[6:7]
    v_pk_mul_f32 v[118:119], v[118:119], v[6:7]
    v_pk_mul_f32 v[120:121], v[120:121], v[6:7]
    v_pk_mul_f32 v[122:123], v[122:123], v[6:7]
    v_pk_mul_f32 v[124:125], v[124:125], v[6:7]
    v_pk_mul_f32 v[126:127], v[126:127], v[6:7]
    v_cvt_pk_bf16_f32 v128, v112, v113
    v_cvt_pk_bf16_f32 v129, v114, v115
    v_cvt_pk_bf16_f32 v130, v116, v117
    v_cvt_pk_bf16_f32 v131, v118, v119
    v_cvt_pk_bf16_f32 v132, v120, v121
    v_cvt_pk_bf16_f32 v133, v122, v123
    v_cvt_pk_bf16_f32 v134, v124, v125
    v_cvt_pk_bf16_f32 v135, v126, v127
    v_cndmask_b32 v134, v134, 0, s[48:49]
    v_cndmask_b32 v135, v135, 0, s[48:49]
    buffer_store_dwordx4 v[128:131], v2, s[24:27], s44 offen sc1
    buffer_store_dwordx4 v[132:135], v2, s[24:27], s44 offen offset:1024 sc1
    s_lshl_b32 s45, s59, 8
    s_lshl_b32 s46, s43, 8
    s_add_u32 s45, s45, 13631488
    s_add_u32 s46, s46, 13631488
    buffer_load_dword v22, v17, s[24:27], s45 offen sc1
    buffer_load_dword v24, v17, s[24:27], s46 offen sc1
    s_cmp_lg_u32 s50, 0
    s_cbranch_scc1 K2_OK
    v_pk_add_f32 v[136:137], v[112:113], v[114:115]
    v_pk_add_f32 v[138:139], v[116:117], v[118:119]
    v_pk_add_f32 v[140:141], v[120:121], v[122:123]
    v_pk_add_f32 v[142:143], v[124:125], v[126:127]
    v_pk_add_f32 v[136:137], v[136:137], v[138:139]
    v_pk_add_f32 v[140:141], v[140:141], v[142:143]
    v_pk_add_f32 v[136:137], v[136:137], v[140:141]
    v_add_f32 v6, v136, v137
    v_fma_f32 v6, v6, 0, v5
    v_cmp_le_f32 vcc, 0x30800000, v6
    s_mov_b64 s[44:45], vcc
    v_cmp_ge_f32 vcc, 0x53800000, v6
    s_and_b64 vcc, vcc, s[44:45]
    s_cmp_eq_u64 vcc, -1
    s_cbranch_scc0 K2_SLOW
K2_OK:
    s_lshl_b32 s52, s54, 4
    s_add_u32 s52, s52, s28
    s_lshl_b32 s52, s52, 7
    s_add_u32 s52, s52, 16121856
    s_cmp_ge_u32 s2, 224
    s_cbranch_scc0 K3_GO
    s_waitcnt vmcnt(0)
    v_cmp_gt_u32 vcc, 16, v1
    v_lshlrev_b32 v8, 3, v1
    v_mov_b32 v10, 2146435072
    v_cndmask_b32 v10, v10, v8, vcc
    v_mov_b32 v8, s62
    v_mov_b32 v9, s63
    buffer_store_dwordx2 v[8:9], v10, s[24:27], s52 offen sc1
    s_endpgm
K2_SLOW:
    s_lshl_b32 s41, s28, 18
    s_add_u32 s41, s41, 2097152
    s_mov_b32 s50, 0
    v_mov_b32 v112, 0
    v_mov_b32 v113, 0
    v_mov_b32 v114, 0
    v_mov_b32 v115, 0
    v_mov_b32 v116, 0
    v_mov_b32 v117, 0
    v_mov_b32 v118, 0
    v_mov_b32 v119, 0
    v_mov_b32 v120, 0
    v_mov_b32 v121, 0
    v_mov_b32 v122, 0
    v_mov_b32 v123, 0
    v_mov_b32 v124, 0
    v_mov_b32 v125, 0
    v_mov_b32 v126, 0
    v_mov_b32 v127, 0
    v_mov_b32 v8, 0xff7fffff
K2_SLOOP:
    buffer_load_dwordx4 v[64:67], v2, s[24:27], s41 offen offset:0 sc1
    buffer_load_dwordx4 v[68:71], v2, s[24:27], s41 offen offset:1024 sc1
    buffer_load_dwordx4 v[72:75], v2, s[24:27], s41 offen offset:2048 sc1
    buffer_load_dwordx4 v[76:79], v2, s[24:27], s41 offen offset:3072 sc1
    s_waitcnt vmcnt(0)
    v_mfma_f32_32x32x16_bf16 v[128:143], v[64:67], v[56:59], 0
    v_mfma_f32_32x32x16_bf16 v[128:143], v[68:71], v[60:63], v[128:143]
    s_nop 15
    v_max3_f32 v9, v8, v128, v129
    v_max3_f32 v9, v9, v130, v131
    v_max3_f32 v9, v9, v132, v133
    v_max3_f32 v9, v9, v134, v135
    v_max3_f32 v9, v9, v136, v137
    v_max3_f32 v9, v9, v138, v139
    v_max3_f32 v9, v9, v140, v141
    v_max3_f32 v9, v9, v142, v143
    v_mov_b32 v10, v9
    s_nop 1
    v_permlane32_swap_b32 v9, v10
    s_nop 1
    v_max_f32 v9, v9, v10
    v_sub_f32 v10, v8, v9
    v_exp_f32 v10, v10
    v_mov_b32 v8, v9
    v_sub_f32 v128, v128, v9
    v_sub_f32 v129, v129, v9
    v_sub_f32 v130, v130, v9
    v_sub_f32 v131, v131, v9
    v_sub_f32 v132, v132, v9
    v_sub_f32 v133, v133, v9
    v_sub_f32 v134, v134, v9
    v_sub_f32 v135, v135, v9
    v_sub_f32 v136, v136, v9
    v_sub_f32 v137, v137, v9
    v_sub_f32 v138, v138, v9
    v_sub_f32 v139, v139, v9
    v_sub_f32 v140, v140, v9
    v_sub_f32 v141, v141, v9
    v_sub_f32 v142, v142, v9
    v_sub_f32 v143, v143, v9
    v_exp_f32 v128, v128
    v_exp_f32 v129, v129
    v_exp_f32 v130, v130
    v_exp_f32 v131, v131
    v_exp_f32 v132, v132
    v_exp_f32 v133, v133
    v_exp_f32 v134, v134
    v_exp_f32 v135, v135
    v_exp_f32 v136, v136
    v_exp_f32 v137, v137
    v_exp_f32 v138, v138
    v_exp_f32 v139, v139
    v_exp_f32 v140, v140
    v_exp_f32 v141, v141
    v_exp_f32 v142, v142
    v_exp_f32 v143, v143
    v_mul_f32 v112, v112, v10
    v_mul_f32 v113, v113, v10
    v_mul_f32 v114, v114, v10
    v_mul_f32 v115, v115, v10
    v_mul_f32 v116, v116, v10
    v_mul_f32 v117, v117, v10
    v_mul_f32 v118, v118, v10
    v_mul_f32 v119, v119, v10
    v_mul_f32 v120, v120, v10
    v_mul_f32 v121, v121, v10
    v_mul_f32 v122, v122, v10
    v_mul_f32 v123, v123, v10
    v_mul_f32 v124, v124, v10
    v_mul_f32 v125, v125, v10
    v_mul_f32 v126, v126, v10
    v_mul_f32 v127, v127, v10
    s_nop 1
    v_smfmac_f32_32x32x32_bf16 v[112:127], v[72:75], v[128:135], v12
    v_smfmac_f32_32x32x32_bf16 v[112:127], v[76:79], v[136:143], v12
    s_nop 15
    s_add_u32 s41, s41, 4096
    s_add_u32 s50, s50, 1
    s_cmp_lg_u32 s50, 64
    s_cbranch_scc1 K2_SLOOP
    v_mov_b32 v4, v124
    v_mov_b32 v5, v124
    s_nop 1
    v_permlane32_swap_b32 v4, v5
    s_nop 1
    s_branch K2_FIN
K3_GO:
    s_and_b32 s44, s36, 1
    s_lshl_b32 s58, s51, 1
    s_add_u32 s58, s58, s44
    v_and_b32 v8, 31, v1
    v_lshrrev_b32 v9, 5, v1
    s_xor_b32 s46, s58, 0
    s_lshl_b32 s46, s46, 5
    v_add_u32 v20, s46, v8
    v_cvt_f32_u32 v20, v20
    s_xor_b32 s46, s58, 1
    s_lshl_b32 s46, s46, 5
    v_add_u32 v21, s46, v8
    v_cvt_f32_u32 v21, v21
    s_mul_i32 s46, s36, 56
    v_lshl_add_u32 v4, v9, 2, s46
    v_cvt_f32_u32 v4, v4
    v_and_b32 v12, 1, v1
    v_lshlrev_b32 v12, 31, v12
    v_or_b32 v12, 0x3f003f00, v12
    s_mov_b32 s57, 0
    s_cmp_eq_u32 s36, 0
    s_cselect_b32 s56, -1, 0
    v_mul_u32_u24 v18, 57344, v8
    v_lshl_add_u32 v18, v9, 4, v18
    s_mul_i32 s46, s59, 896
    s_lshl_b32 s47, s58, 6
    s_add_u32 s46, s46, s47
    v_add_u32 v18, s46, v18
    v_bfe_u32 v10, v1, 2, 2
    v_lshl_add_u32 v9, v9, 2, v10
    s_mul_i32 s46, s36, 112
    v_add_lshl_u32 v9, s46, v9, 7
    v_lshrrev_b32 v10, 1, v10
    v_xor_b32 v10, s44, v10
    v_lshl_add_u32 v9, v10, 6, v9
    v_bfe_u32 v10, v1, 4, 1
    v_lshl_add_u32 v9, v10, 5, v9
    v_and_b32 v10, 3, v1
    v_lshl_add_u32 v26, v10, 3, v9
    v_xor_b32 v27, 64, v26
    s_xor_b32 s44, s36, 1
    s_mul_i32 s44, s44, 12288
    s_add_u32 s44, s44, 106496
    v_add_u32 v13, s44, v2
    s_xor_b32 s44, s36, 2
    s_mul_i32 s44, s44, 12288
    s_add_u32 s44, s44, 110592
    v_add_u32 v14, s44, v2
    s_xor_b32 s44, s36, 3
    s_mul_i32 s44, s44, 12288
    s_add_u32 s44, s44, 114688
    v_add_u32 v15, s44, v2
    v_add_u32 v16, 49152, v16
    s_cmp_eq_u32 s36, 3
    s_cselect_b32 s44, 57344, 0
    v_mov_b32 v10, s44
    v_cndmask_b32 v10, 0, v10, s[48:49]
    v_sub_u32 v28, v26, v10
    v_xor_b32 v29, 64, v28
    v_lshrrev_b32 v9, 5, v1
    v_bfe_u32 v10, v1, 2, 2
    v_lshl_add_u32 v9, v9, 3, v10
    v_lshlrev_b32 v9, 6, v9
    v_bfe_u32 v10, v1, 4, 1
    v_lshl_add_u32 v9, v10, 5, v9
    v_and_b32 v10, 3, v1
    v_lshl_add_u32 v9, v10, 3, v9
    s_mul_i32 s44, s36, 14336
    s_add_u32 s44, s44, 106496
    v_add_u32 v17, s44, v9
    v_mul_f32 v8, v4, v20
    v_mul_f32 v9, 0x3b124925, v8
    v_floor_f32 v9, v9
    v_fmamk_f32 v8, v9, 0xc3e00000, v8
    v_mul_f32 v8, 0x3b124925, v8
    v_mul_f32 v20, 0x3b124925, v20
    v_fmamk_f32 v144, v20, 0x0, v8
    v_sin_f32 v145, -v144
    v_cos_f32 v144, v144
    v_fmamk_f32 v146, v20, 0x3f800000, v8
    v_sin_f32 v147, -v146
    v_cos_f32 v146, v146
    v_fmamk_f32 v148, v20, 0x40000000, v8
    v_sin_f32 v149, -v148
    v_cos_f32 v148, v148
    v_fmamk_f32 v150, v20, 0x40400000, v8
    v_sin_f32 v151, -v150
    v_cos_f32 v150, v150
    v_fmamk_f32 v160, v20, 0xc1000000, v8
    v_sin_f32 v161, -v160
    v_cos_f32 v160, v160
    v_fmamk_f32 v162, v20, 0xc0e00000, v8
    v_sin_f32 v163, -v162
    v_cos_f32 v162, v162
    v_fmamk_f32 v164, v20, 0xc0c00000, v8
    v_sin_f32 v165, -v164
    v_cos_f32 v164, v164
    v_fmamk_f32 v166, v20, 0xc0a00000, v8
    v_sin_f32 v167, -v166
    v_cos_f32 v166, v166
    v_mul_f32 v20, 0x41000000, v20
    v_cos_f32 v20, v20
    s_nop 0
    v_add_f32 v20, v20, v20
    s_waitcnt vmcnt(2)
    v_cmp_gt_u32 vcc, 16, v1
    v_lshlrev_b32 v8, 3, v1
    v_mov_b32 v10, 2146435072
    v_cndmask_b32 v10, v10, v8, vcc
    v_mov_b32 v8, s62
    v_mov_b32 v9, s63
    buffer_store_dwordx2 v[8:9], v10, s[24:27], s52 offen sc1
    v_mul_f32 v8, v4, v21
    v_mul_f32 v9, 0x3b124925, v8
    v_floor_f32 v9, v9
    v_fmamk_f32 v8, v9, 0xc3e00000, v8
    v_mul_f32 v8, 0x3b124925, v8
    v_mul_f32 v21, 0x3b124925, v21
    v_fmamk_f32 v152, v21, 0x0, v8
    v_sin_f32 v153, -v152
    v_cos_f32 v152, v152
    v_fmamk_f32 v154, v21, 0x3f800000, v8
    v_sin_f32 v155, -v154
    v_cos_f32 v154, v154
    v_fmamk_f32 v156, v21, 0x40000000, v8
    v_sin_f32 v157, -v156
    v_cos_f32 v156, v156
    v_fmamk_f32 v158, v21, 0x40400000, v8
    v_sin_f32 v159, -v158
    v_cos_f32 v158, v158
    v_fmamk_f32 v168, v21, 0xc1000000, v8
    v_sin_f32 v169, -v168
    v_cos_f32 v168, v168
    v_fmamk_f32 v170, v21, 0xc0e00000, v8
    v_sin_f32 v171, -v170
    v_cos_f32 v170, v170
    v_fmamk_f32 v172, v21, 0xc0c00000, v8
    v_sin_f32 v173, -v172
    v_cos_f32 v172, v172
    v_fmamk_f32 v174, v21, 0xc0a00000, v8
    v_sin_f32 v175, -v174
    v_cos_f32 v174, v174
    v_mul_f32 v21, 0x41000000, v21
    v_cos_f32 v21, v21
    s_nop 0
    v_add_f32 v21, v21, v21
    v_cvt_pk_bf16_f32 v176, v144, v145
    v_cvt_pk_bf16_f32 v177, v146, v147
    v_cvt_pk_bf16_f32 v178, v148, v149
    v_cvt_pk_bf16_f32 v179, v150, v151
    v_cvt_pk_bf16_f32 v180, v152, v153
    v_cvt_pk_bf16_f32 v181, v154, v155
    v_cvt_pk_bf16_f32 v182, v156, v157
    v_cvt_pk_bf16_f32 v183, v158, v159
    v_cndmask_b32 v176, v176, v12, s[56:57]
    v_cndmask_b32 v180, v180, v12, s[56:57]
    s_barrier
    ds_read_b64_tr_b16 v[48:49], v17 offset:0
    ds_read_b64_tr_b16 v[50:51], v17 offset:256
    ds_read_b64_tr_b16 v[52:53], v17 offset:7168
    ds_read_b64_tr_b16 v[54:55], v17 offset:7424
    ds_read_b64_tr_b16 v[56:57], v17 offset:1024
    ds_read_b64_tr_b16 v[58:59], v17 offset:1280
    ds_read_b64_tr_b16 v[60:61], v17 offset:8192
    ds_read_b64_tr_b16 v[62:63], v17 offset:8448
    v_and_b32 v8, 3, v1
    v_bfe_u32 v9, v1, 2, 1
    v_lshl_add_u32 v8, v9, 4, v8
    v_lshlrev_b32 v8, 7, v8
    s_lshl_b32 s44, s55, 5
    s_lshl_b32 s45, s36, 2
    s_add_u32 s44, s44, s45
    s_lshl_b32 s44, s44, 7
    s_add_u32 s53, s44, 16121856
    s_waitcnt lgkmcnt(4)
    v_mfma_f32_32x32x16_bf16 v[112:127], v[180:183], v[52:55], 0
    ds_read_b64_tr_b16 v[136:137], v17 offset:2048
    ds_read_b64_tr_b16 v[138:139], v17 offset:2304
    ds_read_b64_tr_b16 v[140:141], v17 offset:9216
    ds_read_b64_tr_b16 v[142:143], v17 offset:9472
    v_fma_f32 v160, v20, v144, -v160
    v_fma_f32 v161, v20, v145, -v161
    v_fma_f32 v162, v20, v146, -v162
    v_mfma_f32_32x32x16_bf16 v[96:111], v[176:179], v[52:55], 0
    v_fma_f32 v163, v20, v147, -v163
    v_fma_f32 v164, v20, v148, -v164
    v_fma_f32 v165, v20, v149, -v165
    v_fma_f32 v166, v20, v150, -v166
    v_fma_f32 v167, v20, v151, -v167
    v_fma_f32 v168, v21, v152, -v168
    v_fma_f32 v169, v21, v153, -v169
    v_mfma_f32_32x32x16_bf16 v[80:95], v[180:183], v[48:51], 0
    v_fma_f32 v170, v21, v154, -v170
    v_fma_f32 v171, v21, v155, -v171
    v_fma_f32 v172, v21, v156, -v172
    v_fma_f32 v173, v21, v157, -v173
    v_fma_f32 v174, v21, v158, -v174
    v_fma_f32 v175, v21, v159, -v175
    v_cvt_pk_bf16_f32 v184, v160, v161
    v_mfma_f32_32x32x16_bf16 v[64:79], v[176:179], v[48:51], 0
    v_cvt_pk_bf16_f32 v185, v162, v163
    v_cvt_pk_bf16_f32 v186, v164, v165
    v_cvt_pk_bf16_f32 v187, v166, v167
    v_cvt_pk_bf16_f32 v188, v168, v169
    v_cvt_pk_bf16_f32 v189, v170, v171
    v_cvt_pk_bf16_f32 v190, v172, v173
    v_cvt_pk_bf16_f32 v191, v174, v175
    s_nop 0
    s_waitcnt lgkmcnt(4)
    v_mfma_f32_32x32x16_bf16 v[112:127], v[188:191], v[60:63], v[112:127]
    ds_read_b64_tr_b16 v[48:49], v17 offset:3072
    ds_read_b64_tr_b16 v[50:51], v17 offset:3328
    ds_read_b64_tr_b16 v[52:53], v17 offset:10240
    ds_read_b64_tr_b16 v[54:55], v17 offset:10496
    v_fma_f32 v144, v20, v160, -v144
    v_fma_f32 v145, v20, v161, -v145
    v_fma_f32 v146, v20, v162, -v146
    v_mfma_f32_32x32x16_bf16 v[96:111], v[184:187], v[60:63], v[96:111]
    v_fma_f32 v147, v20, v163, -v147
    v_fma_f32 v148, v20, v164, -v148
    v_fma_f32 v149, v20, v165, -v149
    v_fma_f32 v150, v20, v166, -v150
    v_fma_f32 v151, v20, v167, -v151
    v_fma_f32 v152, v21, v168, -v152
    v_fma_f32 v153, v21, v169, -v153
    v_mfma_f32_32x32x16_bf16 v[80:95], v[188:191], v[56:59], v[80:95]
    v_fma_f32 v154, v21, v170, -v154
    v_fma_f32 v155, v21, v171, -v155
    v_fma_f32 v156, v21, v172, -v156
    v_fma_f32 v157, v21, v173, -v157
    v_fma_f32 v158, v21, v174, -v158
    v_fma_f32 v159, v21, v175, -v159
    v_cvt_pk_bf16_f32 v176, v144, v145
    v_mfma_f32_32x32x16_bf16 v[64:79], v[184:187], v[56:59], v[64:79]
    v_cvt_pk_bf16_f32 v177, v146, v147
    v_cvt_pk_bf16_f32 v178, v148, v149
    v_cvt_pk_bf16_f32 v179, v150, v151
    v_cvt_pk_bf16_f32 v180, v152, v153
    v_cvt_pk_bf16_f32 v181, v154, v155
    v_cvt_pk_bf16_f32 v182, v156, v157
    v_cvt_pk_bf16_f32 v183, v158, v159
    s_nop 0
    s_waitcnt lgkmcnt(4)
    v_mfma_f32_32x32x16_bf16 v[112:127], v[180:183], v[140:143], v[112:127]
    ds_read_b64_tr_b16 v[56:57], v17 offset:4096
    ds_read_b64_tr_b16 v[58:59], v17 offset:4352
    ds_read_b64_tr_b16 v[60:61], v17 offset:11264
    ds_read_b64_tr_b16 v[62:63], v17 offset:11520
    v_fma_f32 v160, v20, v144, -v160
    v_fma_f32 v161, v20, v145, -v161
    v_fma_f32 v162, v20, v146, -v162
    v_mfma_f32_32x32x16_bf16 v[96:111], v[176:179], v[140:143], v[96:111]
    v_fma_f32 v163, v20, v147, -v163
    v_fma_f32 v164, v20, v148, -v164
    v_fma_f32 v165, v20, v149, -v165
    v_fma_f32 v166, v20, v150, -v166
    v_fma_f32 v167, v20, v151, -v167
    v_fma_f32 v168, v21, v152, -v168
    v_fma_f32 v169, v21, v153, -v169
    v_mfma_f32_32x32x16_bf16 v[80:95], v[180:183], v[136:139], v[80:95]
    v_fma_f32 v170, v21, v154, -v170
    v_fma_f32 v171, v21, v155, -v171
    v_fma_f32 v172, v21, v156, -v172
    v_fma_f32 v173, v21, v157, -v173
    v_fma_f32 v174, v21, v158, -v174
    v_fma_f32 v175, v21, v159, -v175
    v_cvt_pk_bf16_f32 v184, v160, v161
    v_mfma_f32_32x32x16_bf16 v[64:79], v[176:179], v[136:139], v[64:79]
    v_cvt_pk_bf16_f32 v185, v162, v163
    v_cvt_pk_bf16_f32 v186, v164, v165
    v_cvt_pk_bf16_f32 v187, v166, v167
    v_cvt_pk_bf16_f32 v188, v168, v169
    v_cvt_pk_bf16_f32 v189, v170, v171
    v_cvt_pk_bf16_f32 v190, v172, v173
    v_cvt_pk_bf16_f32 v191, v174, v175
    s_nop 0
    s_waitcnt lgkmcnt(4)
    v_mfma_f32_32x32x16_bf16 v[112:127], v[188:191], v[52:55], v[112:127]
    ds_read_b64_tr_b16 v[136:137], v17 offset:5120
    ds_read_b64_tr_b16 v[138:139], v17 offset:5376
    ds_read_b64_tr_b16 v[140:141], v17 offset:12288
    ds_read_b64_tr_b16 v[142:143], v17 offset:12544
    v_fma_f32 v144, v20, v160, -v144
    v_fma_f32 v145, v20, v161, -v145
    v_fma_f32 v146, v20, v162, -v146
    v_mfma_f32_32x32x16_bf16 v[96:111], v[184:187], v[52:55], v[96:111]
    v_fma_f32 v147, v20, v163, -v147
    v_fma_f32 v148, v20, v164, -v148
    v_fma_f32 v149, v20, v165, -v149
    v_fma_f32 v150, v20, v166, -v150
    v_fma_f32 v151, v20, v167, -v151
    v_fma_f32 v152, v21, v168, -v152
    v_fma_f32 v153, v21, v169, -v153
    v_mfma_f32_32x32x16_bf16 v[80:95], v[188:191], v[48:51], v[80:95]
    v_fma_f32 v154, v21, v170, -v154
    v_fma_f32 v155, v21, v171, -v155
    v_fma_f32 v156, v21, v172, -v156
    v_fma_f32 v157, v21, v173, -v157
    v_fma_f32 v158, v21, v174, -v158
    v_fma_f32 v159, v21, v175, -v159
    v_cvt_pk_bf16_f32 v176, v144, v145
    v_mfma_f32_32x32x16_bf16 v[64:79], v[184:187], v[48:51], v[64:79]
    v_cvt_pk_bf16_f32 v177, v146, v147
    v_cvt_pk_bf16_f32 v178, v148, v149
    v_cvt_pk_bf16_f32 v179, v150, v151
    v_cvt_pk_bf16_f32 v180, v152, v153
    v_cvt_pk_bf16_f32 v181, v154, v155
    v_cvt_pk_bf16_f32 v182, v156, v157
    v_cvt_pk_bf16_f32 v183, v158, v159
    s_nop 0
    s_waitcnt lgkmcnt(4)
    v_mfma_f32_32x32x16_bf16 v[112:127], v[180:183], v[60:63], v[112:127]
    ds_read_b64_tr_b16 v[48:49], v17 offset:6144
    ds_read_b64_tr_b16 v[50:51], v17 offset:6400
    ds_read_b64_tr_b16 v[52:53], v17 offset:13312
    ds_read_b64_tr_b16 v[54:55], v17 offset:13568
    v_fma_f32 v160, v20, v144, -v160
    v_fma_f32 v161, v20, v145, -v161
    v_fma_f32 v162, v20, v146, -v162
    v_mfma_f32_32x32x16_bf16 v[96:111], v[176:179], v[60:63], v[96:111]
    v_fma_f32 v163, v20, v147, -v163
    v_fma_f32 v164, v20, v148, -v164
    v_fma_f32 v165, v20, v149, -v165
    v_fma_f32 v166, v20, v150, -v166
    v_fma_f32 v167, v20, v151, -v167
    v_fma_f32 v168, v21, v152, -v168
    v_fma_f32 v169, v21, v153, -v169
    v_mfma_f32_32x32x16_bf16 v[80:95], v[180:183], v[56:59], v[80:95]
    v_fma_f32 v170, v21, v154, -v170
    v_fma_f32 v171, v21, v155, -v171
    v_fma_f32 v172, v21, v156, -v172
    v_fma_f32 v173, v21, v157, -v173
    v_fma_f32 v174, v21, v158, -v174
    v_fma_f32 v175, v21, v159, -v175
    v_cvt_pk_bf16_f32 v184, v160, v161
    v_mfma_f32_32x32x16_bf16 v[64:79], v[176:179], v[56:59], v[64:79]
    v_cvt_pk_bf16_f32 v185, v162, v163
    v_cvt_pk_bf16_f32 v186, v164, v165
    v_cvt_pk_bf16_f32 v187, v166, v167
    v_cvt_pk_bf16_f32 v188, v168, v169
    v_cvt_pk_bf16_f32 v189, v170, v171
    v_cvt_pk_bf16_f32 v190, v172, v173
    v_cvt_pk_bf16_f32 v191, v174, v175
    s_nop 0
    s_waitcnt lgkmcnt(4)
    v_mfma_f32_32x32x16_bf16 v[112:127], v[188:191], v[140:143], v[112:127]
    v_fma_f32 v144, v20, v160, -v144
    v_fma_f32 v145, v20, v161, -v145
    v_fma_f32 v146, v20, v162, -v146
    v_fma_f32 v147, v20, v163, -v147
    v_fma_f32 v148, v20, v164, -v148
    v_fma_f32 v149, v20, v165, -v149
    v_mfma_f32_32x32x16_bf16 v[96:111], v[184:187], v[140:143], v[96:111]
    v_fma_f32 v150, v20, v166, -v150
    v_fma_f32 v151, v20, v167, -v151
    v_fma_f32 v152, v21, v168, -v152
    v_fma_f32 v153, v21, v169, -v153
    v_fma_f32 v154, v21, v170, -v154
    v_fma_f32 v155, v21, v171, -v155
    v_mfma_f32_32x32x16_bf16 v[80:95], v[188:191], v[136:139], v[80:95]
    v_fma_f32 v156, v21, v172, -v156
    v_fma_f32 v157, v21, v173, -v157
    v_fma_f32 v158, v21, v174, -v158
    v_fma_f32 v159, v21, v175, -v159
    v_cvt_pk_bf16_f32 v176, v144, v145
    v_cvt_pk_bf16_f32 v177, v146, v147
    v_mfma_f32_32x32x16_bf16 v[64:79], v[184:187], v[136:139], v[64:79]
    v_cvt_pk_bf16_f32 v178, v148, v149
    v_cvt_pk_bf16_f32 v179, v150, v151
    v_cvt_pk_bf16_f32 v180, v152, v153
    v_cvt_pk_bf16_f32 v181, v154, v155
    v_cvt_pk_bf16_f32 v182, v156, v157
    v_cvt_pk_bf16_f32 v183, v158, v159
    s_nop 0
    s_waitcnt lgkmcnt(0)
    v_mfma_f32_32x32x16_bf16 v[112:127], v[180:183], v[52:55], v[112:127]
    ds_read_b64_tr_b16 v[32:33], v26 offset:0
    ds_read_b64_tr_b16 v[34:35], v26 offset:1024
    v_mfma_f32_32x32x16_bf16 v[96:111], v[176:179], v[52:55], v[96:111]
    ds_read_b64_tr_b16 v[36:37], v27 offset:0
    ds_read_b64_tr_b16 v[38:39], v27 offset:1024
    v_mfma_f32_32x32x16_bf16 v[80:95], v[180:183], v[48:51], v[80:95]
    ds_read_b64_tr_b16 v[40:41], v26 offset:2048
    ds_read_b64_tr_b16 v[42:43], v26 offset:3072
    v_mfma_f32_32x32x16_bf16 v[64:79], v[176:179], v[48:51], v[64:79]
    ds_read_b64_tr_b16 v[44:45], v27 offset:2048
    ds_read_b64_tr_b16 v[46:47], v27 offset:3072
    s_mov_b32 s61, 200000
POLL9:
    buffer_load_dwordx2 v[10:11], v8, s[24:27], s53 offen offset:0 sc1
    s_waitcnt vmcnt(0)
    v_xor_b32 v10, s62, v10
    v_xor_b32 v11, s63, v11
    v_or_b32 v10, v10, v11
    v_cmp_ne_u32 vcc, 0, v10
    s_sub_u32 s61, s61, 1
    s_cbranch_scc1 POLL9_X
    s_cmp_eq_u64 vcc, 0
    s_cbranch_scc1 POLL9_X
    s_sleep 2
    s_branch POLL9
POLL9_X:
    s_lshl_b32 s44, s36, 13
    s_add_u32 s44, s44, 8388608
    s_lshl_b32 s45, s59, 15
    s_lshl_b32 s46, s43, 15
    s_add_u32 s45, s45, s44
    s_add_u32 s46, s46, s44
    buffer_load_dwordx4 v[192:195], v2, s[24:27], s45 offen offset:0 sc1
    buffer_load_dwordx4 v[196:199], v2, s[24:27], s46 offen offset:0 sc1
    buffer_load_dwordx4 v[200:203], v2, s[24:27], s45 offen offset:1024 sc1
    buffer_load_dwordx4 v[204:207], v2, s[24:27], s46 offen offset:1024 sc1
    buffer_load_dwordx4 v[208:211], v2, s[24:27], s45 offen offset:2048 sc1
    buffer_load_dwordx4 v[212:215], v2, s[24:27], s46 offen offset:2048 sc1
    buffer_load_dwordx4 v[216:219], v2, s[24:27], s45 offen offset:3072 sc1
    buffer_load_dwordx4 v[220:223], v2, s[24:27], s46 offen offset:3072 sc1
    s_add_u32 s45, s45, 4096
    s_add_u32 s46, s46, 4096
    buffer_load_dwordx4 v[224:227], v2, s[24:27], s45 offen offset:0 sc1
    buffer_load_dwordx4 v[228:231], v2, s[24:27], s46 offen offset:0 sc1
    buffer_load_dwordx4 v[232:235], v2, s[24:27], s45 offen offset:1024 sc1
    buffer_load_dwordx4 v[236:239], v2, s[24:27], s46 offen offset:1024 sc1
    buffer_load_dwordx4 v[240:243], v2, s[24:27], s45 offen offset:2048 sc1
    buffer_load_dwordx4 v[244:247], v2, s[24:27], s46 offen offset:2048 sc1
    buffer_load_dwordx4 v[248:251], v2, s[24:27], s45 offen offset:3072 sc1
    buffer_load_dwordx4 v[252:255], v2, s[24:27], s46 offen offset:3072 sc1
    s_barrier
    s_mov_b32 s16, s100
    s_and_b32 s17, s101, 0xffff
    s_mov_b32 s18, 1835008
    s_mov_b32 s19, 0x20000
    v_mov_b32 v23, v22
    v_mov_b32 v25, v24
    s_xor_b32 s44, s36, 0
    s_mul_i32 s44, s44, 4352
    s_mul_i32 s45, s36, 17408
    s_add_u32 s44, s44, s45
    s_add_u32 s44, s44, 57344
    v_add_u32 v16, s44, v2
    s_xor_b32 s44, s36, 1
    s_mul_i32 s44, s44, 4352
    s_mul_i32 s45, s36, 17408
    s_add_u32 s44, s44, s45
    s_add_u32 s44, s44, 57344
    v_add_u32 v13, s44, v2
    s_xor_b32 s44, s36, 2
    s_mul_i32 s44, s44, 4352
    s_mul_i32 s45, s36, 17408
    s_add_u32 s44, s44, s45
    s_add_u32 s44, s44, 57344
    v_add_u32 v14, s44, v2
    s_xor_b32 s44, s36, 3
    s_mul_i32 s44, s44, 4352
    s_mul_i32 s45, s36, 17408
    s_add_u32 s44, s44, s45
    s_add_u32 s44, s44, 57344
    v_add_u32 v15, s44, v2
    s_and_b32 s44, s36, 1
    s_lshl_b32 s44, s44, 4
    v_lshrrev_b32 v5, 3, v1
    v_add_u32 v5, s44, v5
    v_and_b32 v6, 7, v1
    v_mul_u32_u24 v4, 1088, v6
    v_lshl_add_u32 v4, v5, 4, v4
    s_lshr_b32 s44, s36, 1
    s_mul_i32 s44, s44, 8704
    s_add_u32 s44, s44, 57344
    v_add_u32 v4, s44, v4
    v_mul_u32_u24 v18, 57344, v5
    v_lshl_add_u32 v18, v6, 4, v18
    s_mul_i32 s52, s59, 896
    s_lshr_b32 s44, s2, 5
    s_lshl_b32 s44, s44, 7
    s_add_u32 s52, s52, s44
    v_add_u32 v18, s52, v18
    v_add_u32 v5, 458752, v18
    v_pk_mul_f32 v[112:113], v[112:113], v[24:25]
    v_pk_mul_f32 v[114:115], v[114:115], v[24:25]
    v_pk_mul_f32 v[116:117], v[116:117], v[24:25]
    v_pk_mul_f32 v[118:119], v[118:119], v[24:25]
    v_pk_mul_f32 v[120:121], v[120:121], v[24:25]
    v_pk_mul_f32 v[122:123], v[122:123], v[24:25]
    v_pk_mul_f32 v[124:125], v[124:125], v[24:25]
    v_pk_mul_f32 v[126:127], v[126:127], v[24:25]
    v_pk_mul_f32 v[96:97], v[96:97], v[24:25]
    v_pk_mul_f32 v[98:99], v[98:99], v[24:25]
    v_pk_mul_f32 v[100:101], v[100:101], v[24:25]
    v_pk_mul_f32 v[102:103], v[102:103], v[24:25]
    v_pk_mul_f32 v[104:105], v[104:105], v[24:25]
    v_pk_mul_f32 v[106:107], v[106:107], v[24:25]
    v_pk_mul_f32 v[108:109], v[108:109], v[24:25]
    v_pk_mul_f32 v[110:111], v[110:111], v[24:25]
    v_pk_mul_f32 v[80:81], v[80:81], v[22:23]
    v_pk_mul_f32 v[82:83], v[82:83], v[22:23]
    v_pk_mul_f32 v[84:85], v[84:85], v[22:23]
    v_pk_mul_f32 v[86:87], v[86:87], v[22:23]
    v_pk_mul_f32 v[88:89], v[88:89], v[22:23]
    v_pk_mul_f32 v[90:91], v[90:91], v[22:23]
    v_pk_mul_f32 v[92:93], v[92:93], v[22:23]
    v_pk_mul_f32 v[94:95], v[94:95], v[22:23]
    v_pk_mul_f32 v[64:65], v[64:65], v[22:23]
    v_pk_mul_f32 v[66:67], v[66:67], v[22:23]
    v_pk_mul_f32 v[68:69], v[68:69], v[22:23]
    v_pk_mul_f32 v[70:71], v[70:71], v[22:23]
    v_pk_mul_f32 v[72:73], v[72:73], v[22:23]
    v_pk_mul_f32 v[74:75], v[74:75], v[22:23]
    v_pk_mul_f32 v[76:77], v[76:77], v[22:23]
    v_pk_mul_f32 v[78:79], v[78:79], v[22:23]
    s_waitcnt vmcnt(14) lgkmcnt(4)
    v_mfma_f32_32x32x16_bf16 v[112:127], v[36:39], v[196:199], v[112:127]
    v_mfma_f32_32x32x16_bf16 v[96:111], v[32:35], v[196:199], v[96:111]
    v_mfma_f32_32x32x16_bf16 v[80:95], v[36:39], v[192:195], v[80:95]
    v_mfma_f32_32x32x16_bf16 v[64:79], v[32:35], v[192:195], v[64:79]
    ds_read_b64_tr_b16 v[32:33], v26 offset:3584
    ds_read_b64_tr_b16 v[34:35], v26 offset:4608
    ds_read_b64_tr_b16 v[36:37], v27 offset:3584
    ds_read_b64_tr_b16 v[38:39], v27 offset:4608
    s_waitcnt vmcnt(12) lgkmcnt(4)
    v_mfma_f32_32x32x16_bf16 v[112:127], v[44:47], v[204:207], v[112:127]
    v_mfma_f32_32x32x16_bf16 v[96:111], v[40:43], v[204:207], v[96:111]
    v_mfma_f32_32x32x16_bf16 v[80:95], v[44:47], v[200:203], v[80:95]
    v_mfma_f32_32x32x16_bf16 v[64:79], v[40:43], v[200:203], v[64:79]
    ds_read_b64_tr_b16 v[40:41], v26 offset:5632
    ds_read_b64_tr_b16 v[42:43], v26 offset:6656
    ds_read_b64_tr_b16 v[44:45], v27 offset:5632
    ds_read_b64_tr_b16 v[46:47], v27 offset:6656
    s_waitcnt vmcnt(10) lgkmcnt(4)
    v_mfma_f32_32x32x16_bf16 v[112:127], v[36:39], v[212:215], v[112:127]
    v_mfma_f32_32x32x16_bf16 v[96:111], v[32:35], v[212:215], v[96:111]
    v_mfma_f32_32x32x16_bf16 v[80:95], v[36:39], v[208:211], v[80:95]
    v_mfma_f32_32x32x16_bf16 v[64:79], v[32:35], v[208:211], v[64:79]
    ds_read_b64_tr_b16 v[32:33], v26 offset:7168
    ds_read_b64_tr_b16 v[34:35], v26 offset:8192
    ds_read_b64_tr_b16 v[36:37], v27 offset:7168
    ds_read_b64_tr_b16 v[38:39], v27 offset:8192
    s_waitcnt vmcnt(8) lgkmcnt(4)
    v_mfma_f32_32x32x16_bf16 v[112:127], v[44:47], v[220:223], v[112:127]
    v_mfma_f32_32x32x16_bf16 v[96:111], v[40:43], v[220:223], v[96:111]
    v_mfma_f32_32x32x16_bf16 v[80:95], v[44:47], v[216:219], v[80:95]
    v_mfma_f32_32x32x16_bf16 v[64:79], v[40:43], v[216:219], v[64:79]
    ds_read_b64_tr_b16 v[40:41], v26 offset:9216
    ds_read_b64_tr_b16 v[42:43], v26 offset:10240
    ds_read_b64_tr_b16 v[44:45], v27 offset:9216
    ds_read_b64_tr_b16 v[46:47], v27 offset:10240
    s_waitcnt vmcnt(6) lgkmcnt(4)
    v_mfma_f32_32x32x16_bf16 v[112:127], v[36:39], v[228:231], v[112:127]
    v_mfma_f32_32x32x16_bf16 v[96:111], v[32:35], v[228:231], v[96:111]
    v_mfma_f32_32x32x16_bf16 v[80:95], v[36:39], v[224:227], v[80:95]
    v_mfma_f32_32x32x16_bf16 v[64:79], v[32:35], v[224:227], v[64:79]
    ds_read_b64_tr_b16 v[32:33], v26 offset:10752
    ds_read_b64_tr_b16 v[34:35], v26 offset:11776
    ds_read_b64_tr_b16 v[36:37], v27 offset:10752
    ds_read_b64_tr_b16 v[38:39], v27 offset:11776
    s_waitcnt vmcnt(4) lgkmcnt(4)
    v_mfma_f32_32x32x16_bf16 v[112:127], v[44:47], v[236:239], v[112:127]
    v_mfma_f32_32x32x16_bf16 v[96:111], v[40:43], v[236:239], v[96:111]
    v_mfma_f32_32x32x16_bf16 v[80:95], v[44:47], v[232:235], v[80:95]
    v_mfma_f32_32x32x16_bf16 v[64:79], v[40:43], v[232:235], v[64:79]
    ds_read_b64_tr_b16 v[40:41], v26 offset:12800
    ds_read_b64_tr_b16 v[42:43], v28 offset:13824
    ds_read_b64_tr_b16 v[44:45], v27 offset:12800
    ds_read_b64_tr_b16 v[46:47], v29 offset:13824
    s_waitcnt vmcnt(0) lgkmcnt(0)
    v_mfma_f32_32x32x16_bf16 v[112:127], v[36:39], v[244:247], v[112:127]
    v_mfma_f32_32x32x16_bf16 v[112:127], v[44:47], v[252:255], v[112:127]
    v_mfma_f32_32x32x16_bf16 v[96:111], v[32:35], v[244:247], v[96:111]
    s_nop 4
    v_mfma_f32_32x32x16_bf16 v[96:111], v[40:43], v[252:255], v[96:111]
    s_nop 4
    ds_write_b128 v15, v[112:115] offset:0
    ds_write_b128 v15, v[116:119] offset:1088
    v_mfma_f32_32x32x16_bf16 v[80:95], v[36:39], v[240:243], v[80:95]
    ds_write_b128 v15, v[120:123] offset:2176
    ds_write_b128 v15, v[124:127] offset:3264
    v_mfma_f32_32x32x16_bf16 v[80:95], v[44:47], v[248:251], v[80:95]
    s_nop 0
    ds_write_b128 v14, v[96:99] offset:0
    ds_write_b128 v14, v[100:103] offset:1088
    v_mfma_f32_32x32x16_bf16 v[64:79], v[32:35], v[240:243], v[64:79]
    ds_write_b128 v14, v[104:107] offset:2176
    ds_write_b128 v14, v[108:111] offset:3264
    v_mfma_f32_32x32x16_bf16 v[64:79], v[40:43], v[248:251], v[64:79]
    s_nop 4
    ds_write_b128 v13, v[80:83] offset:0
    ds_write_b128 v13, v[84:87] offset:1088
    ds_write_b128 v13, v[88:91] offset:2176
    ds_write_b128 v13, v[92:95] offset:3264
    s_nop 2
    ds_write_b128 v16, v[64:67] offset:0
    ds_write_b128 v16, v[68:71] offset:1088
    ds_write_b128 v16, v[72:75] offset:2176
    ds_write_b128 v16, v[76:79] offset:3264
    s_waitcnt lgkmcnt(0)
    s_barrier
    ds_read_b128 v[128:131], v4 offset:0
    ds_read_b128 v[132:135], v4 offset:512
    ds_read_b128 v[136:139], v4 offset:17408
    ds_read_b128 v[140:143], v4 offset:17920
    ds_read_b128 v[144:147], v4 offset:34816
    ds_read_b128 v[148:151], v4 offset:35328
    ds_read_b128 v[152:155], v4 offset:52224
    ds_read_b128 v[156:159], v4 offset:52736
    ds_read_b128 v[160:163], v4 offset:128
    ds_read_b128 v[164:167], v4 offset:640
    ds_read_b128 v[168:171], v4 offset:17536
    ds_read_b128 v[172:175], v4 offset:18048
    ds_read_b128 v[176:179], v4 offset:34944
    ds_read_b128 v[180:183], v4 offset:35456
    ds_read_b128 v[184:187], v4 offset:52352
    ds_read_b128 v[188:191], v4 offset:52864
    s_waitcnt lgkmcnt(12)
    v_pk_add_f32 v[128:129], v[128:129], v[136:137]
    v_pk_add_f32 v[130:131], v[130:131], v[138:139]
    v_pk_add_f32 v[132:133], v[132:133], v[140:141]
    v_pk_add_f32 v[134:135], v[134:135], v[142:143]
    s_waitcnt lgkmcnt(8)
    v_pk_add_f32 v[144:145], v[144:145], v[152:153]
    v_pk_add_f32 v[146:147], v[146:147], v[154:155]
    v_pk_add_f32 v[148:149], v[148:149], v[156:157]
    v_pk_add_f32 v[150:151], v[150:151], v[158:159]
    v_pk_add_f32 v[128:129], v[128:129], v[144:145]
    v_pk_add_f32 v[130:131], v[130:131], v[146:147]
    v_pk_add_f32 v[132:133], v[132:133], v[148:149]
    v_pk_add_f32 v[134:135], v[134:135], v[150:151]
    v_cvt_pk_bf16_f32 v192, v128, v129
    v_cvt_pk_bf16_f32 v193, v130, v131
    v_cvt_pk_bf16_f32 v194, v132, v133
    v_cvt_pk_bf16_f32 v195, v134, v135
    buffer_store_dwordx4 v[192:195], v18, s[16:19], 0 offen sc1
    s_waitcnt lgkmcnt(4)
    v_pk_add_f32 v[160:161], v[160:161], v[168:169]
    v_pk_add_f32 v[162:163], v[162:163], v[170:171]
    v_pk_add_f32 v[164:165], v[164:165], v[172:173]
    v_pk_add_f32 v[166:167], v[166:167], v[174:175]
    s_waitcnt lgkmcnt(0)
    v_pk_add_f32 v[176:177], v[176:177], v[184:185]
    v_pk_add_f32 v[178:179], v[178:179], v[186:187]
    v_pk_add_f32 v[180:181], v[180:181], v[188:189]
    v_pk_add_f32 v[182:183], v[182:183], v[190:191]
    v_pk_add_f32 v[160:161], v[160:161], v[176:177]
    v_pk_add_f32 v[162:163], v[162:163], v[178:179]
    v_pk_add_f32 v[164:165], v[164:165], v[180:181]
    v_pk_add_f32 v[166:167], v[166:167], v[182:183]
    v_cvt_pk_bf16_f32 v196, v160, v161
    v_cvt_pk_bf16_f32 v197, v162, v163
    v_cvt_pk_bf16_f32 v198, v164, v165
    v_cvt_pk_bf16_f32 v199, v166, v167
    buffer_store_dwordx4 v[196:199], v5, s[16:19], 0 offen sc1
    s_endpgm
K2_FFT:
    s_mov_b32 s52, 0
    s_barrier
    v_mov_b32 v8, 98304
    v_mov_b32 v9, 0
    v_mov_b32 v10, 0
    ds_write2_b32 v8, v9, v10 offset0:0 offset1:1
    ds_write_b32 v8, v9 offset:16
    v_mov_b32 v11, 4290847552
    ds_write2_b32 v8, v9, v11 offset0:2 offset1:3
    s_waitcnt lgkmcnt(0)
    s_barrier
K2_FFS:
    s_setprio 1
    s_mov_b32 s56, s52
    s_bfe_u32 s44, s2, 0x20001
    s_and_b32 s45, s2, 1
    s_lshl_b32 s45, s45, 1
    v_and_b32 v209, 1, v1
    v_bfe_u32 v208, v1, 1, 4
    v_lshl_add_u32 v208, v208, 2, v209
    v_lshrrev_b32 v7, 5, v1
    v_lshl_add_u32 v208, v7, 8, v208
    v_lshlrev_b32 v208, 7, v208
    v_bfe_u32 v7, v1, 1, 1
    v_lshl_add_u32 v209, v7, 2, v209
    v_lshlrev_b32 v209, 7, v209
    s_lshl_b32 s58, s44, 6
    s_add_u32 s58, s58, s45
    s_lshl_b32 s58, s58, 7
    s_add_u32 s58, s58, 15728640
    s_lshl_b32 s59, s44, 4
    s_lshr_b32 s44, s2, 4
    s_add_u32 s59, s59, s44
    s_lshl_b32 s59, s59, 3
    s_add_u32 s59, s59, s45
    s_lshl_b32 s59, s59, 7
    s_add_u32 s59, s59, 15859712
    s_add_u32 s58, s58, 65536
    s_and_b32 s40, s2, 7
    s_lshr_b32 s39, s2, 3
    s_lshr_b32 s44, s39, 2
    s_lshl_b32 s44, s44, 5
    s_lshl_b32 s45, s40, 2
    s_add_u32 s41, s44, s45
    s_and_b32 s44, s39, 3
    s_add_u32 s41, s41, s44
    v_and_b32 v210, 15, v1
    v_lshlrev_b32 v211, 9, v1
    v_mov_b32 v212, v211
    s_lshr_b32 s44, s41, 6
    s_lshl_b32 s45, s44, 7
    s_add_u32 s51, s45, 15990784
    s_lshl_b32 s44, s44, 7
    s_bfe_u32 s45, s41, 0x20004
    s_add_u32 s44, s44, s45
    s_lshl_b32 s44, s44, 7
    s_add_u32 s50, s44, 15925248
    v_add_u32 v211, s50, v211
    s_lshr_b32 s44, s39, 1
    s_lshl_b32 s44, s44, 3
    s_lshl_b32 s45, s40, 2
    s_and_b32 s46, s39, 3
    s_add_u32 s45, s45, s46
    s_lshl_b32 s45, s45, 2
    v_and_b32 v7, 7, v1
    v_add_u32 v7, s44, v7
    v_and_b32 v10, 3, v1
    v_cmp_gt_u32 vcc, 40, v1
    v_add_u32 v10, s45, v10
    s_mov_b32 s50, 16023552
    v_cndmask_b32 v7, v10, v7, vcc
    v_cmp_gt_u32 vcc, 32, v1
    v_lshl_add_u32 v7, v7, 7, s50
    v_and_b32 v10, 31, v1
    v_cndmask_b32 v211, v7, v211, vcc
    v_lshlrev_b32 v10, 3, v10
    v_lshrrev_b32 v7, 5, v1
    v_lshl_add_u32 v213, v7, 9, v10
    s_lshl_b32 s44, s36, 12
    s_cmp_ge_u32 s3, 128
    s_cselect_b32 s45, 0, 0
    s_add_u32 s44, s44, s45
    s_add_u32 s44, s44, 81920
    v_add_u32 v6, s44, v2
    s_cmp_ge_u32 s3, 128
    s_cbranch_scc1 K2_AZ
    s_lshl_b32 s44, s38, 1
    s_lshr_b32 s45, s36, 1
    s_add_u32 s44, s44, s45
    s_lshl_b32 s53, s44, 19
    s_lshr_b32 s44, s37, 2
    s_lshl_b32 s44, s44, 3
    s_and_b32 s45, s37, 3
    s_add_u32 s44, s44, s45
    s_lshl_b32 s44, s44, 1
    s_and_b32 s45, s36, 1
    s_add_u32 s44, s44, s45
    s_lshl_b32 s44, s44, 1
    s_add_u32 s44, s44, s55
    s_lshl_b32 s44, s44, 11
    s_add_u32 s53, s53, s44
    s_add_u32 s53, s53, 2129920
    s_mov_b32 s54, 1024
    s_mov_b32 s60, 261120
    v_mov_b32 v4, v2
    s_lshl_b32 s44, s55, 2
    s_add_u32 s44, s44, s38
    s_lshl_b32 s44, s44, 4
    s_add_u32 s44, s44, s37
    s_mov_b32 s45, 15794176
    s_branch K2_AS
K2_AZ:
    s_lshl_b32 s44, s38, 2
    s_add_u32 s44, s44, s36
    s_lshl_b32 s53, s44, 17
    s_lshl_b32 s44, s37, 1
    s_add_u32 s44, s44, s55
    s_lshl_b32 s45, s44, 8
    s_add_u32 s53, s53, s45
    s_add_u32 s53, s53, 6291456
    s_mov_b32 s54, 32768
    s_mov_b32 s60, 32768
    v_lshrrev_b32 v4, 4, v1
    v_lshlrev_b32 v4, 13, v4
    v_and_b32 v5, 15, v1
    v_lshl_add_u32 v4, v5, 4, v4
    s_lshl_b32 s45, s38, 5
    s_add_u32 s44, s44, s45
    s_mov_b32 s45, 15925248
K2_AS:
    s_lshl_b32 s44, s44, 2
    s_add_u32 s44, s44, s36
    s_lshl_b32 s44, s44, 7
    s_add_u32 s57, s44, s45
    s_sleep 6
    ds_read_b128 v[60:63], v6 offset:0
    ds_read_b128 v[64:67], v6 offset:1024
    ds_read_b128 v[68:71], v6 offset:2048
    ds_read_b128 v[72:75], v6 offset:3072
    s_waitcnt lgkmcnt(3)
    buffer_store_dwordx4 v[60:63], v4, s[24:27], s53 offen sc1
    s_add_u32 s53, s53, s54
    s_waitcnt lgkmcnt(2)
    buffer_store_dwordx4 v[64:67], v4, s[24:27], s53 offen sc1
    s_add_u32 s53, s53, s60
    s_waitcnt lgkmcnt(1)
    buffer_store_dwordx4 v[68:71], v4, s[24:27], s53 offen sc1
    s_add_u32 s53, s53, s54
    s_waitcnt lgkmcnt(0)
    buffer_store_dwordx4 v[72:75], v4, s[24:27], s53 offen sc1
    s_waitcnt vmcnt(0)
    v_cmp_gt_u32 vcc, 16, v1
    v_lshlrev_b32 v8, 3, v1
    v_mov_b32 v10, 2146435072
    v_cndmask_b32 v10, v10, v8, vcc
    v_mov_b32 v8, s62
    v_mov_b32 v9, s63
    buffer_store_dwordx2 v[8:9], v10, s[24:27], s57 offen sc1
    s_cmp_eq_u32 s56, 0
    s_cbranch_scc1 K2_NSF
    v_cmp_gt_u32 vcc, 16, v1
    v_lshlrev_b32 v8, 3, v1
    v_mov_b32 v10, 2146435072
    v_cndmask_b32 v10, v10, v8, vcc
    v_mov_b32 v8, s62
    v_mov_b32 v9, s63
    buffer_store_dwordx2 v[8:9], v10, s[24:27], s56 offen sc1
K2_NSF:
    v_mov_b32 v8, 98308
    s_cmp_ge_u32 s36, 2
    s_cbranch_scc1 K2_PW
    s_cmp_eq_u32 s36, 1
    s_cbranch_scc1 K2_PZ
    s_sleep 40
    s_mov_b32 s61, 200000
POLL10:
    buffer_load_dwordx2 v[60:61], v208, s[24:27], s58 offen offset:0 sc1
    s_waitcnt vmcnt(0)
    v_xor_b32 v60, s62, v60
    v_xor_b32 v61, s63, v61
    v_or_b32 v60, v60, v61
    v_cmp_ne_u32 vcc, 0, v60
    s_sub_u32 s61, s61, 1
    s_cbranch_scc1 POLL10_X
    s_cmp_eq_u64 vcc, 0
    s_cbranch_scc1 POLL10_X
    s_sleep 8
    s_branch POLL10
POLL10_X:
    ds_write_b32 v8, v8
    s_branch K2_PW
K2_PZ:
    s_sleep 32
    s_mov_b32 s61, 200000
POLL11:
    buffer_load_dwordx2 v[60:61], v211, s[24:27], 0 offen offset:0 sc1
    buffer_load_dwordx2 v[62:63], v212, s[24:27], s51 offen offset:0 sc1
    s_waitcnt vmcnt(0)
    v_xor_b32 v60, s62, v60
    v_xor_b32 v61, s63, v61
    v_xor_b32 v62, s62, v62
    v_xor_b32 v63, s63, v63
    v_or_b32 v60, v60, v61
    v_or_b32 v60, v60, v62
    v_or_b32 v60, v60, v63
    v_cmp_ne_u32 vcc, 0, v60
    s_sub_u32 s61, s61, 1
    s_cbranch_scc1 POLL11_X
    s_cmp_eq_u64 vcc, 0
    s_cbranch_scc1 POLL11_X
    s_sleep 8
    s_branch POLL11
POLL11_X:
    ds_write_b32 v8, v8 offset:4
K2_PW:
    s_mov_b32 s61, 200000
K2_PWL:
    ds_read_b32 v9, v8 offset:4
    s_waitcnt lgkmcnt(0)
    v_readfirstlane_b32 s44, v9
    s_cmp_lg_u32 s44, 0
    s_cbranch_scc1 K2_PWD
    s_sub_u32 s61, s61, 1
    s_cbranch_scc1 K2_PWD
    s_sleep 3
    s_branch K2_PWL
K2_PWD:
    s_cmp_gt_u32 s41, 224
    s_cbranch_scc1 K2_FSKIP
    s_lshl_b32 s44, s41, 13
    s_add_u32 s44, s44, 6291456
    s_add_u32 s45, s44, 4096
    s_lshl_b32 s56, s36, 11
    s_add_u32 s56, s56, s44
    s_add_u32 s56, s56, 10485760
    s_lshl_b32 s46, s36, 11
    s_add_u32 s44, s44, s46
    s_add_u32 m0, s46, 65536
    v_add_u32 v213, 65536, v213
    buffer_load_dwordx4 v2, s[24:27], s44 offen sc1 lds
    buffer_load_dwordx4 v2, s[24:27], s44 offen offset:1024 sc1 lds
    buffer_load_dwordx4 v[44:47], v2, s[24:27], s56 offen sc1
    buffer_load_dwordx4 v[48:51], v2, s[24:27], s56 offen offset:1024 sc1
    v_mov_b32 v8, 98320
    v_mov_b32 v9, 1
    s_waitcnt vmcnt(2)
    ds_add_u32 v8, v9
    s_mov_b32 s61, 200000
K2_ZW:
    ds_read_b32 v9, v8
    s_waitcnt lgkmcnt(0)
    v_readfirstlane_b32 s45, v9
    s_sub_u32 s61, s61, 1
    s_cbranch_scc1 K2_ZD
    s_cmp_ge_u32 s45, 256
    s_cbranch_scc1 K2_ZD
    s_sleep 1
    s_branch K2_ZW
K2_ZD:
    ds_read_b64 v[12:13], v213 offset:0
    ds_read_b64 v[14:15], v213 offset:256
    ds_read_b64 v[16:17], v213 offset:1024
    ds_read_b64 v[18:19], v213 offset:1280
    ds_read_b64 v[20:21], v213 offset:2048
    ds_read_b64 v[22:23], v213 offset:2304
    ds_read_b64 v[24:25], v213 offset:3072
    ds_read_b64 v[26:27], v213 offset:3328
    ds_read_b64 v[28:29], v213 offset:4096
    ds_read_b64 v[30:31], v213 offset:4352
    s_waitcnt lgkmcnt(8)
    v_mfma_f32_32x32x16_bf16 v[60:75], v[76:79], v[12:15], 0
    ds_read_b64 v[32:33], v213 offset:5120
    ds_read_b64 v[34:35], v213 offset:5376
    s_waitcnt lgkmcnt(8)
    v_mfma_f32_32x32x16_bf16 v[60:75], v[80:83], v[16:19], v[60:75]
    ds_read_b64 v[36:37], v213 offset:6144
    ds_read_b64 v[38:39], v213 offset:6400
    s_waitcnt lgkmcnt(8)
    v_mfma_f32_32x32x16_bf16 v[60:75], v[84:87], v[20:23], v[60:75]
    ds_read_b64 v[40:41], v213 offset:7168
    ds_read_b64 v[42:43], v213 offset:7424
    s_waitcnt lgkmcnt(8)
    v_mfma_f32_32x32x16_bf16 v[60:75], v[88:91], v[24:27], v[60:75]
    s_waitcnt lgkmcnt(6)
    v_mfma_f32_32x32x16_bf16 v[60:75], v[92:95], v[28:31], v[60:75]
    s_waitcnt lgkmcnt(4)
    v_mfma_f32_32x32x16_bf16 v[60:75], v[96:99], v[32:35], v[60:75]
    s_waitcnt lgkmcnt(2)
    v_mfma_f32_32x32x16_bf16 v[60:75], v[100:103], v[36:39], v[60:75]
    s_waitcnt lgkmcnt(0)
    v_mfma_f32_32x32x16_bf16 v[60:75], v[104:107], v[40:43], v[60:75]
    s_waitcnt vmcnt(0)
    v_and_b32 v59, 0xffff0000, v51
    v_lshlrev_b32 v58, 16, v51
    v_and_b32 v57, 0xffff0000, v50
    v_lshlrev_b32 v56, 16, v50
    v_and_b32 v55, 0xffff0000, v49
    v_lshlrev_b32 v54, 16, v49
    v_and_b32 v53, 0xffff0000, v48
    v_lshlrev_b32 v52, 16, v48
    v_and_b32 v51, 0xffff0000, v47
    v_lshlrev_b32 v50, 16, v47
    v_and_b32 v49, 0xffff0000, v46
    v_lshlrev_b32 v48, 16, v46
    v_and_b32 v47, 0xffff0000, v45
    v_lshlrev_b32 v46, 16, v45
    v_and_b32 v45, 0xffff0000, v44
    v_lshlrev_b32 v44, 16, v44
    v_mul_f32 v8, v68, v45
    v_mul_f32 v9, v68, v44
    v_fma_f32 v8, v60, v44, -v8
    v_fma_f32 v9, v60, v45, v9
    v_cvt_pk_bf16_f32 v172, v8, v9
    v_mul_f32 v8, v69, v47
    v_mul_f32 v9, v69, v46
    v_fma_f32 v8, v61, v46, -v8
    v_fma_f32 v9, v61, v47, v9
    v_cvt_pk_bf16_f32 v173, v8, v9
    v_mul_f32 v8, v70, v49
    v_mul_f32 v9, v70, v48
    v_fma_f32 v8, v62, v48, -v8
    v_fma_f32 v9, v62, v49, v9
    v_cvt_pk_bf16_f32 v174, v8, v9
    v_mul_f32 v8, v71, v51
    v_mul_f32 v9, v71, v50
    v_fma_f32 v8, v63, v50, -v8
    v_fma_f32 v9, v63, v51, v9
    v_cvt_pk_bf16_f32 v175, v8, v9
    v_mul_f32 v8, v72, v53
    v_mul_f32 v9, v72, v52
    v_fma_f32 v8, v64, v52, -v8
    v_fma_f32 v9, v64, v53, v9
    v_cvt_pk_bf16_f32 v176, v8, v9
    v_mul_f32 v8, v73, v55
    v_mul_f32 v9, v73, v54
    v_fma_f32 v8, v65, v54, -v8
    v_fma_f32 v9, v65, v55, v9
    v_cvt_pk_bf16_f32 v177, v8, v9
    v_mul_f32 v8, v74, v57
    v_mul_f32 v9, v74, v56
    v_fma_f32 v8, v66, v56, -v8
    v_fma_f32 v9, v66, v57, v9
    v_cvt_pk_bf16_f32 v178, v8, v9
    v_mul_f32 v8, v75, v59
    v_mul_f32 v9, v75, v58
    v_fma_f32 v8, v67, v58, -v8
    v_fma_f32 v9, v67, v59, v9
    v_cvt_pk_bf16_f32 v179, v8, v9
    ds_write_b128 v205, v[172:175]
    ds_write_b128 v205, v[176:179] offset:1024
    v_mov_b32 v8, 98304
    v_mov_b32 v9, 1
    s_waitcnt lgkmcnt(0)
    ds_add_u32 v8, v9
    s_mov_b32 s61, 200000
K2_XW:
    ds_read_b32 v9, v8
    s_waitcnt lgkmcnt(0)
    v_readfirstlane_b32 s44, v9
    s_sub_u32 s61, s61, 1
    s_cbranch_scc1 K2_XD
    s_cmp_ge_u32 s44, 256
    s_cbranch_scc1 K2_XD
    s_sleep 2
    s_branch K2_XW
K2_XD:
    ds_read_b128 v[12:15], v206 offset:0
    ds_read_b128 v[16:19], v206 offset:256
    ds_read_b128 v[20:23], v206 offset:2048
    ds_read_b128 v[24:27], v206 offset:2304
    ds_read_b128 v[28:31], v206 offset:4096
    ds_read_b128 v[32:35], v206 offset:4352
    ds_read_b128 v[36:39], v206 offset:6144
    ds_read_b128 v[40:43], v206 offset:6400
    s_waitcnt lgkmcnt(6)
    v_mfma_f32_16x16x32_bf16 v[172:175], v[12:15], v[108:111], 0
    v_mfma_f32_16x16x32_bf16 v[176:179], v[12:15], v[124:127], 0
    v_mfma_f32_16x16x32_bf16 v[180:183], v[16:19], v[108:111], 0
    v_mfma_f32_16x16x32_bf16 v[184:187], v[16:19], v[124:127], 0
    s_waitcnt lgkmcnt(4)
    v_mfma_f32_16x16x32_bf16 v[172:175], v[20:23], v[112:115], v[172:175]
    v_mfma_f32_16x16x32_bf16 v[176:179], v[20:23], v[128:131], v[176:179]
    v_mfma_f32_16x16x32_bf16 v[180:183], v[24:27], v[112:115], v[180:183]
    v_mfma_f32_16x16x32_bf16 v[184:187], v[24:27], v[128:131], v[184:187]
    s_waitcnt lgkmcnt(2)
    v_mfma_f32_16x16x32_bf16 v[172:175], v[28:31], v[116:119], v[172:175]
    v_mfma_f32_16x16x32_bf16 v[176:179], v[28:31], v[132:135], v[176:179]
    v_mfma_f32_16x16x32_bf16 v[180:183], v[32:35], v[116:119], v[180:183]
    v_mfma_f32_16x16x32_bf16 v[184:187], v[32:35], v[132:135], v[184:187]
    s_waitcnt lgkmcnt(0)
    v_mfma_f32_16x16x32_bf16 v[172:175], v[36:39], v[120:123], v[172:175]
    v_mfma_f32_16x16x32_bf16 v[176:179], v[36:39], v[136:139], v[176:179]
    v_mfma_f32_16x16x32_bf16 v[180:183], v[40:43], v[120:123], v[180:183]
    v_mfma_f32_16x16x32_bf16 v[184:187], v[40:43], v[136:139], v[184:187]
    s_nop 7
    v_mul_f32 v8, v176, v189
    v_mul_f32 v9, v176, v188
    v_fma_f32 v8, v172, v188, -v8
    v_fma_f32 v9, v172, v189, v9
    v_cvt_pk_bf16_f32 v12, v8, v9
    v_mul_f32 v8, v177, v191
    v_mul_f32 v9, v177, v190
    v_fma_f32 v8, v173, v190, -v8
    v_fma_f32 v9, v173, v191, v9
    v_cvt_pk_bf16_f32 v13, v8, v9
    v_mul_f32 v8, v178, v193
    v_mul_f32 v9, v178, v192
    v_fma_f32 v8, v174, v192, -v8
    v_fma_f32 v9, v174, v193, v9
    v_cvt_pk_bf16_f32 v14, v8, v9
    v_mul_f32 v8, v179, v195
    v_mul_f32 v9, v179, v194
    v_fma_f32 v8, v175, v194, -v8
    v_fma_f32 v9, v175, v195, v9
    v_cvt_pk_bf16_f32 v15, v8, v9
    v_mul_f32 v8, v184, v197
    v_mul_f32 v9, v184, v196
    v_fma_f32 v8, v180, v196, -v8
    v_fma_f32 v9, v180, v197, v9
    v_cvt_pk_bf16_f32 v16, v8, v9
    v_mul_f32 v8, v185, v199
    v_mul_f32 v9, v185, v198
    v_fma_f32 v8, v181, v198, -v8
    v_fma_f32 v9, v181, v199, v9
    v_cvt_pk_bf16_f32 v17, v8, v9
    v_mul_f32 v8, v186, v201
    v_mul_f32 v9, v186, v200
    v_fma_f32 v8, v182, v200, -v8
    v_fma_f32 v9, v182, v201, v9
    v_cvt_pk_bf16_f32 v18, v8, v9
    v_mul_f32 v8, v187, v203
    v_mul_f32 v9, v187, v202
    v_fma_f32 v8, v183, v202, -v8
    v_fma_f32 v9, v183, v203, v9
    v_cvt_pk_bf16_f32 v19, v8, v9
    s_mul_i32 s44, s36, 458752
    s_add_u32 s44, s44, 10485760
    v_mfma_f32_16x16x32_bf16 v[60:63], v[140:143], v[12:15], 0
    v_mfma_f32_16x16x32_bf16 v[64:67], v[148:151], v[12:15], 0
    v_mfma_f32_16x16x32_bf16 v[68:71], v[156:159], v[12:15], 0
    v_mfma_f32_16x16x32_bf16 v[72:75], v[164:167], v[12:15], 0
    v_mfma_f32_16x16x32_bf16 v[60:63], v[144:147], v[16:19], v[60:63]
    v_mfma_f32_16x16x32_bf16 v[64:67], v[152:155], v[16:19], v[64:67]
    v_mfma_f32_16x16x32_bf16 v[68:71], v[160:163], v[16:19], v[68:71]
    v_mfma_f32_16x16x32_bf16 v[72:75], v[168:171], v[16:19], v[72:75]
    s_lshl_b32 s52, s36, 8
    s_add_u32 s52, s52, s41
    s_lshl_b32 s52, s52, 7
    s_add_u32 s52, s52, 16252928
    s_lshl_b32 s45, s41, 7
    s_cmp_eq_u32 s41, 224
    s_cselect_b32 s45, 64, s45
    s_cselect_b32 s41, 0, s41
    s_add_u32 s44, s44, s45
    v_cvt_pk_bf16_f32 v172, v60, v61
    v_cvt_pk_bf16_f32 v173, v62, v63
    v_cvt_pk_bf16_f32 v174, v68, v69
    v_cvt_pk_bf16_f32 v175, v70, v71
    v_cvt_pk_bf16_f32 v176, v64, v65
    v_cvt_pk_bf16_f32 v177, v66, v67
    v_cvt_pk_bf16_f32 v178, v72, v73
    v_cvt_pk_bf16_f32 v179, v74, v75
    s_nop 0
    v_permlane16_swap_b32 v172, v174
    v_permlane16_swap_b32 v173, v175
    v_permlane16_swap_b32 v176, v178
    v_permlane16_swap_b32 v177, v179
    s_cmp_eq_u32 s41, 0
    s_cbranch_scc0 K2_STF
    buffer_store_dwordx4 v[172:175], v204, s[24:27], s44 offen sc1
    s_branch K2_STD
K2_STF:
    v_mov_b32 v60, v172
    v_mov_b32 v61, v173
    v_mov_b32 v62, v174
    v_mov_b32 v63, v175
    v_cmp_lt_u32 vcc, 7, v210
    v_add_u32 v208, 4294737984, v204
    s_add_u32 s45, s44, 229376
    v_mov_b32_dpp v172, v176 row_ror:8 row_mask:0xf bank_mask:0xc
    v_mov_b32_dpp v173, v177 row_ror:8 row_mask:0xf bank_mask:0xc
    v_mov_b32_dpp v174, v178 row_ror:8 row_mask:0xf bank_mask:0xc
    v_mov_b32_dpp v175, v179 row_ror:8 row_mask:0xf bank_mask:0xc
    v_mov_b32_dpp v176, v60 row_ror:8 row_mask:0xf bank_mask:0x3
    v_mov_b32_dpp v177, v61 row_ror:8 row_mask:0xf bank_mask:0x3
    v_mov_b32_dpp v178, v62 row_ror:8 row_mask:0xf bank_mask:0x3
    v_mov_b32_dpp v179, v63 row_ror:8 row_mask:0xf bank_mask:0x3
    v_cndmask_b32 v204, v204, v208, vcc
    buffer_store_dwordx4 v[172:175], v204, s[24:27], s44 offen sc1
    buffer_store_dwordx4 v[176:179], v204, s[24:27], s45 offen sc1
K2_STD:
    s_waitcnt vmcnt(0)
    v_cmp_gt_u32 vcc, 16, v1
    v_lshlrev_b32 v8, 3, v1
    v_mov_b32 v10, 2146435072
    v_cndmask_b32 v10, v10, v8, vcc
    v_mov_b32 v8, s62
    v_mov_b32 v9, s63
    buffer_store_dwordx2 v[8:9], v10, s[24:27], s52 offen sc1
K2_FSKIP:
    v_mov_b32 v8, 98316
    v_mov_b32 v9, 1
    ds_add_u32 v8, v9
    s_cmp_ge_u32 s2, 224
    s_cbranch_scc1 K2_FX
    s_mov_b32 s20, s8
    s_and_b32 s21, s9, 0xffff
    s_mov_b32 s22, 401408
    s_mov_b32 s23, 0x20000
    v_lshrrev_b32 v4, 3, v1
    v_mul_u32_u24 v4, 896, v4
    v_and_b32 v5, 7, v1
    v_bfe_u32 v6, v1, 4, 1
    v_lshlrev_b32 v6, 2, v6
    v_xor_b32 v5, v5, v6
    v_lshl_add_u32 v4, v5, 4, v4
    s_lshr_b32 s44, s2, 5
    s_lshl_b32 s44, s44, 7
    s_mul_i32 s45, s36, 100352
    s_add_u32 s44, s44, s45
    s_mul_i32 s45, s36, 14336
    s_mov_b32 s46, 14
K2_WOL:
    s_add_u32 m0, s45, 0
    s_add_u32 s45, s45, 1024
    buffer_load_dwordx4 v4, s[20:23], s44 offen lds
    s_add_u32 s44, s44, 7168
    s_waitcnt vmcnt(5)
    s_sub_u32 s46, s46, 1
    s_cmp_lg_u32 s46, 0
    s_cbranch_scc1 K2_WOL
    s_mul_i32 s44, s36, 56
    v_add_u32 v4, s44, v1
    v_cmp_gt_u32 vcc, 56, v1
    v_mov_b32 v5, 224
    s_lshr_b32 s44, s40, 1
    s_lshl_b32 s44, s44, 15
    v_cndmask_b32 v4, v5, v4, vcc
    v_lshlrev_b32 v4, 7, v4
    s_add_u32 s44, s44, 16252928
    s_mov_b32 s61, 200000
POLL12:
    buffer_load_dwordx2 v[60:61], v4, s[24:27], s44 offen offset:0 sc1
    s_waitcnt vmcnt(0)
    v_xor_b32 v60, s62, v60
    v_xor_b32 v61, s63, v61
    v_or_b32 v60, v60, v61
    v_cmp_ne_u32 vcc, 0, v60
    s_sub_u32 s61, s61, 1
    s_cbranch_scc1 POLL12_X
    s_cmp_eq_u64 vcc, 0
    s_cbranch_scc1 POLL12_X
    s_sleep 5
    s_branch POLL12
POLL12_X:
    s_lshl_b32 s44, s40, 2
    s_and_b32 s45, s39, 3
    s_add_u32 s44, s44, s45
    s_lshl_b32 s44, s44, 1
    s_lshr_b32 s45, s36, 1
    s_add_u32 s44, s44, s45
    s_xor_b32 s45, s44, 1
    s_mul_i32 s46, s36, 7168
    s_add_u32 s46, s46, 10485760
    s_mul_i32 s44, s44, 28672
    s_mul_i32 s45, s45, 28672
    s_add_u32 s44, s44, s46
    s_add_u32 s45, s45, s46
    s_mul_i32 s46, s36, 14336
    s_add_u32 m0, s46, 106496
    s_nop 0
    buffer_load_dwordx4 v2, s[24:27], s44 offen sc1 lds
    s_add_u32 m0, s46, 107520
    s_add_u32 s44, s44, 1024
    buffer_load_dwordx4 v2, s[24:27], s44 offen sc1 lds
    s_add_u32 m0, s46, 108544
    s_add_u32 s44, s44, 1024
    buffer_load_dwordx4 v2, s[24:27], s44 offen sc1 lds
    s_add_u32 m0, s46, 109568
    s_add_u32 s44, s44, 1024
    buffer_load_dwordx4 v2, s[24:27], s44 offen sc1 lds
    s_add_u32 m0, s46, 110592
    s_add_u32 s44, s44, 1024
    buffer_load_dwordx4 v2, s[24:27], s44 offen sc1 lds
    s_add_u32 m0, s46, 111616
    s_add_u32 s44, s44, 1024
    buffer_load_dwordx4 v2, s[24:27], s44 offen sc1 lds
    s_add_u32 m0, s46, 112640
    s_add_u32 s44, s44, 1024
    buffer_load_dwordx4 v2, s[24:27], s44 offen sc1 lds
    s_add_u32 m0, s46, 113664
    s_nop 0
    buffer_load_dwordx4 v2, s[24:27], s45 offen sc1 lds
    s_add_u32 m0, s46, 114688
    s_add_u32 s45, s45, 1024
    buffer_load_dwordx4 v2, s[24:27], s45 offen sc1 lds
    s_add_u32 m0, s46, 115712
    s_add_u32 s45, s45, 1024
    buffer_load_dwordx4 v2, s[24:27], s45 offen sc1 lds
    s_add_u32 m0, s46, 116736
    s_add_u32 s45, s45, 1024
    buffer_load_dwordx4 v2, s[24:27], s45 offen sc1 lds
    s_add_u32 m0, s46, 117760
    s_add_u32 s45, s45, 1024
    buffer_load_dwordx4 v2, s[24:27], s45 offen sc1 lds
    s_add_u32 m0, s46, 118784
    s_add_u32 s45, s45, 1024
    buffer_load_dwordx4 v2, s[24:27], s45 offen sc1 lds
    s_add_u32 m0, s46, 119808
    s_add_u32 s45, s45, 1024
    buffer_load_dwordx4 v2, s[24:27], s45 offen sc1 lds
K2_FX:
    s_waitcnt vmcnt(0)
    s_waitcnt lgkmcnt(0)
    s_endpgm
K_END:
    s_endpgm
.section .rodata,"a"
.p2align 6
.amdhsa_kernel gated_mix__spectral_gfnet__softmax_full_mha__prompt_kernel
  .amdhsa_next_free_vgpr 256
  .amdhsa_next_free_sgpr 102
  .amdhsa_accum_offset 256
  .amdhsa_group_segment_fixed_size 0
  .amdhsa_kernarg_size 80
  .amdhsa_user_sgpr_count 2
  .amdhsa_user_sgpr_kernarg_segment_ptr 1
  .amdhsa_system_sgpr_workgroup_id_x 1
  .amdhsa_float_denorm_mode_32 3
.end_amdhsa_kernel
```
